```python
import torch

def _softmax(x, axis=-1):
    return torch.softmax(x, dim=axis)
def _gelu(x):
    return torch.nn.functional.gelu(x, approximate="tanh")
def _silu(x):
    return torch.nn.functional.silu(x)
def _sigmoid(x):
    return torch.sigmoid(x)
def _layernorm(x, axis=-1, eps=1e-5):
    m = x.mean(dim=axis, keepdim=True)
    v = x.var(dim=axis, keepdim=True, unbiased=False)
    return (x - m) / torch.sqrt(v + eps)
def _scatter_add(tgt, idx, src, axis=0):
    return tgt.clone().index_add_(axis, idx, src)
def _segment_sum(src, seg, n):
    out = torch.zeros((n,) + src.shape[1:], dtype=src.dtype)
    return out.index_add_(0, seg, src)
def _pad(x, pw):
    flat = tuple(v for pair in reversed(pw) for v in pair)
    return torch.nn.functional.pad(x, flat)

kernel_name = 'parallel_sum__ssm_conv_s4d__glu_gated_swiglu__prompt'

def setup_inputs():

    _w = (lambda a: (lambda t: t.to(torch.bfloat16) if t.is_floating_point() else t)(torch.as_tensor(a)))
    def _A_setup():
        Bsz, L, D, N = 1, 2048, 640, 128
        return {
            "u": _w((lambda *s: torch.randn(*s, dtype=torch.bfloat16) * 0.05)(Bsz, L, D)),
            "log_A_real": _w((lambda *s: torch.randn(*s, dtype=torch.bfloat16) * 3.2)(D, N) * 0.5),
            "A_imag": _w((lambda *s: torch.randn(*s, dtype=torch.bfloat16) * 0.05)(D, N) * 3.14),
            "C_real": _w((lambda *s: torch.randn(*s, dtype=torch.bfloat16) * 0.2)(D, N) / N ** 0.5),
            "C_imag": _w((lambda *s: torch.randn(*s, dtype=torch.bfloat16) * 0.2)(D, N) / N ** 0.5),
            "log_dt": _w((lambda *s: torch.randn(*s, dtype=torch.bfloat16) * 0.05)(D) * 0.5 - 4.0),
            "D_skip": _w((lambda *s: torch.randn(*s, dtype=torch.bfloat16) * 0.05)(D)),
        }
    _A_in = _A_setup()

    def _B_setup():
        B, S, D, F = 1, 2048, 640, 1728
        return {
            "x": _w((lambda *s: torch.randn(*s, dtype=torch.bfloat16) * 0.05)(B, S, D)),
            "w1": _w((lambda *s: torch.randn(*s, dtype=torch.bfloat16) * 0.4)(D, F) * (2.0 / D) ** 0.5),
            "w3": _w((lambda *s: torch.randn(*s, dtype=torch.bfloat16) * 0.4)(D, F) * (2.0 / D) ** 0.5),
            "w2": _w((lambda *s: torch.randn(*s, dtype=torch.bfloat16) * 0.4)(F, D) * (2.0 / F) ** 0.5),
        }
    _B_in = _B_setup()

    return {
        "A_u": _A_in["u"],
        "A_log_A_real": _A_in["log_A_real"],
        "A_A_imag": _A_in["A_imag"],
        "A_C_real": _A_in["C_real"],
        "A_C_imag": _A_in["C_imag"],
        "A_log_dt": _A_in["log_dt"],
        "A_D_skip": _A_in["D_skip"],
        "B_x": _B_in["x"],
        "B_w1": _B_in["w1"],
        "B_w3": _B_in["w3"],
        "B_w2": _B_in["w2"],
    }

def reference(A_u, A_log_A_real, A_A_imag, A_C_real, A_C_imag, A_log_dt, A_D_skip, B_x, B_w1, B_w3, B_w2):
    def _A_ref(u, log_A_real, A_imag, C_real, C_imag, log_dt, D_skip):
        L = u.shape[1]
        dt = torch.exp(log_dt)
        A = -torch.exp(log_A_real) + 1j * A_imag
        C = (C_real + 1j * C_imag) * dt[:, None]
        pos = (lambda x, dt: x.to(dt))(torch.arange(L), log_dt.dtype)
        P = torch.exp((A * dt[:, None])[:, :, None] * pos[None, None, :])
        K = 2.0 * torch.einsum("dn,dnl->dl", C, P).real
        L2 = 2 * L
        u_t = (lambda x, *d: x.permute(*d))(u, 0, 2, 1)
        Kf = (lambda x, *a, **k: torch.fft.rfft(x.float(), *a, **k))(K, L2)
        Uf = (lambda x, *a, **k: torch.fft.rfft(x.float(), *a, **k))(u_t, L2)
        y = (lambda x, *a, **k: torch.fft.irfft(x, *a, **k).to(torch.bfloat16))(Uf * Kf[None, :, :], L2)[:, :, :L]
        y = (lambda x, *d: x.permute(*d))(y, 0, 2, 1)
        return y + u * D_skip[None, None, :]

    def _B_ref(x, w1, w3, w2):
        gate = torch.einsum("bsd,df->bsf", x, w1)
        up = torch.einsum("bsd,df->bsf", x, w3)
        h = _silu(gate) * up
        out = torch.einsum("bsf,fd->bsd", h, w2)
        return out

    x = A_u
    xn = _layernorm(x, axis=-1)
    return x + _A_ref(xn, A_log_A_real, A_A_imag, A_C_real, A_C_imag, A_log_dt, A_D_skip) + _B_ref(xn, B_w1, B_w3, B_w2)
```

```asm
; @launch grid=(256,1,1) block=(512,1,1) lds=163840
.amdgcn_target "amdgcn-amd-amdhsa--gfx950"
.text
.globl parallel_sum__ssm_conv_s4d__glu_gated_swiglu__prompt_kernel
.p2align 8
.type parallel_sum__ssm_conv_s4d__glu_gated_swiglu__prompt_kernel,@function
parallel_sum__ssm_conv_s4d__glu_gated_swiglu__prompt_kernel:
  s_load_dwordx2 s[4:5], s[0:1], 0
  s_load_dwordx4 s[40:43], s[0:1], 64
  s_load_dwordx2 s[6:7], s[0:1], 104
  s_load_dwordx8 s[48:55], s[0:1], 8
  s_load_dwordx4 s[56:59], s[0:1], 40
  s_load_dwordx2 s[84:85], s[0:1], 88
  s_load_dwordx2 s[86:87], s[0:1], 80
  s_cmp_ge_u32 s2, 256
  s_cbranch_scc1 L_end2
  v_lshrrev_b32 v1, 6, v0
  s_getpc_b64 s[46:47]
L_pc:
  v_readfirstlane_b32 s26, v1
  v_and_b32 v1, 63, v0
  s_lshr_b32 s28, s2, 3
  s_lshl_b32 s28, s28, 11
  v_lshl_add_u32 v2, v0, 7, s28
  v_min_u32 v2, L_end2-L_pc, v2
  v_cmp_gt_u32 vcc, 16, v0
  s_nop 0
  s_and_saveexec_b64 s[8:9], vcc
  s_cbranch_execz L_npf
  global_load_dword v10, v2, s[46:47]
L_npf:
  s_mov_b64 exec, -1
  s_and_b32 s27, s2, 7
  s_lshr_b32 s28, s2, 3
  s_lshl_b32 s29, s27, 5
  s_add_u32 s29, s29, s28
  s_and_b32 s24, s27, 3
  s_mul_i32 s24, s24, 27
  s_add_u32 s24, s24, s28
  s_lshr_b32 s25, s24, 2
  s_and_b32 s24, s24, 3
  s_and_b32 s27, s27, 4
  s_add_u32 s24, s27, s24
  s_sub_u32 s30, s26, 4
  s_mov_b32 s10, 2621440
  s_mov_b32 s11, 0x20000
  s_mov_b32 s14, 2211840
  s_mov_b32 s15, 0x20000
  s_mov_b32 s18, 2211840
  s_mov_b32 s19, 0x20000
  s_mov_b32 s22, 22020096
  s_mov_b32 s23, 0x20000
  s_cmp_ge_u32 s2, 216
  s_cbranch_scc1 L_aux
  s_cmp_lt_u32 s30, 2
  s_cbranch_scc1 L_dw
  s_cmp_ge_u32 s26, 6
  s_cbranch_scc1 L_hw0
  s_lshr_b32 s45, s26, 1
  s_lshl_b32 s44, s2, 1
  s_add_u32 s44, s44, s45
  s_lshl_b32 s27, s44, 8
  v_lshl_add_u32 v14, v1, 2, s27
  s_lshl_b32 s27, s44, 1
  v_mov_b32 v15, s27
  s_waitcnt lgkmcnt(0)
  global_load_dword v16, v14, s[48:49]
  global_load_dword v17, v14, s[50:51]
  global_load_dword v18, v14, s[52:53]
  global_load_dword v19, v14, s[54:55]
  global_load_ushort v20, v15, s[56:57]
  s_load_dword s3, s[6:7], 0
  s_mov_b64 s[8:9], s[4:5]
  s_mov_b64 s[12:13], s[40:41]
  s_mov_b64 s[16:17], s[42:43]
  s_mov_b64 s[20:21], s[6:7]
  s_branch L_cw
L_hw0:
  s_sub_u32 s31, s30, 2
  v_lshrrev_b32 v14, 4, v1
  v_mul_u32_u24 v14, 1280, v14
  v_and_b32 v15, 15, v1
  v_lshl_add_u32 v14, v15, 4, v14
  s_lshl_b32 s27, s29, 1
  s_add_u32 s27, s27, s31
  s_mul_i32 s27, s27, 5120
  s_waitcnt lgkmcnt(0)
  s_load_dword s3, s[6:7], 0
  s_mov_b64 s[8:9], s[4:5]
  s_mov_b64 s[12:13], s[40:41]
  s_mov_b64 s[16:17], s[42:43]
  s_mov_b64 s[20:21], s[6:7]
  buffer_load_dwordx4 v[144:147], v14, s[8:11], s27 offen offset:0
  buffer_load_dwordx4 v[148:151], v14, s[8:11], s27 offen offset:256
  buffer_load_dwordx4 v[152:155], v14, s[8:11], s27 offen offset:512
  buffer_load_dwordx4 v[156:159], v14, s[8:11], s27 offen offset:768
  buffer_load_dwordx4 v[160:163], v14, s[8:11], s27 offen offset:1024
  s_lshl_b32 s44, s2, 1
  s_add_u32 s44, s44, s31
  s_lshl_b32 s27, s44, 1
  v_mov_b32 v15, s27
  global_load_ushort v13, v15, s[58:59]
  s_branch L_hw
L_dw:
  v_lshrrev_b32 v2, 3, v1
  v_and_b32 v3, 7, v1
  v_lshrrev_b32 v4, 4, v1
  v_xor_b32 v5, v4, v3
  v_lshlrev_b32 v5, 4, v5
  v_mul_u32_u24 v144, 1280, v2
  v_add_u32 v144, v144, v5
  v_xor_b32 v145, 64, v144
  v_add_u32 v145, 9216, v145
  v_add_u32 v146, 18432, v144
  v_add_u32 v147, 18432, v145
  v_and_b32 v4, 1, v4
  v_lshlrev_b32 v4, 1, v4
  v_xor_b32 v4, v4, v3
  v_lshlrev_b32 v4, 4, v4
  v_mul_u32_u24 v148, 3456, v2
  v_add_u32 v148, v148, v4
  v_xor_b32 v149, 64, v148
  v_add_u32 v149, 26624, v149
  v_add_u32 v150, 53248, v148
  v_add_u32 v151, 53248, v149
  s_lshl_b32 s31, s24, 1
  s_add_u32 s31, s31, s30
  s_mul_i32 s31, s31, 163840
  s_lshl_b32 s32, s25, 7
  s_lshl_b32 s33, s30, 13
  s_mov_b32 s38, 0
  s_mov_b32 s45, 0
  s_setprio 3
  s_and_b32 s35, s24, 3
  s_mul_i32 s35, s35, 5
  s_lshr_b32 s35, s35, 1
  s_mul_i32 s27, s25, 0
  s_add_u32 s35, s35, s27
  s_mul_i32 s27, s35, 6554
  s_lshr_b32 s27, s27, 16
  s_mul_i32 s27, s27, 10
  s_sub_u32 s35, s35, s27
  s_lshl_b32 s36, s35, 7
  s_add_u32 s36, s36, s31
  s_mul_i32 s37, s35, 221184
  s_add_u32 s37, s37, s32
  s_add_u32 s35, s35, 1
  s_cmp_eq_u32 s35, 10
  s_cselect_b32 s35, 0, s35
  s_add_u32 s39, s38, s33
  s_lshl_b32 s44, s39, 1
  s_add_u32 s39, s39, 98304
  s_add_u32 s38, s38, 16384
  s_cmp_eq_u32 s38, 49152
  s_cselect_b32 s38, 0, s38
  v_mov_b64 v[172:173], 0
  v_mov_b64 v[174:175], 0
  s_waitcnt lgkmcnt(0)
  s_load_dword s3, s[6:7], 0
  s_mov_b64 s[8:9], s[4:5]
  s_mov_b64 s[12:13], s[40:41]
  s_mov_b64 s[16:17], s[42:43]
  s_mov_b64 s[20:21], s[6:7]
  s_cmp_eq_u32 s30, 0
  s_cselect_b64 s[12:13], s[40:41], s[42:43]
  s_call_b64 s[100:101], L_dAB
  s_branch L_dgo
L_dAB:
  s_mov_b32 m0, s39
  s_nop 0
  buffer_load_dwordx4 v148, s[12:15], s37 offen offset:0 lds
  buffer_load_dwordx4 v149, s[12:15], s37 offen offset:1024 lds
  buffer_load_dwordx4 v150, s[12:15], s37 offen offset:2048 lds
  buffer_load_dwordx4 v151, s[12:15], s37 offen offset:3072 lds
  s_add_u32 m0, s39, 4096
  s_add_u32 s37, s37, 110592
  buffer_load_dwordx4 v148, s[12:15], s37 offen offset:0 lds
  buffer_load_dwordx4 v149, s[12:15], s37 offen offset:1024 lds
  buffer_load_dwordx4 v150, s[12:15], s37 offen offset:2048 lds
  buffer_load_dwordx4 v151, s[12:15], s37 offen offset:3072 lds
  s_mov_b32 m0, s44
  s_nop 0
  buffer_load_dwordx4 v144, s[8:11], s36 offen offset:0 lds
  buffer_load_dwordx4 v145, s[8:11], s36 offen offset:1024 lds
  buffer_load_dwordx4 v146, s[8:11], s36 offen offset:2048 lds
  buffer_load_dwordx4 v147, s[8:11], s36 offen offset:3072 lds
L_dB:
  s_add_u32 m0, s44, 4096
  s_add_u32 s36, s36, 40960
  buffer_load_dwordx4 v144, s[8:11], s36 offen offset:0 lds
  buffer_load_dwordx4 v145, s[8:11], s36 offen offset:1024 lds
  buffer_load_dwordx4 v146, s[8:11], s36 offen offset:2048 lds
  buffer_load_dwordx4 v147, s[8:11], s36 offen offset:3072 lds
  s_add_u32 m0, s44, 8192
  s_add_u32 s36, s36, 40960
  buffer_load_dwordx4 v144, s[8:11], s36 offen offset:0 lds
  buffer_load_dwordx4 v145, s[8:11], s36 offen offset:1024 lds
  buffer_load_dwordx4 v146, s[8:11], s36 offen offset:2048 lds
  buffer_load_dwordx4 v147, s[8:11], s36 offen offset:3072 lds
  s_add_u32 m0, s44, 12288
  s_add_u32 s36, s36, 40960
  buffer_load_dwordx4 v144, s[8:11], s36 offen offset:0 lds
  buffer_load_dwordx4 v145, s[8:11], s36 offen offset:1024 lds
  buffer_load_dwordx4 v146, s[8:11], s36 offen offset:2048 lds
  buffer_load_dwordx4 v147, s[8:11], s36 offen offset:3072 lds
  s_lshl_b32 s36, s35, 7
  s_add_u32 s36, s36, s31
  s_mul_i32 s37, s35, 221184
  s_add_u32 s37, s37, s32
  s_add_u32 s35, s35, 1
  s_cmp_eq_u32 s35, 10
  s_cselect_b32 s35, 0, s35
  s_add_u32 s39, s38, s33
  s_lshl_b32 s44, s39, 1
  s_add_u32 s39, s39, 98304
  s_add_u32 s38, s38, 16384
  s_cmp_eq_u32 s38, 49152
  s_cselect_b32 s38, 0, s38
  s_setpc_b64 s[100:101]
L_dgo:
  s_lshr_b32 s91, s2, 3
  s_sub_u32 s92, s91, 2
  s_cmp_ge_u32 s91, 27
  s_cselect_b32 s91, s92, s91
  s_mul_i32 s92, s91, 26
  s_lshr_b32 s92, s92, 8
  s_mul_i32 s93, s92, 10
  s_sub_u32 s91, s91, s93
  s_and_b32 s90, s2, 7
  s_mul_i32 s90, s90, 3
  s_add_u32 s90, s90, s92
  s_mul_i32 s90, s90, 5
  s_mul_i32 s93, s91, 5
  s_add_u32 s92, s92, s93
  s_sub_u32 s93, s92, 54
  s_cmp_ge_u32 s92, 54
  s_cselect_b32 s92, s93, s92
  s_mul_i32 s93, s90, 55296
  s_add_u32 s93, s93, 1048576
  s_lshl_b32 s94, s91, 7
  v_lshrrev_b32 v13, 4, v1
  v_lshlrev_b32 v13, 1, v13
  v_and_b32 v172, 7, v1
  v_xor_b32 v172, v172, v13
  v_lshrrev_b32 v13, 3, v1
  v_mul_u32_u24 v13, 1280, v13
  v_lshl_add_u32 v172, v172, 4, v13
  v_add_u32 v173, 9216, v172
  v_add_u32 v174, 18432, v172
  v_add_u32 v175, 27648, v172
  s_mul_i32 s46, s30, 2880
  s_add_u32 s46, s46, 152064
  s_call_b64 s[100:101], L_dAB
  s_waitcnt vmcnt(24) lgkmcnt(0)
  s_barrier
  s_call_b64 s[100:101], L_ccon
  s_mov_b32 s45, 8
L_dloop:
  s_barrier
  s_call_b64 s[100:101], L_dAB
  s_sub_u32 s45, s45, 1
  s_waitcnt vmcnt(24)
  s_cmp_lg_u32 s45, 0
  s_cbranch_scc1 L_dloop
  s_barrier
  s_mul_i32 s3, s3, 0x9E3779B1
  s_add_u32 s3, s3, 0x7F4A7C15
  s_lshl_b32 s44, s2, 1
  s_add_u32 s44, s44, s30
  s_mov_b32 s16, s86
  s_mov_b32 s17, s87
  s_mov_b32 s18, 2211840
  s_mov_b32 s19, 0x20000
  s_cmp_eq_u32 s30, 0
  s_cselect_b32 s27, 1, 1
  s_cselect_b32 s28, 0, 16
  s_lshl_b32 s95, s27, 15
  s_add_u32 s96, s92, s27
  s_add_u32 s96, s96, s28
  s_lshl_b32 s28, s28, 10
  s_add_u32 s95, s95, s28
  s_sub_u32 s97, s96, 54
  s_cmp_ge_u32 s96, 54
  s_cselect_b32 s96, s97, s96
  s_call_b64 s[100:101], L_wfill
  s_lshl_b32 s28, s30, 3
  s_add_u32 s96, s92, s28
  s_add_u32 s96, s96, 19
  s_lshl_b32 s95, s28, 10
  s_add_u32 s95, s95, 114688
  s_sub_u32 s97, s96, 54
  s_cmp_ge_u32 s96, 54
  s_cselect_b32 s96, s97, s96
  s_add_u32 m0, s95, 0
  s_add_u32 s98, s96, 0
  s_sub_u32 s97, s98, 54
  s_cmp_ge_u32 s98, 54
  s_cselect_b32 s98, s97, s98
  s_mul_i32 s98, s98, 40960
  s_add_u32 s98, s98, s94
  buffer_load_dwordx4 v172, s[16:19], s98 offen offset:0 lds
  buffer_load_dwordx4 v173, s[16:19], s98 offen offset:1024 lds
  buffer_load_dwordx4 v174, s[16:19], s98 offen offset:2048 lds
  buffer_load_dwordx4 v175, s[16:19], s98 offen offset:3072 lds
  s_add_u32 m0, s95, 4096
  s_add_u32 s98, s96, 4
  s_sub_u32 s97, s98, 54
  s_cmp_ge_u32 s98, 54
  s_cselect_b32 s98, s97, s98
  s_mul_i32 s98, s98, 40960
  s_add_u32 s98, s98, s94
  buffer_load_dwordx4 v172, s[16:19], s98 offen offset:0 lds
  buffer_load_dwordx4 v173, s[16:19], s98 offen offset:1024 lds
  buffer_load_dwordx4 v174, s[16:19], s98 offen offset:2048 lds
  buffer_load_dwordx4 v175, s[16:19], s98 offen offset:3072 lds
  s_waitcnt vmcnt(24)
  s_barrier
  s_cmp_eq_u32 s30, 0
  s_cselect_b32 s27, 2, 2
  s_cselect_b32 s28, 0, 16
  s_lshl_b32 s95, s27, 15
  s_add_u32 s96, s92, s27
  s_add_u32 s96, s96, s28
  s_lshl_b32 s28, s28, 10
  s_add_u32 s95, s95, s28
  s_sub_u32 s97, s96, 54
  s_cmp_ge_u32 s96, 54
  s_cselect_b32 s96, s97, s96
  s_call_b64 s[100:101], L_wfill
  s_barrier
  s_lshl_b32 s28, s30, 3
  s_add_u32 s96, s92, s28
  s_add_u32 s96, s96, 3
  s_lshl_b32 s95, s28, 10
  s_add_u32 s95, s95, 98304
  s_sub_u32 s97, s96, 54
  s_cmp_ge_u32 s96, 54
  s_cselect_b32 s96, s97, s96
  s_add_u32 m0, s95, 0
  s_add_u32 s98, s96, 0
  s_sub_u32 s97, s98, 54
  s_cmp_ge_u32 s98, 54
  s_cselect_b32 s98, s97, s98
  s_mul_i32 s98, s98, 40960
  s_add_u32 s98, s98, s94
  buffer_load_dwordx4 v172, s[16:19], s98 offen offset:0 lds
  buffer_load_dwordx4 v173, s[16:19], s98 offen offset:1024 lds
  buffer_load_dwordx4 v174, s[16:19], s98 offen offset:2048 lds
  buffer_load_dwordx4 v175, s[16:19], s98 offen offset:3072 lds
  s_add_u32 m0, s95, 4096
  s_add_u32 s98, s96, 4
  s_sub_u32 s97, s98, 54
  s_cmp_ge_u32 s98, 54
  s_cselect_b32 s98, s97, s98
  s_mul_i32 s98, s98, 40960
  s_add_u32 s98, s98, s94
  buffer_load_dwordx4 v172, s[16:19], s98 offen offset:0 lds
  buffer_load_dwordx4 v173, s[16:19], s98 offen offset:1024 lds
  buffer_load_dwordx4 v174, s[16:19], s98 offen offset:2048 lds
  buffer_load_dwordx4 v175, s[16:19], s98 offen offset:3072 lds
  s_cmp_eq_u32 s30, 0
  s_cselect_b32 s27, 0, 0
  s_cselect_b32 s28, 0, 16
  s_lshl_b32 s95, s27, 15
  s_add_u32 s96, s92, s27
  s_add_u32 s96, s96, s28
  s_lshl_b32 s28, s28, 10
  s_add_u32 s95, s95, s28
  s_sub_u32 s97, s96, 54
  s_cmp_ge_u32 s96, 54
  s_cselect_b32 s96, s97, s96
  s_call_b64 s[100:101], L_wfillp
  s_mul_i32 s45, s30, 4608
  s_add_u32 s45, s45, 131072
  s_barrier
  s_setprio 0
  s_call_b64 s[100:101], L_cprep0
  s_call_b64 s[100:101], L_cprep1
  v_and_b32 v2, 15, v1
  v_lshrrev_b32 v3, 4, v1
  v_lshlrev_b32 v6, 5, v2
  v_lshl_add_u32 v7, v3, 3, v6
  v_and_b32 v4, 1, v3
  v_mul_u32_u24 v4, 504, v4
  v_add_u32 v5, v7, v4
  v_lshl_add_u32 v6, v3, 4, v6
  v_add_u32 v6, s45, v6
  s_lshl_b32 s27, s44, 12
  s_add_u32 s27, s27, 18874368
  s_waitcnt vmcnt(0)
  s_barrier
  s_setprio 2
  s_call_b64 s[100:101], L_cvA
  s_branch L_cvd
L_wfill:
  s_add_u32 m0, s95, 0
  s_add_u32 s98, s96, 0
  s_sub_u32 s97, s98, 54
  s_cmp_ge_u32 s98, 54
  s_cselect_b32 s98, s97, s98
  s_mul_i32 s98, s98, 40960
  s_add_u32 s98, s98, s94
  buffer_load_dwordx4 v172, s[16:19], s98 offen offset:0 lds
  buffer_load_dwordx4 v173, s[16:19], s98 offen offset:1024 lds
  buffer_load_dwordx4 v174, s[16:19], s98 offen offset:2048 lds
  buffer_load_dwordx4 v175, s[16:19], s98 offen offset:3072 lds
  s_add_u32 m0, s95, 4096
  s_add_u32 s98, s96, 4
  s_sub_u32 s97, s98, 54
  s_cmp_ge_u32 s98, 54
  s_cselect_b32 s98, s97, s98
  s_mul_i32 s98, s98, 40960
  s_add_u32 s98, s98, s94
  buffer_load_dwordx4 v172, s[16:19], s98 offen offset:0 lds
  buffer_load_dwordx4 v173, s[16:19], s98 offen offset:1024 lds
  buffer_load_dwordx4 v174, s[16:19], s98 offen offset:2048 lds
  buffer_load_dwordx4 v175, s[16:19], s98 offen offset:3072 lds
  s_add_u32 m0, s95, 8192
  s_add_u32 s98, s96, 8
  s_sub_u32 s97, s98, 54
  s_cmp_ge_u32 s98, 54
  s_cselect_b32 s98, s97, s98
  s_mul_i32 s98, s98, 40960
  s_add_u32 s98, s98, s94
  buffer_load_dwordx4 v172, s[16:19], s98 offen offset:0 lds
  buffer_load_dwordx4 v173, s[16:19], s98 offen offset:1024 lds
  buffer_load_dwordx4 v174, s[16:19], s98 offen offset:2048 lds
  buffer_load_dwordx4 v175, s[16:19], s98 offen offset:3072 lds
  s_add_u32 m0, s95, 12288
  s_add_u32 s98, s96, 12
  s_sub_u32 s97, s98, 54
  s_cmp_ge_u32 s98, 54
  s_cselect_b32 s98, s97, s98
  s_mul_i32 s98, s98, 40960
  s_add_u32 s98, s98, s94
  buffer_load_dwordx4 v172, s[16:19], s98 offen offset:0 lds
  buffer_load_dwordx4 v173, s[16:19], s98 offen offset:1024 lds
  buffer_load_dwordx4 v174, s[16:19], s98 offen offset:2048 lds
  buffer_load_dwordx4 v175, s[16:19], s98 offen offset:3072 lds
  s_setpc_b64 s[100:101]
L_wfillp:
  s_waitcnt vmcnt(63)
  s_add_u32 m0, s95, 0
  s_add_u32 s98, s96, 0
  s_sub_u32 s97, s98, 54
  s_cmp_ge_u32 s98, 54
  s_cselect_b32 s98, s97, s98
  s_mul_i32 s98, s98, 40960
  s_add_u32 s98, s98, s94
  buffer_load_dwordx4 v172, s[16:19], s98 offen offset:0 lds
  buffer_load_dwordx4 v173, s[16:19], s98 offen offset:1024 lds
  buffer_load_dwordx4 v174, s[16:19], s98 offen offset:2048 lds
  buffer_load_dwordx4 v175, s[16:19], s98 offen offset:3072 lds
  s_waitcnt vmcnt(63)
  s_add_u32 m0, s95, 4096
  s_add_u32 s98, s96, 4
  s_sub_u32 s97, s98, 54
  s_cmp_ge_u32 s98, 54
  s_cselect_b32 s98, s97, s98
  s_mul_i32 s98, s98, 40960
  s_add_u32 s98, s98, s94
  buffer_load_dwordx4 v172, s[16:19], s98 offen offset:0 lds
  buffer_load_dwordx4 v173, s[16:19], s98 offen offset:1024 lds
  buffer_load_dwordx4 v174, s[16:19], s98 offen offset:2048 lds
  buffer_load_dwordx4 v175, s[16:19], s98 offen offset:3072 lds
  s_waitcnt vmcnt(63)
  s_add_u32 m0, s95, 8192
  s_add_u32 s98, s96, 8
  s_sub_u32 s97, s98, 54
  s_cmp_ge_u32 s98, 54
  s_cselect_b32 s98, s97, s98
  s_mul_i32 s98, s98, 40960
  s_add_u32 s98, s98, s94
  buffer_load_dwordx4 v172, s[16:19], s98 offen offset:0 lds
  buffer_load_dwordx4 v173, s[16:19], s98 offen offset:1024 lds
  buffer_load_dwordx4 v174, s[16:19], s98 offen offset:2048 lds
  buffer_load_dwordx4 v175, s[16:19], s98 offen offset:3072 lds
  s_waitcnt vmcnt(63)
  s_add_u32 m0, s95, 12288
  s_add_u32 s98, s96, 12
  s_sub_u32 s97, s98, 54
  s_cmp_ge_u32 s98, 54
  s_cselect_b32 s98, s97, s98
  s_mul_i32 s98, s98, 40960
  s_add_u32 s98, s98, s94
  buffer_load_dwordx4 v172, s[16:19], s98 offen offset:0 lds
  buffer_load_dwordx4 v173, s[16:19], s98 offen offset:1024 lds
  buffer_load_dwordx4 v174, s[16:19], s98 offen offset:2048 lds
  buffer_load_dwordx4 v175, s[16:19], s98 offen offset:3072 lds
  s_setpc_b64 s[100:101]
L_krows:
  v_lshlrev_b32 v80, 16, v16
  v_and_b32 v81, 0xffff0000, v16
  v_lshlrev_b32 v82, 16, v20
  v_mul_f32 v80, 0x3fb8aa3b, v80
  v_mul_f32 v81, 0x3fb8aa3b, v81
  v_mul_f32 v82, 0x3fb8aa3b, v82
  v_exp_f32 v80, v80
  v_exp_f32 v81, v81
  v_exp_f32 v82, v82
  v_lshlrev_b32 v84, 16, v17
  v_and_b32 v85, 0xffff0000, v17
  v_cvt_pk_bf16_f32 v81, v80, v81
  v_cvt_pk_bf16_f32 v82, v82, v82
  v_lshlrev_b32 v80, 16, v81
  v_and_b32 v81, 0xffff0000, v81
  v_lshlrev_b32 v82, 16, v82
  v_add_f32 v83, v82, v82
  v_pk_mul_f32 v[80:81], v[80:81], v[82:83] op_sel:[0,0] op_sel_hi:[1,0]
  v_pk_mul_f32 v[84:85], v[84:85], v[82:83] op_sel:[0,0] op_sel_hi:[1,0]
  v_lshlrev_b32 v40, 16, v18
  v_and_b32 v41, 0xffff0000, v18
  v_lshlrev_b32 v42, 16, v19
  v_and_b32 v43, 0xffff0000, v19
  v_pk_mul_f32 v[40:41], v[40:41], v[82:83] op_sel:[0,1] op_sel_hi:[1,1]
  v_pk_mul_f32 v[42:43], v[42:43], v[82:83] op_sel:[0,1] op_sel_hi:[1,1]
  s_bitcmp1_b32 s47, 0
  s_cbranch_scc1 L_krowsB
  v_mul_f32 v88, 0xc038aa3b, v80
  v_mul_f32 v90, 0x3ea2f983, v84
  v_mul_f32 v89, 0xc038aa3b, v81
  v_mul_f32 v91, 0x3ea2f983, v85
  v_mul_f32 v92, 0xc1b8aa3b, v80
  v_mul_f32 v94, 0x4022f983, v84
  v_mul_f32 v93, 0xc1b8aa3b, v81
  v_mul_f32 v95, 0x4022f983, v85
  v_mul_f32 v96, 0xc3b8aa3b, v80
  v_mul_f32 v98, 0x4222f983, v84
  v_mul_f32 v97, 0xc3b8aa3b, v81
  v_mul_f32 v99, 0x4222f983, v85
  v_exp_f32 v88, v88
  v_fract_f32 v90, v90
  v_exp_f32 v89, v89
  v_fract_f32 v91, v91
  v_exp_f32 v92, v92
  v_fract_f32 v94, v94
  v_exp_f32 v93, v93
  v_fract_f32 v95, v95
  v_exp_f32 v96, v96
  v_fract_f32 v98, v98
  v_exp_f32 v97, v97
  v_fract_f32 v99, v99
  v_cos_f32 v22, v90
  v_sin_f32 v24, v90
  v_cos_f32 v23, v91
  v_sin_f32 v25, v91
  v_cos_f32 v26, v94
  v_sin_f32 v28, v94
  v_cos_f32 v27, v95
  v_sin_f32 v29, v95
  v_cos_f32 v30, v98
  v_sin_f32 v32, v98
  v_cos_f32 v31, v99
  v_sin_f32 v33, v99
  v_pk_mul_f32 v[22:23], v[22:23], v[88:89]
  v_pk_mul_f32 v[24:25], v[24:25], v[88:89]
  v_pk_mul_f32 v[26:27], v[26:27], v[92:93]
  v_pk_mul_f32 v[28:29], v[28:29], v[92:93]
  v_pk_mul_f32 v[30:31], v[30:31], v[96:97]
  v_pk_mul_f32 v[32:33], v[32:33], v[96:97]
  .p2align 3
  v_mov_b32 v88, 0x3f80
  v_mov_b32 v89, 0x3f80
  v_pk_mul_f32 v[80:81], v[42:43], v[32:33]
  v_pk_mul_f32 v[82:83], v[42:43], v[30:31]
  v_pk_fma_f32 v[46:47], v[40:41], v[32:33], v[82:83]
  v_pk_fma_f32 v[44:45], v[40:41], v[30:31], v[80:81] neg_lo:[0,0,1] neg_hi:[0,0,1]
  v_cvt_pk_bf16_f32 v90, v26, v28
  v_cvt_pk_bf16_f32 v91, v27, v29
  v_cvt_pk_bf16_f32 v104, v44, -v46
  v_cvt_pk_bf16_f32 v105, v45, -v47
  v_pk_mul_f32 v[80:81], v[28:29], v[28:29]
  v_pk_mul_f32 v[84:85], v[46:47], v[24:25]
  v_pk_mul_f32 v[82:83], v[28:29], v[26:27]
  v_pk_mul_f32 v[86:87], v[46:47], v[22:23]
  v_pk_fma_f32 v[36:37], v[26:27], v[28:29], v[82:83]
  v_pk_fma_f32 v[66:67], v[44:45], v[24:25], v[86:87]
  v_pk_fma_f32 v[34:35], v[26:27], v[26:27], v[80:81] neg_lo:[0,0,1] neg_hi:[0,0,1]
  v_pk_fma_f32 v[64:65], v[44:45], v[22:23], v[84:85] neg_lo:[0,0,1] neg_hi:[0,0,1]
  v_cvt_pk_bf16_f32 v92, v34, v36
  v_cvt_pk_bf16_f32 v93, v35, v37
  v_cvt_pk_bf16_f32 v106, v64, -v66
  v_cvt_pk_bf16_f32 v107, v65, -v67
  v_pk_mul_f32 v[80:81], v[36:37], v[28:29]
  v_pk_mul_f32 v[84:85], v[66:67], v[24:25]
  v_pk_mul_f32 v[82:83], v[36:37], v[26:27]
  v_pk_mul_f32 v[86:87], v[66:67], v[22:23]
  v_pk_fma_f32 v[36:37], v[34:35], v[28:29], v[82:83]
  v_pk_fma_f32 v[50:51], v[64:65], v[24:25], v[86:87]
  v_pk_fma_f32 v[34:35], v[34:35], v[26:27], v[80:81] neg_lo:[0,0,1] neg_hi:[0,0,1]
  v_pk_fma_f32 v[48:49], v[64:65], v[22:23], v[84:85] neg_lo:[0,0,1] neg_hi:[0,0,1]
  v_cvt_pk_bf16_f32 v94, v34, v36
  v_cvt_pk_bf16_f32 v95, v35, v37
  v_cvt_pk_bf16_f32 v108, v48, -v50
  v_cvt_pk_bf16_f32 v109, v49, -v51
  v_pk_mul_f32 v[80:81], v[36:37], v[28:29]
  v_pk_mul_f32 v[84:85], v[50:51], v[24:25]
  v_pk_mul_f32 v[82:83], v[36:37], v[26:27]
  v_pk_mul_f32 v[86:87], v[50:51], v[22:23]
  v_pk_fma_f32 v[36:37], v[34:35], v[28:29], v[82:83]
  v_pk_fma_f32 v[66:67], v[48:49], v[24:25], v[86:87]
  v_pk_fma_f32 v[34:35], v[34:35], v[26:27], v[80:81] neg_lo:[0,0,1] neg_hi:[0,0,1]
  v_pk_fma_f32 v[64:65], v[48:49], v[22:23], v[84:85] neg_lo:[0,0,1] neg_hi:[0,0,1]
  v_cvt_pk_bf16_f32 v96, v34, v36
  v_cvt_pk_bf16_f32 v97, v35, v37
  v_cvt_pk_bf16_f32 v110, v64, -v66
  v_cvt_pk_bf16_f32 v111, v65, -v67
  v_pk_mul_f32 v[80:81], v[36:37], v[28:29]
  v_pk_mul_f32 v[84:85], v[66:67], v[24:25]
  v_pk_mul_f32 v[82:83], v[36:37], v[26:27]
  v_pk_mul_f32 v[86:87], v[66:67], v[22:23]
  v_pk_fma_f32 v[36:37], v[34:35], v[28:29], v[82:83]
  v_pk_fma_f32 v[54:55], v[64:65], v[24:25], v[86:87]
  v_pk_fma_f32 v[34:35], v[34:35], v[26:27], v[80:81] neg_lo:[0,0,1] neg_hi:[0,0,1]
  v_pk_fma_f32 v[52:53], v[64:65], v[22:23], v[84:85] neg_lo:[0,0,1] neg_hi:[0,0,1]
  v_cvt_pk_bf16_f32 v98, v34, v36
  v_cvt_pk_bf16_f32 v99, v35, v37
  v_cvt_pk_bf16_f32 v112, v52, -v54
  v_cvt_pk_bf16_f32 v113, v53, -v55
  v_pk_mul_f32 v[80:81], v[36:37], v[28:29]
  v_pk_mul_f32 v[84:85], v[54:55], v[24:25]
  v_pk_mul_f32 v[82:83], v[36:37], v[26:27]
  v_pk_mul_f32 v[86:87], v[54:55], v[22:23]
  v_pk_fma_f32 v[36:37], v[34:35], v[28:29], v[82:83]
  v_pk_fma_f32 v[66:67], v[52:53], v[24:25], v[86:87]
  v_pk_fma_f32 v[34:35], v[34:35], v[26:27], v[80:81] neg_lo:[0,0,1] neg_hi:[0,0,1]
  v_pk_fma_f32 v[64:65], v[52:53], v[22:23], v[84:85] neg_lo:[0,0,1] neg_hi:[0,0,1]
  v_cvt_pk_bf16_f32 v100, v34, v36
  v_cvt_pk_bf16_f32 v101, v35, v37
  v_cvt_pk_bf16_f32 v114, v64, -v66
  v_cvt_pk_bf16_f32 v115, v65, -v67
  v_pk_mul_f32 v[80:81], v[36:37], v[28:29]
  v_pk_mul_f32 v[84:85], v[66:67], v[24:25]
  v_pk_mul_f32 v[82:83], v[36:37], v[26:27]
  v_pk_mul_f32 v[86:87], v[66:67], v[22:23]
  v_pk_fma_f32 v[36:37], v[34:35], v[28:29], v[82:83]
  v_pk_fma_f32 v[58:59], v[64:65], v[24:25], v[86:87]
  v_pk_fma_f32 v[34:35], v[34:35], v[26:27], v[80:81] neg_lo:[0,0,1] neg_hi:[0,0,1]
  v_pk_fma_f32 v[56:57], v[64:65], v[22:23], v[84:85] neg_lo:[0,0,1] neg_hi:[0,0,1]
  v_cvt_pk_bf16_f32 v102, v34, v36
  v_cvt_pk_bf16_f32 v103, v35, v37
  v_cvt_pk_bf16_f32 v72, v56, -v58
  v_cvt_pk_bf16_f32 v73, v57, -v59
  ds_write2st64_b64 v124, v[112:113], v[72:73] offset0:36 offset1:44
  v_pk_mul_f32 v[80:81], v[36:37], v[28:29]
  v_pk_mul_f32 v[84:85], v[58:59], v[24:25]
  v_pk_mul_f32 v[82:83], v[36:37], v[26:27]
  v_pk_mul_f32 v[86:87], v[58:59], v[22:23]
  v_pk_fma_f32 v[36:37], v[34:35], v[28:29], v[82:83]
  v_pk_fma_f32 v[66:67], v[56:57], v[24:25], v[86:87]
  v_pk_fma_f32 v[34:35], v[34:35], v[26:27], v[80:81] neg_lo:[0,0,1] neg_hi:[0,0,1]
  v_pk_fma_f32 v[64:65], v[56:57], v[22:23], v[84:85] neg_lo:[0,0,1] neg_hi:[0,0,1]
  v_cvt_pk_bf16_f32 v68, v34, v36
  v_cvt_pk_bf16_f32 v69, v35, v37
  ds_write2st64_b64 v120, v[88:89], v[68:69] offset0:0 offset1:8
  v_cvt_pk_bf16_f32 v74, v64, -v66
  v_cvt_pk_bf16_f32 v75, v65, -v67
  ds_write2st64_b64 v125, v[114:115], v[74:75] offset0:37 offset1:45
  v_pk_mul_f32 v[80:81], v[36:37], v[28:29]
  v_pk_mul_f32 v[84:85], v[66:67], v[24:25]
  v_pk_mul_f32 v[82:83], v[36:37], v[26:27]
  v_pk_mul_f32 v[86:87], v[66:67], v[22:23]
  v_pk_fma_f32 v[36:37], v[34:35], v[28:29], v[82:83]
  v_pk_fma_f32 v[62:63], v[64:65], v[24:25], v[86:87]
  v_pk_fma_f32 v[34:35], v[34:35], v[26:27], v[80:81] neg_lo:[0,0,1] neg_hi:[0,0,1]
  v_pk_fma_f32 v[60:61], v[64:65], v[22:23], v[84:85] neg_lo:[0,0,1] neg_hi:[0,0,1]
  v_cvt_pk_bf16_f32 v70, v34, v36
  v_cvt_pk_bf16_f32 v71, v35, v37
  ds_write2st64_b64 v121, v[90:91], v[70:71] offset0:1 offset1:9
  v_cvt_pk_bf16_f32 v76, v60, -v62
  v_cvt_pk_bf16_f32 v77, v61, -v63
  ds_write_b64 v126, v[76:77] offset:19456
  v_pk_mul_f32 v[80:81], v[36:37], v[28:29]
  v_pk_mul_f32 v[84:85], v[50:51], v[32:33]
  v_pk_mul_f32 v[82:83], v[36:37], v[26:27]
  v_pk_mul_f32 v[86:87], v[50:51], v[30:31]
  v_pk_fma_f32 v[36:37], v[34:35], v[28:29], v[82:83]
  v_pk_fma_f32 v[50:51], v[48:49], v[32:33], v[86:87]
  v_pk_fma_f32 v[34:35], v[34:35], v[26:27], v[80:81] neg_lo:[0,0,1] neg_hi:[0,0,1]
  v_pk_fma_f32 v[48:49], v[48:49], v[30:31], v[84:85] neg_lo:[0,0,1] neg_hi:[0,0,1]
  v_cvt_pk_bf16_f32 v68, v34, v36
  v_cvt_pk_bf16_f32 v69, v35, v37
  ds_write2st64_b64 v122, v[92:93], v[68:69] offset0:2 offset1:10
  v_cvt_pk_bf16_f32 v74, v48, -v50
  v_cvt_pk_bf16_f32 v75, v49, -v51
  ds_write2st64_b64 v120, v[104:105], v[74:75] offset0:32 offset1:48
  v_pk_mul_f32 v[80:81], v[36:37], v[28:29]
  v_pk_mul_f32 v[84:85], v[54:55], v[32:33]
  v_pk_mul_f32 v[82:83], v[36:37], v[26:27]
  v_pk_mul_f32 v[86:87], v[54:55], v[30:31]
  v_pk_fma_f32 v[36:37], v[34:35], v[28:29], v[82:83]
  v_pk_fma_f32 v[54:55], v[52:53], v[32:33], v[86:87]
  v_pk_fma_f32 v[34:35], v[34:35], v[26:27], v[80:81] neg_lo:[0,0,1] neg_hi:[0,0,1]
  v_pk_fma_f32 v[52:53], v[52:53], v[30:31], v[84:85] neg_lo:[0,0,1] neg_hi:[0,0,1]
  v_cvt_pk_bf16_f32 v70, v34, v36
  v_cvt_pk_bf16_f32 v71, v35, v37
  ds_write2st64_b64 v123, v[94:95], v[70:71] offset0:3 offset1:11
  v_cvt_pk_bf16_f32 v72, v52, -v54
  v_cvt_pk_bf16_f32 v73, v53, -v55
  ds_write2st64_b64 v121, v[106:107], v[72:73] offset0:33 offset1:49
  v_pk_mul_f32 v[80:81], v[36:37], v[28:29]
  v_pk_mul_f32 v[84:85], v[58:59], v[32:33]
  v_pk_mul_f32 v[82:83], v[36:37], v[26:27]
  v_pk_mul_f32 v[86:87], v[58:59], v[30:31]
  v_pk_fma_f32 v[36:37], v[34:35], v[28:29], v[82:83]
  v_pk_fma_f32 v[58:59], v[56:57], v[32:33], v[86:87]
  v_pk_fma_f32 v[34:35], v[34:35], v[26:27], v[80:81] neg_lo:[0,0,1] neg_hi:[0,0,1]
  v_pk_fma_f32 v[56:57], v[56:57], v[30:31], v[84:85] neg_lo:[0,0,1] neg_hi:[0,0,1]
  v_cvt_pk_bf16_f32 v68, v34, v36
  v_cvt_pk_bf16_f32 v69, v35, v37
  ds_write2st64_b64 v124, v[96:97], v[68:69] offset0:4 offset1:12
  v_cvt_pk_bf16_f32 v74, v56, -v58
  v_cvt_pk_bf16_f32 v75, v57, -v59
  ds_write2st64_b64 v122, v[108:109], v[74:75] offset0:34 offset1:50
  v_pk_mul_f32 v[80:81], v[36:37], v[28:29]
  v_pk_mul_f32 v[84:85], v[62:63], v[32:33]
  v_pk_mul_f32 v[82:83], v[36:37], v[26:27]
  v_pk_mul_f32 v[86:87], v[62:63], v[30:31]
  v_pk_fma_f32 v[36:37], v[34:35], v[28:29], v[82:83]
  v_pk_fma_f32 v[62:63], v[60:61], v[32:33], v[86:87]
  v_pk_fma_f32 v[34:35], v[34:35], v[26:27], v[80:81] neg_lo:[0,0,1] neg_hi:[0,0,1]
  v_pk_fma_f32 v[60:61], v[60:61], v[30:31], v[84:85] neg_lo:[0,0,1] neg_hi:[0,0,1]
  v_cvt_pk_bf16_f32 v70, v34, v36
  v_cvt_pk_bf16_f32 v71, v35, v37
  ds_write2st64_b64 v125, v[98:99], v[70:71] offset0:5 offset1:13
  v_cvt_pk_bf16_f32 v72, v60, -v62
  v_cvt_pk_bf16_f32 v73, v61, -v63
  ds_write2st64_b64 v123, v[110:111], v[72:73] offset0:35 offset1:51
  v_pk_mul_f32 v[80:81], v[36:37], v[28:29]
  v_pk_mul_f32 v[82:83], v[36:37], v[26:27]
  v_pk_fma_f32 v[36:37], v[34:35], v[28:29], v[82:83]
  v_pk_fma_f32 v[34:35], v[34:35], v[26:27], v[80:81] neg_lo:[0,0,1] neg_hi:[0,0,1]
  v_cvt_pk_bf16_f32 v68, v34, v36
  v_cvt_pk_bf16_f32 v69, v35, v37
  ds_write2st64_b64 v126, v[100:101], v[68:69] offset0:6 offset1:14
  v_pk_mul_f32 v[80:81], v[36:37], v[28:29]
  v_pk_mul_f32 v[82:83], v[36:37], v[26:27]
  v_pk_fma_f32 v[36:37], v[34:35], v[28:29], v[82:83]
  v_pk_fma_f32 v[34:35], v[34:35], v[26:27], v[80:81] neg_lo:[0,0,1] neg_hi:[0,0,1]
  v_cvt_pk_bf16_f32 v70, v34, v36
  v_cvt_pk_bf16_f32 v71, v35, v37
  ds_write2st64_b64 v127, v[102:103], v[70:71] offset0:7 offset1:15
  s_waitcnt lgkmcnt(0)
  s_setpc_b64 s[100:101]
L_krowsB:
  v_mul_f32 v88, 0xbfb8aa3b, v80
  v_mul_f32 v90, 0x3e22f983, v84
  v_mul_f32 v89, 0xbfb8aa3b, v81
  v_mul_f32 v91, 0x3e22f983, v85
  v_mul_f32 v92, 0xc48a7fac, v80
  v_mul_f32 v94, 0x42f47645, v84
  v_mul_f32 v93, 0xc48a7fac, v81
  v_mul_f32 v95, 0x42f47645, v85
  v_mul_f32 v96, 0xc3b8aa3b, v80
  v_mul_f32 v98, 0x4222f983, v84
  v_mul_f32 v97, 0xc3b8aa3b, v81
  v_mul_f32 v99, 0x4222f983, v85
  v_exp_f32 v88, v88
  v_fract_f32 v90, v90
  v_exp_f32 v89, v89
  v_fract_f32 v91, v91
  v_exp_f32 v92, v92
  v_fract_f32 v94, v94
  v_exp_f32 v93, v93
  v_fract_f32 v95, v95
  v_exp_f32 v96, v96
  v_fract_f32 v98, v98
  v_exp_f32 v97, v97
  v_fract_f32 v99, v99
  v_cos_f32 v22, v90
  v_sin_f32 v24, v90
  v_cos_f32 v23, v91
  v_sin_f32 v25, v91
  v_cos_f32 v26, v94
  v_sin_f32 v28, v94
  v_cos_f32 v27, v95
  v_sin_f32 v29, v95
  v_cos_f32 v30, v98
  v_sin_f32 v32, v98
  v_cos_f32 v31, v99
  v_sin_f32 v33, v99
  v_pk_mul_f32 v[22:23], v[22:23], v[88:89]
  v_pk_mul_f32 v[24:25], v[24:25], v[88:89]
  v_pk_mul_f32 v[26:27], v[26:27], v[92:93]
  v_pk_mul_f32 v[28:29], v[28:29], v[92:93]
  v_pk_mul_f32 v[30:31], v[30:31], v[96:97]
  v_pk_mul_f32 v[32:33], v[32:33], v[96:97]
  .p2align 3
  v_cvt_pk_bf16_f32 v88, v40, -v42
  v_cvt_pk_bf16_f32 v89, v41, -v43
  v_pk_mul_f32 v[80:81], v[42:43], v[24:25]
  v_pk_mul_f32 v[82:83], v[42:43], v[22:23]
  v_pk_fma_f32 v[70:71], v[40:41], v[24:25], v[82:83]
  v_pk_fma_f32 v[68:69], v[40:41], v[22:23], v[80:81] neg_lo:[0,0,1] neg_hi:[0,0,1]
  v_cvt_pk_bf16_f32 v90, v68, -v70
  v_cvt_pk_bf16_f32 v91, v69, -v71
  v_pk_mul_f32 v[80:81], v[70:71], v[24:25]
  v_pk_mul_f32 v[82:83], v[70:71], v[22:23]
  v_pk_fma_f32 v[66:67], v[68:69], v[24:25], v[82:83]
  v_pk_fma_f32 v[64:65], v[68:69], v[22:23], v[80:81] neg_lo:[0,0,1] neg_hi:[0,0,1]
  v_cvt_pk_bf16_f32 v92, v64, -v66
  v_cvt_pk_bf16_f32 v93, v65, -v67
  v_pk_mul_f32 v[80:81], v[66:67], v[24:25]
  v_pk_mul_f32 v[82:83], v[66:67], v[22:23]
  v_pk_fma_f32 v[70:71], v[64:65], v[24:25], v[82:83]
  v_pk_fma_f32 v[68:69], v[64:65], v[22:23], v[80:81] neg_lo:[0,0,1] neg_hi:[0,0,1]
  v_cvt_pk_bf16_f32 v94, v68, -v70
  v_cvt_pk_bf16_f32 v95, v69, -v71
  v_pk_mul_f32 v[80:81], v[70:71], v[24:25]
  v_pk_mul_f32 v[82:83], v[70:71], v[22:23]
  v_pk_fma_f32 v[46:47], v[68:69], v[24:25], v[82:83]
  v_pk_fma_f32 v[44:45], v[68:69], v[22:23], v[80:81] neg_lo:[0,0,1] neg_hi:[0,0,1]
  v_cvt_pk_bf16_f32 v96, v44, -v46
  v_cvt_pk_bf16_f32 v97, v45, -v47
  v_pk_mul_f32 v[80:81], v[46:47], v[24:25]
  v_pk_mul_f32 v[82:83], v[46:47], v[22:23]
  v_pk_fma_f32 v[70:71], v[44:45], v[24:25], v[82:83]
  v_pk_fma_f32 v[68:69], v[44:45], v[22:23], v[80:81] neg_lo:[0,0,1] neg_hi:[0,0,1]
  v_cvt_pk_bf16_f32 v98, v68, -v70
  v_cvt_pk_bf16_f32 v99, v69, -v71
  v_pk_mul_f32 v[80:81], v[70:71], v[24:25]
  v_pk_mul_f32 v[84:85], v[46:47], v[28:29]
  v_pk_mul_f32 v[82:83], v[70:71], v[22:23]
  v_pk_mul_f32 v[86:87], v[46:47], v[26:27]
  v_pk_fma_f32 v[66:67], v[68:69], v[24:25], v[82:83]
  v_pk_fma_f32 v[46:47], v[44:45], v[28:29], v[86:87]
  v_pk_fma_f32 v[64:65], v[68:69], v[22:23], v[80:81] neg_lo:[0,0,1] neg_hi:[0,0,1]
  v_pk_fma_f32 v[44:45], v[44:45], v[26:27], v[84:85] neg_lo:[0,0,1] neg_hi:[0,0,1]
  v_cvt_pk_bf16_f32 v100, v64, -v66
  v_cvt_pk_bf16_f32 v101, v65, -v67
  v_cvt_pk_bf16_f32 v104, v44, -v46
  v_cvt_pk_bf16_f32 v105, v45, -v47
  v_pk_mul_f32 v[80:81], v[66:67], v[24:25]
  v_pk_mul_f32 v[82:83], v[66:67], v[22:23]
  v_pk_fma_f32 v[70:71], v[64:65], v[24:25], v[82:83]
  v_pk_fma_f32 v[68:69], v[64:65], v[22:23], v[80:81] neg_lo:[0,0,1] neg_hi:[0,0,1]
  v_cvt_pk_bf16_f32 v102, v68, -v70
  v_cvt_pk_bf16_f32 v103, v69, -v71
  v_pk_mul_f32 v[80:81], v[70:71], v[24:25]
  v_pk_mul_f32 v[82:83], v[70:71], v[22:23]
  v_pk_fma_f32 v[50:51], v[68:69], v[24:25], v[82:83]
  v_pk_fma_f32 v[48:49], v[68:69], v[22:23], v[80:81] neg_lo:[0,0,1] neg_hi:[0,0,1]
  v_cvt_pk_bf16_f32 v72, v48, -v50
  v_cvt_pk_bf16_f32 v73, v49, -v51
  ds_write2st64_b64 v120, v[88:89], v[72:73] offset0:16 offset1:24
  v_pk_mul_f32 v[80:81], v[50:51], v[24:25]
  v_pk_mul_f32 v[82:83], v[50:51], v[22:23]
  v_pk_fma_f32 v[70:71], v[48:49], v[24:25], v[82:83]
  v_pk_fma_f32 v[68:69], v[48:49], v[22:23], v[80:81] neg_lo:[0,0,1] neg_hi:[0,0,1]
  v_cvt_pk_bf16_f32 v74, v68, -v70
  v_cvt_pk_bf16_f32 v75, v69, -v71
  ds_write2st64_b64 v121, v[90:91], v[74:75] offset0:17 offset1:25
  v_pk_mul_f32 v[80:81], v[70:71], v[24:25]
  v_pk_mul_f32 v[84:85], v[50:51], v[28:29]
  v_pk_mul_f32 v[82:83], v[70:71], v[22:23]
  v_pk_mul_f32 v[86:87], v[50:51], v[26:27]
  v_pk_fma_f32 v[66:67], v[68:69], v[24:25], v[82:83]
  v_pk_fma_f32 v[50:51], v[48:49], v[28:29], v[86:87]
  v_pk_fma_f32 v[64:65], v[68:69], v[22:23], v[80:81] neg_lo:[0,0,1] neg_hi:[0,0,1]
  v_pk_fma_f32 v[48:49], v[48:49], v[26:27], v[84:85] neg_lo:[0,0,1] neg_hi:[0,0,1]
  v_cvt_pk_bf16_f32 v72, v64, -v66
  v_cvt_pk_bf16_f32 v73, v65, -v67
  ds_write2st64_b64 v122, v[92:93], v[72:73] offset0:18 offset1:26
  v_cvt_pk_bf16_f32 v106, v48, -v50
  v_cvt_pk_bf16_f32 v107, v49, -v51
  v_pk_mul_f32 v[80:81], v[66:67], v[24:25]
  v_pk_mul_f32 v[82:83], v[66:67], v[22:23]
  v_pk_fma_f32 v[70:71], v[64:65], v[24:25], v[82:83]
  v_pk_fma_f32 v[68:69], v[64:65], v[22:23], v[80:81] neg_lo:[0,0,1] neg_hi:[0,0,1]
  v_cvt_pk_bf16_f32 v74, v68, -v70
  v_cvt_pk_bf16_f32 v75, v69, -v71
  ds_write2st64_b64 v123, v[94:95], v[74:75] offset0:19 offset1:27
  v_pk_mul_f32 v[80:81], v[70:71], v[24:25]
  v_pk_mul_f32 v[82:83], v[70:71], v[22:23]
  v_pk_fma_f32 v[54:55], v[68:69], v[24:25], v[82:83]
  v_pk_fma_f32 v[52:53], v[68:69], v[22:23], v[80:81] neg_lo:[0,0,1] neg_hi:[0,0,1]
  v_cvt_pk_bf16_f32 v72, v52, -v54
  v_cvt_pk_bf16_f32 v73, v53, -v55
  ds_write2st64_b64 v124, v[96:97], v[72:73] offset0:20 offset1:28
  v_pk_mul_f32 v[80:81], v[54:55], v[24:25]
  v_pk_mul_f32 v[82:83], v[54:55], v[22:23]
  v_pk_fma_f32 v[70:71], v[52:53], v[24:25], v[82:83]
  v_pk_fma_f32 v[68:69], v[52:53], v[22:23], v[80:81] neg_lo:[0,0,1] neg_hi:[0,0,1]
  v_cvt_pk_bf16_f32 v74, v68, -v70
  v_cvt_pk_bf16_f32 v75, v69, -v71
  ds_write2st64_b64 v125, v[98:99], v[74:75] offset0:21 offset1:29
  v_pk_mul_f32 v[80:81], v[70:71], v[24:25]
  v_pk_mul_f32 v[84:85], v[54:55], v[28:29]
  v_pk_mul_f32 v[82:83], v[70:71], v[22:23]
  v_pk_mul_f32 v[86:87], v[54:55], v[26:27]
  v_pk_fma_f32 v[66:67], v[68:69], v[24:25], v[82:83]
  v_pk_fma_f32 v[54:55], v[52:53], v[28:29], v[86:87]
  v_pk_fma_f32 v[64:65], v[68:69], v[22:23], v[80:81] neg_lo:[0,0,1] neg_hi:[0,0,1]
  v_pk_fma_f32 v[52:53], v[52:53], v[26:27], v[84:85] neg_lo:[0,0,1] neg_hi:[0,0,1]
  v_cvt_pk_bf16_f32 v72, v64, -v66
  v_cvt_pk_bf16_f32 v73, v65, -v67
  ds_write2st64_b64 v126, v[100:101], v[72:73] offset0:22 offset1:30
  v_cvt_pk_bf16_f32 v108, v52, -v54
  v_cvt_pk_bf16_f32 v109, v53, -v55
  v_pk_mul_f32 v[80:81], v[66:67], v[24:25]
  v_pk_mul_f32 v[82:83], v[66:67], v[22:23]
  v_pk_fma_f32 v[70:71], v[64:65], v[24:25], v[82:83]
  v_pk_fma_f32 v[68:69], v[64:65], v[22:23], v[80:81] neg_lo:[0,0,1] neg_hi:[0,0,1]
  v_cvt_pk_bf16_f32 v74, v68, -v70
  v_cvt_pk_bf16_f32 v75, v69, -v71
  ds_write2st64_b64 v127, v[102:103], v[74:75] offset0:23 offset1:31
  v_pk_mul_f32 v[80:81], v[70:71], v[24:25]
  v_pk_mul_f32 v[82:83], v[70:71], v[22:23]
  v_pk_fma_f32 v[58:59], v[68:69], v[24:25], v[82:83]
  v_pk_fma_f32 v[56:57], v[68:69], v[22:23], v[80:81] neg_lo:[0,0,1] neg_hi:[0,0,1]
  v_pk_mul_f32 v[80:81], v[58:59], v[28:29]
  v_pk_mul_f32 v[84:85], v[50:51], v[32:33]
  v_pk_mul_f32 v[82:83], v[58:59], v[26:27]
  v_pk_mul_f32 v[86:87], v[50:51], v[30:31]
  v_pk_fma_f32 v[58:59], v[56:57], v[28:29], v[82:83]
  v_pk_fma_f32 v[50:51], v[48:49], v[32:33], v[86:87]
  v_pk_fma_f32 v[56:57], v[56:57], v[26:27], v[80:81] neg_lo:[0,0,1] neg_hi:[0,0,1]
  v_pk_fma_f32 v[48:49], v[48:49], v[30:31], v[84:85] neg_lo:[0,0,1] neg_hi:[0,0,1]
  v_cvt_pk_bf16_f32 v110, v56, -v58
  v_cvt_pk_bf16_f32 v111, v57, -v59
  v_cvt_pk_bf16_f32 v72, v48, -v50
  v_cvt_pk_bf16_f32 v73, v49, -v51
  ds_write_b64 v120, v[72:73] offset:28672
  v_pk_mul_f32 v[80:81], v[58:59], v[32:33]
  v_pk_mul_f32 v[84:85], v[50:51], v[32:33]
  v_pk_mul_f32 v[82:83], v[58:59], v[30:31]
  v_pk_mul_f32 v[86:87], v[50:51], v[30:31]
  v_pk_fma_f32 v[58:59], v[56:57], v[32:33], v[82:83]
  v_pk_fma_f32 v[50:51], v[48:49], v[32:33], v[86:87]
  v_pk_fma_f32 v[56:57], v[56:57], v[30:31], v[80:81] neg_lo:[0,0,1] neg_hi:[0,0,1]
  v_pk_fma_f32 v[48:49], v[48:49], v[30:31], v[84:85] neg_lo:[0,0,1] neg_hi:[0,0,1]
  v_cvt_pk_bf16_f32 v74, v56, -v58
  v_cvt_pk_bf16_f32 v75, v57, -v59
  ds_write_b64 v121, v[74:75] offset:29184
  v_cvt_pk_bf16_f32 v76, v48, -v50
  v_cvt_pk_bf16_f32 v77, v49, -v51
  ds_write_b64 v122, v[76:77] offset:29696
  v_pk_mul_f32 v[80:81], v[58:59], v[32:33]
  v_pk_mul_f32 v[84:85], v[50:51], v[32:33]
  v_pk_mul_f32 v[82:83], v[58:59], v[30:31]
  v_pk_mul_f32 v[86:87], v[50:51], v[30:31]
  v_pk_fma_f32 v[58:59], v[56:57], v[32:33], v[82:83]
  v_pk_fma_f32 v[50:51], v[48:49], v[32:33], v[86:87]
  v_pk_fma_f32 v[56:57], v[56:57], v[30:31], v[80:81] neg_lo:[0,0,1] neg_hi:[0,0,1]
  v_pk_fma_f32 v[48:49], v[48:49], v[30:31], v[84:85] neg_lo:[0,0,1] neg_hi:[0,0,1]
  v_cvt_pk_bf16_f32 v78, v56, -v58
  v_cvt_pk_bf16_f32 v79, v57, -v59
  ds_write_b64 v123, v[78:79] offset:30208
  v_cvt_pk_bf16_f32 v72, v48, -v50
  v_cvt_pk_bf16_f32 v73, v49, -v51
  ds_write2st64_b64 v124, v[104:105], v[72:73] offset0:52 offset1:60
  v_pk_mul_f32 v[80:81], v[58:59], v[32:33]
  v_pk_mul_f32 v[84:85], v[50:51], v[32:33]
  v_pk_mul_f32 v[82:83], v[58:59], v[30:31]
  v_pk_mul_f32 v[86:87], v[50:51], v[30:31]
  v_pk_fma_f32 v[58:59], v[56:57], v[32:33], v[82:83]
  v_pk_fma_f32 v[50:51], v[48:49], v[32:33], v[86:87]
  v_pk_fma_f32 v[56:57], v[56:57], v[30:31], v[80:81] neg_lo:[0,0,1] neg_hi:[0,0,1]
  v_pk_fma_f32 v[48:49], v[48:49], v[30:31], v[84:85] neg_lo:[0,0,1] neg_hi:[0,0,1]
  v_cvt_pk_bf16_f32 v74, v56, -v58
  v_cvt_pk_bf16_f32 v75, v57, -v59
  ds_write2st64_b64 v125, v[106:107], v[74:75] offset0:53 offset1:61
  v_cvt_pk_bf16_f32 v76, v48, -v50
  v_cvt_pk_bf16_f32 v77, v49, -v51
  ds_write2st64_b64 v126, v[108:109], v[76:77] offset0:54 offset1:62
  v_pk_mul_f32 v[80:81], v[58:59], v[32:33]
  v_pk_mul_f32 v[82:83], v[58:59], v[30:31]
  v_pk_fma_f32 v[58:59], v[56:57], v[32:33], v[82:83]
  v_pk_fma_f32 v[56:57], v[56:57], v[30:31], v[80:81] neg_lo:[0,0,1] neg_hi:[0,0,1]
  v_cvt_pk_bf16_f32 v78, v56, -v58
  v_cvt_pk_bf16_f32 v79, v57, -v59
  ds_write2st64_b64 v127, v[110:111], v[78:79] offset0:55 offset1:63
  s_waitcnt lgkmcnt(0)
  s_setpc_b64 s[100:101]
L_cw:
  s_lshl_b32 s45, s45, 16
  s_add_u32 s45, s45, 65536
  s_mov_b32 s47, s26
  v_lshl_add_u32 v120, v1, 3, s45
  v_xor_b32 v121, 32, v120
  v_xor_b32 v122, 64, v120
  v_xor_b32 v123, 96, v120
  v_xor_b32 v124, 128, v120
  v_xor_b32 v125, 160, v120
  v_xor_b32 v126, 192, v120
  v_xor_b32 v127, 224, v120
  v_and_b32 v11, 15, v1
  v_lshrrev_b32 v12, 4, v1
  v_lshrrev_b32 v32, 1, v11
  v_xor_b32 v32, v32, v12
  v_lshlrev_b32 v32, 4, v32
  v_lshl_add_u32 v32, v11, 7, v32
  s_lshr_b32 s27, s26, 1
  s_lshl_b32 s27, s27, 14
  v_add_u32 v2, s27, v32
  v_xor_b32 v3, 64, v2
  s_and_b32 s28, s26, 1
  s_lshl_b32 s28, s28, 1
  v_lshrrev_b32 v32, 2, v1
  v_and_b32 v32, 3, v32
  v_lshrrev_b32 v33, 4, v1
  v_lshl_add_u32 v6, v33, 3, v32
  v_lshlrev_b32 v6, 7, v6
  v_lshrrev_b32 v32, 1, v32
  v_and_b32 v33, 1, v33
  v_lshl_add_u32 v32, v33, 1, v32
  v_xor_b32 v32, s28, v32
  v_lshl_add_u32 v6, v32, 5, v6
  v_and_b32 v32, 3, v1
  v_lshl_add_u32 v6, v32, 3, v6
  v_add_u32 v6, 98304, v6
  v_xor_b32 v7, 32, v6
  v_mov_b32 v4, v2
  v_mov_b32 v5, v3
  v_mov_b32 v8, v6
  v_mov_b32 v9, v7
  s_mov_b32 s30, 0
  s_mov_b32 s31, 10
  s_lshr_b32 s91, s2, 3
  s_sub_u32 s92, s91, 2
  s_cmp_ge_u32 s91, 27
  s_cselect_b32 s91, s92, s91
  s_mul_i32 s92, s91, 26
  s_lshr_b32 s92, s92, 8
  s_mul_i32 s93, s92, 10
  s_sub_u32 s91, s91, s93
  s_and_b32 s90, s2, 7
  s_mul_i32 s90, s90, 3
  s_add_u32 s90, s90, s92
  s_mul_i32 s90, s90, 5
  s_mul_i32 s93, s91, 5
  s_add_u32 s92, s92, s93
  s_sub_u32 s93, s92, 54
  s_cmp_ge_u32 s92, 54
  s_cselect_b32 s92, s93, s92
  s_mul_i32 s93, s90, 55296
  s_add_u32 s93, s93, 1048576
  s_lshl_b32 s94, s91, 7
  s_add_u32 s96, s92, s26
  s_sub_u32 s97, s96, 54
  s_cmp_ge_u32 s96, 54
  s_cselect_b32 s96, s97, s96
  s_lshl_b32 s95, s26, 15
  v_mov_b64 v[128:129], 0
  v_mov_b64 v[130:131], 0
  v_mov_b64 v[132:133], 0
  v_mov_b64 v[134:135], 0
  v_mov_b64 v[136:137], 0
  v_mov_b64 v[138:139], 0
  v_mov_b64 v[140:141], 0
  v_mov_b64 v[142:143], 0
  v_mov_b64 v[144:145], 0
  v_mov_b64 v[146:147], 0
  v_mov_b64 v[148:149], 0
  v_mov_b64 v[150:151], 0
  v_mov_b64 v[152:153], 0
  v_mov_b64 v[154:155], 0
  v_mov_b64 v[156:157], 0
  v_mov_b64 v[158:159], 0
  v_mov_b64 v[160:161], 0
  v_mov_b64 v[162:163], 0
  v_mov_b64 v[164:165], 0
  v_mov_b64 v[166:167], 0
  v_mov_b64 v[168:169], 0
  v_mov_b64 v[170:171], 0
  v_mov_b64 v[172:173], 0
  v_mov_b64 v[174:175], 0
  v_mov_b64 v[176:177], 0
  v_mov_b64 v[178:179], 0
  v_mov_b64 v[180:181], 0
  v_mov_b64 v[182:183], 0
  v_mov_b64 v[184:185], 0
  v_mov_b64 v[186:187], 0
  v_mov_b64 v[188:189], 0
  v_mov_b64 v[190:191], 0
  v_mov_b64 v[192:193], 0
  v_mov_b64 v[194:195], 0
  v_mov_b64 v[196:197], 0
  v_mov_b64 v[198:199], 0
  v_mov_b64 v[200:201], 0
  v_mov_b64 v[202:203], 0
  v_mov_b64 v[204:205], 0
  v_mov_b64 v[206:207], 0
  v_mov_b64 v[208:209], 0
  v_mov_b64 v[210:211], 0
  v_mov_b64 v[212:213], 0
  v_mov_b64 v[214:215], 0
  v_mov_b64 v[216:217], 0
  v_mov_b64 v[218:219], 0
  v_mov_b64 v[220:221], 0
  v_mov_b64 v[222:223], 0
  v_mov_b64 v[224:225], 0
  v_mov_b64 v[226:227], 0
  v_mov_b64 v[228:229], 0
  v_mov_b64 v[230:231], 0
  v_mov_b64 v[232:233], 0
  v_mov_b64 v[234:235], 0
  v_mov_b64 v[236:237], 0
  v_mov_b64 v[238:239], 0
  v_mov_b64 v[240:241], 0
  v_mov_b64 v[242:243], 0
  v_mov_b64 v[244:245], 0
  v_mov_b64 v[246:247], 0
  v_mov_b64 v[248:249], 0
  v_mov_b64 v[250:251], 0
  v_mov_b64 v[252:253], 0
  v_mov_b64 v[254:255], 0
  s_waitcnt vmcnt(0)
  s_call_b64 s[100:101], L_krows
  s_barrier
  ds_read_b64_tr_b16 v[32:33], v8 offset:0
  ds_read_b64_tr_b16 v[34:35], v8 offset:512
  ds_read_b128 v[48:51], v4 offset:0
  ds_read_b64_tr_b16 v[36:37], v9 offset:0
  ds_read_b64_tr_b16 v[38:39], v9 offset:512
  ds_read_b64_tr_b16 v[40:41], v8 offset:8192
  ds_read_b64_tr_b16 v[42:43], v8 offset:8704
  ds_read_b64_tr_b16 v[44:45], v9 offset:8192
  ds_read_b64_tr_b16 v[46:47], v9 offset:8704
  ds_read_b128 v[52:55], v4 offset:2048
  ds_read_b128 v[56:59], v4 offset:4096
  ds_read_b128 v[60:63], v4 offset:6144
  ds_read_b128 v[64:67], v4 offset:8192
  ds_read_b128 v[68:71], v4 offset:10240
  ds_read_b128 v[72:75], v4 offset:12288
  ds_read_b128 v[76:79], v4 offset:14336
  s_mul_i32 s3, s3, 0x9E3779B1
  s_add_u32 s3, s3, 0x7F4A7C15
  s_lshr_b32 s27, s26, 1
  s_lshl_b32 s27, s27, 11
  s_add_u32 s27, s27, 147456
  v_lshl_add_u32 v13, v11, 4, s27
  s_and_b32 s28, s26, 1
  s_lshl_b32 s28, s28, 7
  s_add_u32 s28, s28, 157824
  v_lshl_add_u32 v14, v12, 4, s28
  s_lshl_b32 s27, s24, 1
  s_lshr_b32 s28, s26, 1
  s_add_u32 s27, s27, s28
  s_mul_i32 s27, s27, 3456
  s_lshl_b32 s28, s25, 4
  s_add_u32 s27, s27, s28
  s_and_b32 s28, s26, 1
  s_lshl_b32 s28, s28, 3
  s_add_u32 s27, s27, s28
  s_lshl_b32 s27, s27, 7
  s_add_u32 s27, s27, 1048576
  s_setprio 2
  s_barrier
  .p2align 6
L_cloop:
  s_waitcnt lgkmcnt(0)
  v_mfma_f32_16x16x32_bf16 v[128:131], v[32:35], v[48:51], v[128:131]
  v_mfma_f32_16x16x32_bf16 v[144:147], v[32:35], v[52:55], v[144:147]
  ds_read_b64_tr_b16 v[80:81], v8 offset:4096
  v_mfma_f32_16x16x32_bf16 v[160:163], v[32:35], v[56:59], v[160:163]
  ds_read_b64_tr_b16 v[82:83], v8 offset:4608
  v_mfma_f32_16x16x32_bf16 v[176:179], v[32:35], v[60:63], v[176:179]
  v_mfma_f32_16x16x32_bf16 v[192:195], v[32:35], v[64:67], v[192:195]
  ds_read_b128 v[96:99], v5 offset:0
  v_mfma_f32_16x16x32_bf16 v[208:211], v[32:35], v[68:71], v[208:211]
  ds_read_b64_tr_b16 v[84:85], v9 offset:4096
  v_mfma_f32_16x16x32_bf16 v[224:227], v[32:35], v[72:75], v[224:227]
  v_mfma_f32_16x16x32_bf16 v[240:243], v[32:35], v[76:79], v[240:243]
  ds_read_b64_tr_b16 v[86:87], v9 offset:4608
  v_mfma_f32_16x16x32_bf16 v[244:247], v[36:39], v[76:79], v[244:247]
  ds_read_b64_tr_b16 v[88:89], v8 offset:12288
  v_mfma_f32_16x16x32_bf16 v[228:231], v[36:39], v[72:75], v[228:231]
  v_mfma_f32_16x16x32_bf16 v[212:215], v[36:39], v[68:71], v[212:215]
  ds_read_b64_tr_b16 v[90:91], v8 offset:12800
  v_mfma_f32_16x16x32_bf16 v[196:199], v[36:39], v[64:67], v[196:199]
  ds_read_b64_tr_b16 v[92:93], v9 offset:12288
  v_mfma_f32_16x16x32_bf16 v[180:183], v[36:39], v[60:63], v[180:183]
  v_mfma_f32_16x16x32_bf16 v[164:167], v[36:39], v[56:59], v[164:167]
  ds_read_b64_tr_b16 v[94:95], v9 offset:12800
  v_mfma_f32_16x16x32_bf16 v[148:151], v[36:39], v[52:55], v[148:151]
  ds_read_b128 v[100:103], v5 offset:2048
  v_mfma_f32_16x16x32_bf16 v[132:135], v[36:39], v[48:51], v[132:135]
  v_mfma_f32_16x16x32_bf16 v[136:139], v[40:43], v[48:51], v[136:139]
  ds_read_b128 v[104:107], v5 offset:4096
  v_mfma_f32_16x16x32_bf16 v[152:155], v[40:43], v[52:55], v[152:155]
  ds_read_b128 v[108:111], v5 offset:6144
  v_mfma_f32_16x16x32_bf16 v[168:171], v[40:43], v[56:59], v[168:171]
  s_add_u32 s30, s30, 16384
  v_mfma_f32_16x16x32_bf16 v[184:187], v[40:43], v[60:63], v[184:187]
  ds_read_b128 v[112:115], v5 offset:8192
  s_cmp_eq_u32 s30, 49152
  v_mfma_f32_16x16x32_bf16 v[200:203], v[40:43], v[64:67], v[200:203]
  ds_read_b128 v[116:119], v5 offset:10240
  s_cselect_b32 s30, 0, s30
  v_mfma_f32_16x16x32_bf16 v[216:219], v[40:43], v[68:71], v[216:219]
  s_lshl_b32 s32, s30, 1
  v_mfma_f32_16x16x32_bf16 v[232:235], v[40:43], v[72:75], v[232:235]
  ds_read_b128 v[120:123], v5 offset:12288
  v_mfma_f32_16x16x32_bf16 v[248:251], v[40:43], v[76:79], v[248:251]
  ds_read_b128 v[124:127], v5 offset:14336
  v_mfma_f32_16x16x32_bf16 v[252:255], v[44:47], v[76:79], v[252:255]
  s_sub_u32 s31, s31, 1
  v_mfma_f32_16x16x32_bf16 v[236:239], v[44:47], v[72:75], v[236:239]
  s_cmp_eq_u32 s31, 0
  v_mfma_f32_16x16x32_bf16 v[220:223], v[44:47], v[68:71], v[220:223]
  v_add_u32 v8, s30, v6
  v_mfma_f32_16x16x32_bf16 v[204:207], v[44:47], v[64:67], v[204:207]
  v_add_u32 v9, s30, v7
  v_mfma_f32_16x16x32_bf16 v[188:191], v[44:47], v[60:63], v[188:191]
  v_add_u32 v4, s32, v2
  v_mfma_f32_16x16x32_bf16 v[172:175], v[44:47], v[56:59], v[172:175]
  v_add_u32 v5, s32, v3
  v_mfma_f32_16x16x32_bf16 v[156:159], v[44:47], v[52:55], v[156:159]
  v_mfma_f32_16x16x32_bf16 v[140:143], v[44:47], v[48:51], v[140:143]
  s_cbranch_scc1 L_ctail
  s_waitcnt lgkmcnt(0)
  v_mfma_f32_16x16x32_bf16 v[128:131], v[80:83], v[96:99], v[128:131]
  v_mfma_f32_16x16x32_bf16 v[144:147], v[80:83], v[100:103], v[144:147]
  s_barrier
  ds_read_b64_tr_b16 v[32:33], v8 offset:0
  v_mfma_f32_16x16x32_bf16 v[160:163], v[80:83], v[104:107], v[160:163]
  ds_read_b64_tr_b16 v[34:35], v8 offset:512
  v_mfma_f32_16x16x32_bf16 v[176:179], v[80:83], v[108:111], v[176:179]
  v_mfma_f32_16x16x32_bf16 v[192:195], v[80:83], v[112:115], v[192:195]
  ds_read_b128 v[48:51], v4 offset:0
  v_mfma_f32_16x16x32_bf16 v[208:211], v[80:83], v[116:119], v[208:211]
  ds_read_b64_tr_b16 v[36:37], v9 offset:0
  v_mfma_f32_16x16x32_bf16 v[224:227], v[80:83], v[120:123], v[224:227]
  v_mfma_f32_16x16x32_bf16 v[240:243], v[80:83], v[124:127], v[240:243]
  ds_read_b64_tr_b16 v[38:39], v9 offset:512
  v_mfma_f32_16x16x32_bf16 v[244:247], v[84:87], v[124:127], v[244:247]
  ds_read_b64_tr_b16 v[40:41], v8 offset:8192
  v_mfma_f32_16x16x32_bf16 v[228:231], v[84:87], v[120:123], v[228:231]
  v_mfma_f32_16x16x32_bf16 v[212:215], v[84:87], v[116:119], v[212:215]
  ds_read_b64_tr_b16 v[42:43], v8 offset:8704
  v_mfma_f32_16x16x32_bf16 v[196:199], v[84:87], v[112:115], v[196:199]
  ds_read_b64_tr_b16 v[44:45], v9 offset:8192
  v_mfma_f32_16x16x32_bf16 v[180:183], v[84:87], v[108:111], v[180:183]
  v_mfma_f32_16x16x32_bf16 v[164:167], v[84:87], v[104:107], v[164:167]
  ds_read_b64_tr_b16 v[46:47], v9 offset:8704
  v_mfma_f32_16x16x32_bf16 v[148:151], v[84:87], v[100:103], v[148:151]
  ds_read_b128 v[52:55], v4 offset:2048
  v_mfma_f32_16x16x32_bf16 v[132:135], v[84:87], v[96:99], v[132:135]
  v_mfma_f32_16x16x32_bf16 v[136:139], v[88:91], v[96:99], v[136:139]
  ds_read_b128 v[56:59], v4 offset:4096
  v_mfma_f32_16x16x32_bf16 v[152:155], v[88:91], v[100:103], v[152:155]
  ds_read_b128 v[60:63], v4 offset:6144
  v_mfma_f32_16x16x32_bf16 v[168:171], v[88:91], v[104:107], v[168:171]
  v_mfma_f32_16x16x32_bf16 v[184:187], v[88:91], v[108:111], v[184:187]
  ds_read_b128 v[64:67], v4 offset:8192
  v_mfma_f32_16x16x32_bf16 v[200:203], v[88:91], v[112:115], v[200:203]
  ds_read_b128 v[68:71], v4 offset:10240
  v_mfma_f32_16x16x32_bf16 v[216:219], v[88:91], v[116:119], v[216:219]
  v_mfma_f32_16x16x32_bf16 v[232:235], v[88:91], v[120:123], v[232:235]
  ds_read_b128 v[72:75], v4 offset:12288
  v_mfma_f32_16x16x32_bf16 v[248:251], v[88:91], v[124:127], v[248:251]
  ds_read_b128 v[76:79], v4 offset:14336
  v_mfma_f32_16x16x32_bf16 v[252:255], v[92:95], v[124:127], v[252:255]
  v_mfma_f32_16x16x32_bf16 v[236:239], v[92:95], v[120:123], v[236:239]
  v_mfma_f32_16x16x32_bf16 v[220:223], v[92:95], v[116:119], v[220:223]
  v_mfma_f32_16x16x32_bf16 v[204:207], v[92:95], v[112:115], v[204:207]
  v_mfma_f32_16x16x32_bf16 v[188:191], v[92:95], v[108:111], v[188:191]
  v_mfma_f32_16x16x32_bf16 v[172:175], v[92:95], v[104:107], v[172:175]
  v_mfma_f32_16x16x32_bf16 v[156:159], v[92:95], v[100:103], v[156:159]
  v_mfma_f32_16x16x32_bf16 v[140:143], v[92:95], v[96:99], v[140:143]
  s_branch L_cloop
L_ctail:
  s_waitcnt lgkmcnt(0)
  v_mfma_f32_16x16x32_bf16 v[128:131], v[80:83], v[96:99], v[128:131]
  ds_read_b128 v[16:19], v14 offset:0
  v_mfma_f32_16x16x32_bf16 v[132:135], v[84:87], v[96:99], v[132:135]
  ds_read_b128 v[20:23], v14 offset:64
  v_mfma_f32_16x16x32_bf16 v[136:139], v[88:91], v[96:99], v[136:139]
  ds_read_b128 v[24:27], v14 offset:256
  v_mfma_f32_16x16x32_bf16 v[140:143], v[92:95], v[96:99], v[140:143]
  ds_read_b128 v[28:31], v14 offset:320
  v_mfma_f32_16x16x32_bf16 v[144:147], v[80:83], v[100:103], v[144:147]
  ds_read_b128 v[32:35], v14 offset:512
  v_mfma_f32_16x16x32_bf16 v[148:151], v[84:87], v[100:103], v[148:151]
  ds_read_b128 v[36:39], v14 offset:576
  v_mfma_f32_16x16x32_bf16 v[152:155], v[88:91], v[100:103], v[152:155]
  ds_read_b128 v[40:43], v14 offset:768
  v_mfma_f32_16x16x32_bf16 v[156:159], v[92:95], v[100:103], v[156:159]
  ds_read_b128 v[44:47], v14 offset:832
  v_mfma_f32_16x16x32_bf16 v[160:163], v[80:83], v[104:107], v[160:163]
  ds_read_b128 v[48:51], v14 offset:1024
  v_mfma_f32_16x16x32_bf16 v[164:167], v[84:87], v[104:107], v[164:167]
  ds_read_b128 v[52:55], v14 offset:1088
  v_mfma_f32_16x16x32_bf16 v[168:171], v[88:91], v[104:107], v[168:171]
  ds_read_b128 v[56:59], v14 offset:1280
  v_mfma_f32_16x16x32_bf16 v[172:175], v[92:95], v[104:107], v[172:175]
  ds_read_b128 v[60:63], v14 offset:1344
  v_mfma_f32_16x16x32_bf16 v[176:179], v[80:83], v[108:111], v[176:179]
  ds_read_b128 v[64:67], v14 offset:1536
  v_mfma_f32_16x16x32_bf16 v[180:183], v[84:87], v[108:111], v[180:183]
  ds_read_b128 v[68:71], v14 offset:1600
  v_mfma_f32_16x16x32_bf16 v[184:187], v[88:91], v[108:111], v[184:187]
  ds_read_b128 v[72:75], v14 offset:1792
  v_mfma_f32_16x16x32_bf16 v[188:191], v[92:95], v[108:111], v[188:191]
  ds_read_b128 v[76:79], v14 offset:1856
  v_mfma_f32_16x16x32_bf16 v[192:195], v[80:83], v[112:115], v[192:195]
  s_waitcnt lgkmcnt(8)
  v_add_f32 v16, v16, v32
  ds_read_b128 v[108:111], v13 offset:768
  s_barrier
  v_mfma_f32_16x16x32_bf16 v[196:199], v[84:87], v[112:115], v[196:199]
  v_add_f32 v17, v17, v33
  ds_read_b128 v[96:99], v13 offset:0
  v_mfma_f32_16x16x32_bf16 v[200:203], v[88:91], v[112:115], v[200:203]
  v_add_f32 v18, v18, v34
  ds_read_b128 v[100:103], v13 offset:256
  v_mfma_f32_16x16x32_bf16 v[204:207], v[92:95], v[112:115], v[204:207]
  v_add_f32 v19, v19, v35
  ds_read_b128 v[104:107], v13 offset:512
  v_mfma_f32_16x16x32_bf16 v[208:211], v[80:83], v[116:119], v[208:211]
  v_add_f32 v20, v20, v36
  ds_read_b128 v[112:115], v13 offset:1024
  v_mfma_f32_16x16x32_bf16 v[212:215], v[84:87], v[116:119], v[212:215]
  v_add_f32 v21, v21, v37
  v_mfma_f32_16x16x32_bf16 v[216:219], v[88:91], v[116:119], v[216:219]
  v_add_f32 v22, v22, v38
  v_mfma_f32_16x16x32_bf16 v[220:223], v[92:95], v[116:119], v[220:223]
  v_add_f32 v23, v23, v39
  v_mfma_f32_16x16x32_bf16 v[224:227], v[80:83], v[120:123], v[224:227]
  v_add_f32 v24, v24, v40
  ds_read_b128 v[116:119], v13 offset:1280
  v_mfma_f32_16x16x32_bf16 v[228:231], v[84:87], v[120:123], v[228:231]
  v_add_f32 v25, v25, v41
  v_mfma_f32_16x16x32_bf16 v[232:235], v[88:91], v[120:123], v[232:235]
  v_add_f32 v26, v26, v42
  v_mfma_f32_16x16x32_bf16 v[236:239], v[92:95], v[120:123], v[236:239]
  v_add_f32 v27, v27, v43
  v_mfma_f32_16x16x32_bf16 v[240:243], v[80:83], v[124:127], v[240:243]
  v_add_f32 v28, v28, v44
  ds_read_b128 v[120:123], v13 offset:1536
  v_mfma_f32_16x16x32_bf16 v[244:247], v[84:87], v[124:127], v[244:247]
  v_add_f32 v29, v29, v45
  v_mfma_f32_16x16x32_bf16 v[248:251], v[88:91], v[124:127], v[248:251]
  v_add_f32 v30, v30, v46
  v_mfma_f32_16x16x32_bf16 v[252:255], v[92:95], v[124:127], v[252:255]
  v_add_f32 v31, v31, v47
  ds_read_b128 v[124:127], v13 offset:1792
  v_lshlrev_b32 v2, 4, v1
  s_waitcnt vmcnt(0) lgkmcnt(4)
  v_pk_add_f32 v[48:49], v[48:49], v[64:65]
  v_pk_add_f32 v[50:51], v[50:51], v[66:67]
  v_pk_add_f32 v[52:53], v[52:53], v[68:69]
  v_pk_add_f32 v[54:55], v[54:55], v[70:71]
  v_pk_add_f32 v[56:57], v[56:57], v[72:73]
  v_pk_add_f32 v[58:59], v[58:59], v[74:75]
  v_pk_add_f32 v[60:61], v[60:61], v[76:77]
  v_pk_add_f32 v[62:63], v[62:63], v[78:79]
  v_pk_add_f32 v[16:17], v[16:17], v[48:49]
  v_pk_add_f32 v[18:19], v[18:19], v[50:51]
  v_pk_add_f32 v[20:21], v[20:21], v[52:53]
  v_pk_add_f32 v[22:23], v[22:23], v[54:55]
  v_pk_add_f32 v[24:25], v[24:25], v[56:57]
  v_pk_add_f32 v[26:27], v[26:27], v[58:59]
  v_pk_add_f32 v[28:29], v[28:29], v[60:61]
  v_pk_add_f32 v[30:31], v[30:31], v[62:63]
  v_pk_fma_f32 v[128:129], v[16:17], v[96:97], v[128:129] op_sel:[0,0,0] op_sel_hi:[1,0,1]
  v_pk_fma_f32 v[130:131], v[18:19], v[96:97], v[130:131] op_sel:[0,0,0] op_sel_hi:[1,0,1]
  v_pk_fma_f32 v[132:133], v[20:21], v[96:97], v[132:133] op_sel:[0,0,0] op_sel_hi:[1,0,1]
  v_pk_fma_f32 v[134:135], v[22:23], v[96:97], v[134:135] op_sel:[0,0,0] op_sel_hi:[1,0,1]
  v_pk_mul_f32 v[64:65], v[128:129], v[96:97] op_sel:[0,1] op_sel_hi:[1,1]
  v_pk_mul_f32 v[66:67], v[130:131], v[96:97] op_sel:[0,1] op_sel_hi:[1,1]
  v_pk_mul_f32 v[68:69], v[132:133], v[96:97] op_sel:[0,1] op_sel_hi:[1,1]
  v_pk_mul_f32 v[70:71], v[134:135], v[96:97] op_sel:[0,1] op_sel_hi:[1,1]
  v_exp_f32 v64, v64
  v_pk_fma_f32 v[136:137], v[24:25], v[96:97], v[136:137] op_sel:[0,0,0] op_sel_hi:[1,0,1]
  v_exp_f32 v65, v65
  v_exp_f32 v66, v66
  v_pk_fma_f32 v[138:139], v[26:27], v[96:97], v[138:139] op_sel:[0,0,0] op_sel_hi:[1,0,1]
  v_exp_f32 v67, v67
  v_exp_f32 v68, v68
  v_pk_fma_f32 v[140:141], v[28:29], v[96:97], v[140:141] op_sel:[0,0,0] op_sel_hi:[1,0,1]
  v_exp_f32 v69, v69
  v_exp_f32 v70, v70
  v_pk_fma_f32 v[142:143], v[30:31], v[96:97], v[142:143] op_sel:[0,0,0] op_sel_hi:[1,0,1]
  v_exp_f32 v71, v71
  v_pk_fma_f32 v[64:65], v[64:65], v[98:99], v[98:99] op_sel:[0,0,0] op_sel_hi:[1,0,0]
  v_pk_fma_f32 v[66:67], v[66:67], v[98:99], v[98:99] op_sel:[0,0,0] op_sel_hi:[1,0,0]
  v_pk_fma_f32 v[68:69], v[68:69], v[98:99], v[98:99] op_sel:[0,0,0] op_sel_hi:[1,0,0]
  v_pk_fma_f32 v[70:71], v[70:71], v[98:99], v[98:99] op_sel:[0,0,0] op_sel_hi:[1,0,0]
  v_rcp_f32 v64, v64
  v_pk_mul_f32 v[128:129], v[128:129], v[136:137]
  v_rcp_f32 v65, v65
  v_rcp_f32 v66, v66
  v_pk_mul_f32 v[130:131], v[130:131], v[138:139]
  v_rcp_f32 v67, v67
  v_rcp_f32 v68, v68
  v_pk_mul_f32 v[132:133], v[132:133], v[140:141]
  v_rcp_f32 v69, v69
  v_rcp_f32 v70, v70
  v_pk_mul_f32 v[134:135], v[134:135], v[142:143]
  v_rcp_f32 v71, v71
  v_pk_mul_f32 v[128:129], v[128:129], v[64:65]
  v_pk_mul_f32 v[130:131], v[130:131], v[66:67]
  v_pk_mul_f32 v[132:133], v[132:133], v[68:69]
  v_pk_mul_f32 v[134:135], v[134:135], v[70:71]
  v_cvt_pk_bf16_f32 v32, v128, v129
  v_cvt_pk_bf16_f32 v33, v130, v131
  v_cvt_pk_bf16_f32 v34, v132, v133
  v_cvt_pk_bf16_f32 v35, v134, v135
  s_waitcnt lgkmcnt(0)
  v_pk_fma_f32 v[144:145], v[16:17], v[100:101], v[144:145] op_sel:[0,0,0] op_sel_hi:[1,0,1]
  v_pk_fma_f32 v[146:147], v[18:19], v[100:101], v[146:147] op_sel:[0,0,0] op_sel_hi:[1,0,1]
  v_pk_fma_f32 v[148:149], v[20:21], v[100:101], v[148:149] op_sel:[0,0,0] op_sel_hi:[1,0,1]
  v_pk_fma_f32 v[150:151], v[22:23], v[100:101], v[150:151] op_sel:[0,0,0] op_sel_hi:[1,0,1]
  v_pk_mul_f32 v[64:65], v[144:145], v[100:101] op_sel:[0,1] op_sel_hi:[1,1]
  v_pk_mul_f32 v[66:67], v[146:147], v[100:101] op_sel:[0,1] op_sel_hi:[1,1]
  v_pk_mul_f32 v[68:69], v[148:149], v[100:101] op_sel:[0,1] op_sel_hi:[1,1]
  v_pk_mul_f32 v[70:71], v[150:151], v[100:101] op_sel:[0,1] op_sel_hi:[1,1]
  v_exp_f32 v64, v64
  v_pk_fma_f32 v[152:153], v[24:25], v[100:101], v[152:153] op_sel:[0,0,0] op_sel_hi:[1,0,1]
  v_exp_f32 v65, v65
  v_exp_f32 v66, v66
  v_pk_fma_f32 v[154:155], v[26:27], v[100:101], v[154:155] op_sel:[0,0,0] op_sel_hi:[1,0,1]
  v_exp_f32 v67, v67
  v_exp_f32 v68, v68
  v_pk_fma_f32 v[156:157], v[28:29], v[100:101], v[156:157] op_sel:[0,0,0] op_sel_hi:[1,0,1]
  v_exp_f32 v69, v69
  v_exp_f32 v70, v70
  v_pk_fma_f32 v[158:159], v[30:31], v[100:101], v[158:159] op_sel:[0,0,0] op_sel_hi:[1,0,1]
  v_exp_f32 v71, v71
  v_pk_fma_f32 v[64:65], v[64:65], v[102:103], v[102:103] op_sel:[0,0,0] op_sel_hi:[1,0,0]
  v_pk_fma_f32 v[66:67], v[66:67], v[102:103], v[102:103] op_sel:[0,0,0] op_sel_hi:[1,0,0]
  v_pk_fma_f32 v[68:69], v[68:69], v[102:103], v[102:103] op_sel:[0,0,0] op_sel_hi:[1,0,0]
  v_pk_fma_f32 v[70:71], v[70:71], v[102:103], v[102:103] op_sel:[0,0,0] op_sel_hi:[1,0,0]
  v_rcp_f32 v64, v64
  v_pk_mul_f32 v[144:145], v[144:145], v[152:153]
  v_rcp_f32 v65, v65
  v_rcp_f32 v66, v66
  v_pk_mul_f32 v[146:147], v[146:147], v[154:155]
  v_rcp_f32 v67, v67
  v_rcp_f32 v68, v68
  v_pk_mul_f32 v[148:149], v[148:149], v[156:157]
  v_rcp_f32 v69, v69
  v_rcp_f32 v70, v70
  v_pk_mul_f32 v[150:151], v[150:151], v[158:159]
  v_rcp_f32 v71, v71
  v_pk_mul_f32 v[144:145], v[144:145], v[64:65]
  v_pk_mul_f32 v[146:147], v[146:147], v[66:67]
  v_pk_mul_f32 v[148:149], v[148:149], v[68:69]
  v_pk_mul_f32 v[150:151], v[150:151], v[70:71]
  v_cvt_pk_bf16_f32 v36, v144, v145
  v_cvt_pk_bf16_f32 v37, v146, v147
  v_cvt_pk_bf16_f32 v38, v148, v149
  v_cvt_pk_bf16_f32 v39, v150, v151
  v_pk_fma_f32 v[160:161], v[16:17], v[104:105], v[160:161] op_sel:[0,0,0] op_sel_hi:[1,0,1]
  v_pk_fma_f32 v[162:163], v[18:19], v[104:105], v[162:163] op_sel:[0,0,0] op_sel_hi:[1,0,1]
  v_pk_fma_f32 v[164:165], v[20:21], v[104:105], v[164:165] op_sel:[0,0,0] op_sel_hi:[1,0,1]
  v_pk_fma_f32 v[166:167], v[22:23], v[104:105], v[166:167] op_sel:[0,0,0] op_sel_hi:[1,0,1]
  v_pk_mul_f32 v[64:65], v[160:161], v[104:105] op_sel:[0,1] op_sel_hi:[1,1]
  v_pk_mul_f32 v[66:67], v[162:163], v[104:105] op_sel:[0,1] op_sel_hi:[1,1]
  v_pk_mul_f32 v[68:69], v[164:165], v[104:105] op_sel:[0,1] op_sel_hi:[1,1]
  v_pk_mul_f32 v[70:71], v[166:167], v[104:105] op_sel:[0,1] op_sel_hi:[1,1]
  v_exp_f32 v64, v64
  v_pk_fma_f32 v[168:169], v[24:25], v[104:105], v[168:169] op_sel:[0,0,0] op_sel_hi:[1,0,1]
  v_exp_f32 v65, v65
  v_exp_f32 v66, v66
  v_pk_fma_f32 v[170:171], v[26:27], v[104:105], v[170:171] op_sel:[0,0,0] op_sel_hi:[1,0,1]
  v_exp_f32 v67, v67
  v_exp_f32 v68, v68
  v_pk_fma_f32 v[172:173], v[28:29], v[104:105], v[172:173] op_sel:[0,0,0] op_sel_hi:[1,0,1]
  v_exp_f32 v69, v69
  v_exp_f32 v70, v70
  v_pk_fma_f32 v[174:175], v[30:31], v[104:105], v[174:175] op_sel:[0,0,0] op_sel_hi:[1,0,1]
  v_exp_f32 v71, v71
  v_pk_fma_f32 v[64:65], v[64:65], v[106:107], v[106:107] op_sel:[0,0,0] op_sel_hi:[1,0,0]
  v_pk_fma_f32 v[66:67], v[66:67], v[106:107], v[106:107] op_sel:[0,0,0] op_sel_hi:[1,0,0]
  v_pk_fma_f32 v[68:69], v[68:69], v[106:107], v[106:107] op_sel:[0,0,0] op_sel_hi:[1,0,0]
  v_pk_fma_f32 v[70:71], v[70:71], v[106:107], v[106:107] op_sel:[0,0,0] op_sel_hi:[1,0,0]
  v_rcp_f32 v64, v64
  v_pk_mul_f32 v[160:161], v[160:161], v[168:169]
  v_rcp_f32 v65, v65
  v_rcp_f32 v66, v66
  v_pk_mul_f32 v[162:163], v[162:163], v[170:171]
  v_rcp_f32 v67, v67
  v_rcp_f32 v68, v68
  v_pk_mul_f32 v[164:165], v[164:165], v[172:173]
  v_rcp_f32 v69, v69
  v_rcp_f32 v70, v70
  v_pk_mul_f32 v[166:167], v[166:167], v[174:175]
  v_rcp_f32 v71, v71
  v_pk_mul_f32 v[160:161], v[160:161], v[64:65]
  v_pk_mul_f32 v[162:163], v[162:163], v[66:67]
  v_pk_mul_f32 v[164:165], v[164:165], v[68:69]
  v_pk_mul_f32 v[166:167], v[166:167], v[70:71]
  v_cvt_pk_bf16_f32 v40, v160, v161
  v_cvt_pk_bf16_f32 v41, v162, v163
  v_cvt_pk_bf16_f32 v42, v164, v165
  v_cvt_pk_bf16_f32 v43, v166, v167
  v_pk_fma_f32 v[176:177], v[16:17], v[108:109], v[176:177] op_sel:[0,0,0] op_sel_hi:[1,0,1]
  v_pk_fma_f32 v[178:179], v[18:19], v[108:109], v[178:179] op_sel:[0,0,0] op_sel_hi:[1,0,1]
  v_pk_fma_f32 v[180:181], v[20:21], v[108:109], v[180:181] op_sel:[0,0,0] op_sel_hi:[1,0,1]
  v_pk_fma_f32 v[182:183], v[22:23], v[108:109], v[182:183] op_sel:[0,0,0] op_sel_hi:[1,0,1]
  v_pk_mul_f32 v[64:65], v[176:177], v[108:109] op_sel:[0,1] op_sel_hi:[1,1]
  v_pk_mul_f32 v[66:67], v[178:179], v[108:109] op_sel:[0,1] op_sel_hi:[1,1]
  v_pk_mul_f32 v[68:69], v[180:181], v[108:109] op_sel:[0,1] op_sel_hi:[1,1]
  v_pk_mul_f32 v[70:71], v[182:183], v[108:109] op_sel:[0,1] op_sel_hi:[1,1]
  v_exp_f32 v64, v64
  v_pk_fma_f32 v[184:185], v[24:25], v[108:109], v[184:185] op_sel:[0,0,0] op_sel_hi:[1,0,1]
  v_exp_f32 v65, v65
  v_exp_f32 v66, v66
  v_pk_fma_f32 v[186:187], v[26:27], v[108:109], v[186:187] op_sel:[0,0,0] op_sel_hi:[1,0,1]
  v_exp_f32 v67, v67
  v_exp_f32 v68, v68
  v_pk_fma_f32 v[188:189], v[28:29], v[108:109], v[188:189] op_sel:[0,0,0] op_sel_hi:[1,0,1]
  v_exp_f32 v69, v69
  v_exp_f32 v70, v70
  v_pk_fma_f32 v[190:191], v[30:31], v[108:109], v[190:191] op_sel:[0,0,0] op_sel_hi:[1,0,1]
  v_exp_f32 v71, v71
  v_pk_fma_f32 v[64:65], v[64:65], v[110:111], v[110:111] op_sel:[0,0,0] op_sel_hi:[1,0,0]
  v_pk_fma_f32 v[66:67], v[66:67], v[110:111], v[110:111] op_sel:[0,0,0] op_sel_hi:[1,0,0]
  v_pk_fma_f32 v[68:69], v[68:69], v[110:111], v[110:111] op_sel:[0,0,0] op_sel_hi:[1,0,0]
  v_pk_fma_f32 v[70:71], v[70:71], v[110:111], v[110:111] op_sel:[0,0,0] op_sel_hi:[1,0,0]
  v_rcp_f32 v64, v64
  v_pk_mul_f32 v[176:177], v[176:177], v[184:185]
  v_rcp_f32 v65, v65
  v_rcp_f32 v66, v66
  v_pk_mul_f32 v[178:179], v[178:179], v[186:187]
  v_rcp_f32 v67, v67
  v_rcp_f32 v68, v68
  v_pk_mul_f32 v[180:181], v[180:181], v[188:189]
  v_rcp_f32 v69, v69
  v_rcp_f32 v70, v70
  v_pk_mul_f32 v[182:183], v[182:183], v[190:191]
  v_rcp_f32 v71, v71
  v_pk_mul_f32 v[176:177], v[176:177], v[64:65]
  v_pk_mul_f32 v[178:179], v[178:179], v[66:67]
  v_pk_mul_f32 v[180:181], v[180:181], v[68:69]
  v_pk_mul_f32 v[182:183], v[182:183], v[70:71]
  v_cvt_pk_bf16_f32 v44, v176, v177
  v_cvt_pk_bf16_f32 v45, v178, v179
  v_cvt_pk_bf16_f32 v46, v180, v181
  v_cvt_pk_bf16_f32 v47, v182, v183
  buffer_store_dwordx4 v[32:35], v2, s[20:23], s27 offen sc1
  s_add_u32 s27, s27, 55296
  buffer_store_dwordx4 v[36:39], v2, s[20:23], s27 offen sc1
  s_add_u32 s27, s27, 55296
  buffer_store_dwordx4 v[40:43], v2, s[20:23], s27 offen sc1
  s_add_u32 s27, s27, 55296
  buffer_store_dwordx4 v[44:47], v2, s[20:23], s27 offen sc1
  s_add_u32 s27, s27, 55296
  v_pk_fma_f32 v[192:193], v[16:17], v[112:113], v[192:193] op_sel:[0,0,0] op_sel_hi:[1,0,1]
  v_pk_fma_f32 v[194:195], v[18:19], v[112:113], v[194:195] op_sel:[0,0,0] op_sel_hi:[1,0,1]
  v_pk_fma_f32 v[196:197], v[20:21], v[112:113], v[196:197] op_sel:[0,0,0] op_sel_hi:[1,0,1]
  v_pk_fma_f32 v[198:199], v[22:23], v[112:113], v[198:199] op_sel:[0,0,0] op_sel_hi:[1,0,1]
  v_pk_mul_f32 v[64:65], v[192:193], v[112:113] op_sel:[0,1] op_sel_hi:[1,1]
  v_pk_mul_f32 v[66:67], v[194:195], v[112:113] op_sel:[0,1] op_sel_hi:[1,1]
  v_pk_mul_f32 v[68:69], v[196:197], v[112:113] op_sel:[0,1] op_sel_hi:[1,1]
  v_pk_mul_f32 v[70:71], v[198:199], v[112:113] op_sel:[0,1] op_sel_hi:[1,1]
  v_exp_f32 v64, v64
  v_pk_fma_f32 v[200:201], v[24:25], v[112:113], v[200:201] op_sel:[0,0,0] op_sel_hi:[1,0,1]
  v_exp_f32 v65, v65
  v_exp_f32 v66, v66
  v_pk_fma_f32 v[202:203], v[26:27], v[112:113], v[202:203] op_sel:[0,0,0] op_sel_hi:[1,0,1]
  v_exp_f32 v67, v67
  v_exp_f32 v68, v68
  v_pk_fma_f32 v[204:205], v[28:29], v[112:113], v[204:205] op_sel:[0,0,0] op_sel_hi:[1,0,1]
  v_exp_f32 v69, v69
  v_exp_f32 v70, v70
  v_pk_fma_f32 v[206:207], v[30:31], v[112:113], v[206:207] op_sel:[0,0,0] op_sel_hi:[1,0,1]
  v_exp_f32 v71, v71
  v_pk_fma_f32 v[64:65], v[64:65], v[114:115], v[114:115] op_sel:[0,0,0] op_sel_hi:[1,0,0]
  v_pk_fma_f32 v[66:67], v[66:67], v[114:115], v[114:115] op_sel:[0,0,0] op_sel_hi:[1,0,0]
  v_pk_fma_f32 v[68:69], v[68:69], v[114:115], v[114:115] op_sel:[0,0,0] op_sel_hi:[1,0,0]
  v_pk_fma_f32 v[70:71], v[70:71], v[114:115], v[114:115] op_sel:[0,0,0] op_sel_hi:[1,0,0]
  v_rcp_f32 v64, v64
  v_pk_mul_f32 v[192:193], v[192:193], v[200:201]
  v_rcp_f32 v65, v65
  v_rcp_f32 v66, v66
  v_pk_mul_f32 v[194:195], v[194:195], v[202:203]
  v_rcp_f32 v67, v67
  v_rcp_f32 v68, v68
  v_pk_mul_f32 v[196:197], v[196:197], v[204:205]
  v_rcp_f32 v69, v69
  v_rcp_f32 v70, v70
  v_pk_mul_f32 v[198:199], v[198:199], v[206:207]
  v_rcp_f32 v71, v71
  v_pk_mul_f32 v[192:193], v[192:193], v[64:65]
  v_pk_mul_f32 v[194:195], v[194:195], v[66:67]
  v_pk_mul_f32 v[196:197], v[196:197], v[68:69]
  v_pk_mul_f32 v[198:199], v[198:199], v[70:71]
  v_cvt_pk_bf16_f32 v48, v192, v193
  v_cvt_pk_bf16_f32 v49, v194, v195
  v_cvt_pk_bf16_f32 v50, v196, v197
  v_cvt_pk_bf16_f32 v51, v198, v199
  buffer_store_dwordx4 v[48:51], v2, s[20:23], s27 offen sc1
  s_add_u32 s27, s27, 55296
  v_pk_fma_f32 v[208:209], v[16:17], v[116:117], v[208:209] op_sel:[0,0,0] op_sel_hi:[1,0,1]
  v_pk_fma_f32 v[210:211], v[18:19], v[116:117], v[210:211] op_sel:[0,0,0] op_sel_hi:[1,0,1]
  v_pk_fma_f32 v[212:213], v[20:21], v[116:117], v[212:213] op_sel:[0,0,0] op_sel_hi:[1,0,1]
  v_pk_fma_f32 v[214:215], v[22:23], v[116:117], v[214:215] op_sel:[0,0,0] op_sel_hi:[1,0,1]
  v_pk_mul_f32 v[64:65], v[208:209], v[116:117] op_sel:[0,1] op_sel_hi:[1,1]
  v_pk_mul_f32 v[66:67], v[210:211], v[116:117] op_sel:[0,1] op_sel_hi:[1,1]
  v_pk_mul_f32 v[68:69], v[212:213], v[116:117] op_sel:[0,1] op_sel_hi:[1,1]
  v_pk_mul_f32 v[70:71], v[214:215], v[116:117] op_sel:[0,1] op_sel_hi:[1,1]
  v_exp_f32 v64, v64
  v_pk_fma_f32 v[216:217], v[24:25], v[116:117], v[216:217] op_sel:[0,0,0] op_sel_hi:[1,0,1]
  v_exp_f32 v65, v65
  v_exp_f32 v66, v66
  v_pk_fma_f32 v[218:219], v[26:27], v[116:117], v[218:219] op_sel:[0,0,0] op_sel_hi:[1,0,1]
  v_exp_f32 v67, v67
  v_exp_f32 v68, v68
  v_pk_fma_f32 v[220:221], v[28:29], v[116:117], v[220:221] op_sel:[0,0,0] op_sel_hi:[1,0,1]
  v_exp_f32 v69, v69
  v_exp_f32 v70, v70
  v_pk_fma_f32 v[222:223], v[30:31], v[116:117], v[222:223] op_sel:[0,0,0] op_sel_hi:[1,0,1]
  v_exp_f32 v71, v71
  v_pk_fma_f32 v[64:65], v[64:65], v[118:119], v[118:119] op_sel:[0,0,0] op_sel_hi:[1,0,0]
  v_pk_fma_f32 v[66:67], v[66:67], v[118:119], v[118:119] op_sel:[0,0,0] op_sel_hi:[1,0,0]
  v_pk_fma_f32 v[68:69], v[68:69], v[118:119], v[118:119] op_sel:[0,0,0] op_sel_hi:[1,0,0]
  v_pk_fma_f32 v[70:71], v[70:71], v[118:119], v[118:119] op_sel:[0,0,0] op_sel_hi:[1,0,0]
  v_rcp_f32 v64, v64
  v_pk_mul_f32 v[208:209], v[208:209], v[216:217]
  v_rcp_f32 v65, v65
  v_rcp_f32 v66, v66
  v_pk_mul_f32 v[210:211], v[210:211], v[218:219]
  v_rcp_f32 v67, v67
  v_rcp_f32 v68, v68
  v_pk_mul_f32 v[212:213], v[212:213], v[220:221]
  v_rcp_f32 v69, v69
  v_rcp_f32 v70, v70
  v_pk_mul_f32 v[214:215], v[214:215], v[222:223]
  v_rcp_f32 v71, v71
  v_pk_mul_f32 v[208:209], v[208:209], v[64:65]
  v_pk_mul_f32 v[210:211], v[210:211], v[66:67]
  v_pk_mul_f32 v[212:213], v[212:213], v[68:69]
  v_pk_mul_f32 v[214:215], v[214:215], v[70:71]
  v_cvt_pk_bf16_f32 v52, v208, v209
  v_cvt_pk_bf16_f32 v53, v210, v211
  v_cvt_pk_bf16_f32 v54, v212, v213
  v_cvt_pk_bf16_f32 v55, v214, v215
  buffer_store_dwordx4 v[52:55], v2, s[20:23], s27 offen sc1
  s_add_u32 s27, s27, 55296
  v_pk_fma_f32 v[224:225], v[16:17], v[120:121], v[224:225] op_sel:[0,0,0] op_sel_hi:[1,0,1]
  v_pk_fma_f32 v[226:227], v[18:19], v[120:121], v[226:227] op_sel:[0,0,0] op_sel_hi:[1,0,1]
  v_pk_fma_f32 v[228:229], v[20:21], v[120:121], v[228:229] op_sel:[0,0,0] op_sel_hi:[1,0,1]
  v_pk_fma_f32 v[230:231], v[22:23], v[120:121], v[230:231] op_sel:[0,0,0] op_sel_hi:[1,0,1]
  v_pk_mul_f32 v[64:65], v[224:225], v[120:121] op_sel:[0,1] op_sel_hi:[1,1]
  v_pk_mul_f32 v[66:67], v[226:227], v[120:121] op_sel:[0,1] op_sel_hi:[1,1]
  v_pk_mul_f32 v[68:69], v[228:229], v[120:121] op_sel:[0,1] op_sel_hi:[1,1]
  v_pk_mul_f32 v[70:71], v[230:231], v[120:121] op_sel:[0,1] op_sel_hi:[1,1]
  v_exp_f32 v64, v64
  v_pk_fma_f32 v[232:233], v[24:25], v[120:121], v[232:233] op_sel:[0,0,0] op_sel_hi:[1,0,1]
  v_exp_f32 v65, v65
  v_exp_f32 v66, v66
  v_pk_fma_f32 v[234:235], v[26:27], v[120:121], v[234:235] op_sel:[0,0,0] op_sel_hi:[1,0,1]
  v_exp_f32 v67, v67
  v_exp_f32 v68, v68
  v_pk_fma_f32 v[236:237], v[28:29], v[120:121], v[236:237] op_sel:[0,0,0] op_sel_hi:[1,0,1]
  v_exp_f32 v69, v69
  v_exp_f32 v70, v70
  v_pk_fma_f32 v[238:239], v[30:31], v[120:121], v[238:239] op_sel:[0,0,0] op_sel_hi:[1,0,1]
  v_exp_f32 v71, v71
  v_pk_fma_f32 v[64:65], v[64:65], v[122:123], v[122:123] op_sel:[0,0,0] op_sel_hi:[1,0,0]
  v_pk_fma_f32 v[66:67], v[66:67], v[122:123], v[122:123] op_sel:[0,0,0] op_sel_hi:[1,0,0]
  v_pk_fma_f32 v[68:69], v[68:69], v[122:123], v[122:123] op_sel:[0,0,0] op_sel_hi:[1,0,0]
  v_pk_fma_f32 v[70:71], v[70:71], v[122:123], v[122:123] op_sel:[0,0,0] op_sel_hi:[1,0,0]
  v_rcp_f32 v64, v64
  v_pk_mul_f32 v[224:225], v[224:225], v[232:233]
  v_rcp_f32 v65, v65
  v_rcp_f32 v66, v66
  v_pk_mul_f32 v[226:227], v[226:227], v[234:235]
  v_rcp_f32 v67, v67
  v_rcp_f32 v68, v68
  v_pk_mul_f32 v[228:229], v[228:229], v[236:237]
  v_rcp_f32 v69, v69
  v_rcp_f32 v70, v70
  v_pk_mul_f32 v[230:231], v[230:231], v[238:239]
  v_rcp_f32 v71, v71
  v_pk_mul_f32 v[224:225], v[224:225], v[64:65]
  v_pk_mul_f32 v[226:227], v[226:227], v[66:67]
  v_pk_mul_f32 v[228:229], v[228:229], v[68:69]
  v_pk_mul_f32 v[230:231], v[230:231], v[70:71]
  v_cvt_pk_bf16_f32 v56, v224, v225
  v_cvt_pk_bf16_f32 v57, v226, v227
  v_cvt_pk_bf16_f32 v58, v228, v229
  v_cvt_pk_bf16_f32 v59, v230, v231
  s_barrier
  buffer_store_dwordx4 v[56:59], v2, s[20:23], s27 offen sc1
  s_add_u32 s27, s27, 55296
  v_pk_fma_f32 v[240:241], v[16:17], v[124:125], v[240:241] op_sel:[0,0,0] op_sel_hi:[1,0,1]
  v_pk_fma_f32 v[242:243], v[18:19], v[124:125], v[242:243] op_sel:[0,0,0] op_sel_hi:[1,0,1]
  v_pk_fma_f32 v[244:245], v[20:21], v[124:125], v[244:245] op_sel:[0,0,0] op_sel_hi:[1,0,1]
  v_pk_fma_f32 v[246:247], v[22:23], v[124:125], v[246:247] op_sel:[0,0,0] op_sel_hi:[1,0,1]
  v_pk_mul_f32 v[64:65], v[240:241], v[124:125] op_sel:[0,1] op_sel_hi:[1,1]
  v_pk_mul_f32 v[66:67], v[242:243], v[124:125] op_sel:[0,1] op_sel_hi:[1,1]
  v_pk_mul_f32 v[68:69], v[244:245], v[124:125] op_sel:[0,1] op_sel_hi:[1,1]
  v_pk_mul_f32 v[70:71], v[246:247], v[124:125] op_sel:[0,1] op_sel_hi:[1,1]
  v_exp_f32 v64, v64
  v_pk_fma_f32 v[248:249], v[24:25], v[124:125], v[248:249] op_sel:[0,0,0] op_sel_hi:[1,0,1]
  v_exp_f32 v65, v65
  v_exp_f32 v66, v66
  v_pk_fma_f32 v[250:251], v[26:27], v[124:125], v[250:251] op_sel:[0,0,0] op_sel_hi:[1,0,1]
  v_exp_f32 v67, v67
  v_exp_f32 v68, v68
  v_pk_fma_f32 v[252:253], v[28:29], v[124:125], v[252:253] op_sel:[0,0,0] op_sel_hi:[1,0,1]
  v_exp_f32 v69, v69
  v_exp_f32 v70, v70
  v_pk_fma_f32 v[254:255], v[30:31], v[124:125], v[254:255] op_sel:[0,0,0] op_sel_hi:[1,0,1]
  v_exp_f32 v71, v71
  v_pk_fma_f32 v[64:65], v[64:65], v[126:127], v[126:127] op_sel:[0,0,0] op_sel_hi:[1,0,0]
  v_pk_fma_f32 v[66:67], v[66:67], v[126:127], v[126:127] op_sel:[0,0,0] op_sel_hi:[1,0,0]
  v_pk_fma_f32 v[68:69], v[68:69], v[126:127], v[126:127] op_sel:[0,0,0] op_sel_hi:[1,0,0]
  v_pk_fma_f32 v[70:71], v[70:71], v[126:127], v[126:127] op_sel:[0,0,0] op_sel_hi:[1,0,0]
  v_rcp_f32 v64, v64
  v_pk_mul_f32 v[240:241], v[240:241], v[248:249]
  v_rcp_f32 v65, v65
  v_rcp_f32 v66, v66
  v_pk_mul_f32 v[242:243], v[242:243], v[250:251]
  v_rcp_f32 v67, v67
  v_rcp_f32 v68, v68
  v_pk_mul_f32 v[244:245], v[244:245], v[252:253]
  v_rcp_f32 v69, v69
  v_rcp_f32 v70, v70
  v_pk_mul_f32 v[246:247], v[246:247], v[254:255]
  v_rcp_f32 v71, v71
  v_pk_mul_f32 v[240:241], v[240:241], v[64:65]
  v_pk_mul_f32 v[242:243], v[242:243], v[66:67]
  v_pk_mul_f32 v[244:245], v[244:245], v[68:69]
  v_pk_mul_f32 v[246:247], v[246:247], v[70:71]
  v_cvt_pk_bf16_f32 v60, v240, v241
  v_cvt_pk_bf16_f32 v61, v242, v243
  v_cvt_pk_bf16_f32 v62, v244, v245
  v_cvt_pk_bf16_f32 v63, v246, v247
  buffer_store_dwordx4 v[60:63], v2, s[20:23], s27 offen sc1
  s_add_u32 s27, s27, 55296
  s_lshl_b32 s27, s24, 1
  s_lshr_b32 s28, s26, 1
  s_add_u32 s27, s27, s28
  s_lshl_b32 s27, s27, 6
  s_lshl_b32 s28, s25, 1
  s_add_u32 s27, s27, s28
  s_and_b32 s28, s26, 1
  s_add_u32 s27, s27, s28
  s_lshl_b32 s27, s27, 7
  s_add_u32 s27, s27, 327680
  v_lshlrev_b32 v3, 4, v1
  v_add_u32 v4, 55296, v3
  v_add_u32 v5, 110592, v3
  v_add_u32 v6, 165888, v3
  v_add_u32 v7, 221184, v3
  v_lshrrev_b32 v13, 2, v1
  v_lshlrev_b32 v8, 7, v13
  v_bfe_u32 v13, v1, 3, 2
  v_lshl_add_u32 v8, v13, 5, v8
  v_and_b32 v13, 3, v1
  v_lshl_add_u32 v8, v13, 3, v8
  v_add_u32 v8, s95, v8
  v_xor_b32 v9, 32, v8
  v_xor_b32 v10, 64, v8
  v_xor_b32 v11, 0x60, v8
  v_lshrrev_b32 v13, 4, v1
  v_lshlrev_b32 v13, 1, v13
  v_and_b32 v172, 7, v1
  v_xor_b32 v172, v172, v13
  v_lshrrev_b32 v13, 3, v1
  v_mul_u32_u24 v13, 1280, v13
  v_lshl_add_u32 v172, v172, 4, v13
  v_add_u32 v173, 9216, v172
  v_add_u32 v174, 18432, v172
  v_add_u32 v175, 27648, v172
  s_mov_b32 s16, s86
  s_mov_b32 s17, s87
  s_mov_b32 s18, 2211840
  s_mov_b32 s19, 0x20000
  s_add_u32 s48, s96, 0
  s_sub_u32 s97, s48, 54
  s_cmp_ge_u32 s48, 54
  s_cselect_b32 s48, s97, s48
  s_mul_i32 s48, s48, 1024
  s_add_u32 s48, s48, s93
  s_add_u32 s49, s96, 4
  s_sub_u32 s97, s49, 54
  s_cmp_ge_u32 s49, 54
  s_cselect_b32 s49, s97, s49
  s_mul_i32 s49, s49, 1024
  s_add_u32 s49, s49, s93
  s_add_u32 s50, s96, 8
  s_sub_u32 s97, s50, 54
  s_cmp_ge_u32 s50, 54
  s_cselect_b32 s50, s97, s50
  s_mul_i32 s50, s50, 1024
  s_add_u32 s50, s50, s93
  s_add_u32 s51, s96, 12
  s_sub_u32 s97, s51, 54
  s_cmp_ge_u32 s51, 54
  s_cselect_b32 s51, s97, s51
  s_mul_i32 s51, s51, 1024
  s_add_u32 s51, s51, s93
  s_add_u32 s52, s96, 16
  s_sub_u32 s97, s52, 54
  s_cmp_ge_u32 s52, 54
  s_cselect_b32 s52, s97, s52
  s_mul_i32 s52, s52, 1024
  s_add_u32 s52, s52, s93
  s_add_u32 s53, s96, 20
  s_sub_u32 s97, s53, 54
  s_cmp_ge_u32 s53, 54
  s_cselect_b32 s53, s97, s53
  s_mul_i32 s53, s53, 1024
  s_add_u32 s53, s53, s93
  s_add_u32 s54, s96, 24
  s_sub_u32 s97, s54, 54
  s_cmp_ge_u32 s54, 54
  s_cselect_b32 s54, s97, s54
  s_mul_i32 s54, s54, 1024
  s_add_u32 s54, s54, s93
  s_add_u32 s55, s96, 28
  s_sub_u32 s97, s55, 54
  s_cmp_ge_u32 s55, 54
  s_cselect_b32 s55, s97, s55
  s_mul_i32 s55, s55, 1024
  s_add_u32 s55, s55, s93
  s_add_u32 s56, s96, 32
  s_sub_u32 s97, s56, 54
  s_cmp_ge_u32 s56, 54
  s_cselect_b32 s56, s97, s56
  s_mul_i32 s56, s56, 1024
  s_add_u32 s56, s56, s93
  s_add_u32 s57, s96, 36
  s_sub_u32 s97, s57, 54
  s_cmp_ge_u32 s57, 54
  s_cselect_b32 s57, s97, s57
  s_mul_i32 s57, s57, 1024
  s_add_u32 s57, s57, s93
  s_add_u32 s58, s96, 40
  s_sub_u32 s97, s58, 54
  s_cmp_ge_u32 s58, 54
  s_cselect_b32 s58, s97, s58
  s_mul_i32 s58, s58, 1024
  s_add_u32 s58, s58, s93
  s_add_u32 s59, s96, 44
  s_sub_u32 s97, s59, 54
  s_cmp_ge_u32 s59, 54
  s_cselect_b32 s59, s97, s59
  s_mul_i32 s59, s59, 1024
  s_add_u32 s59, s59, s93
  s_add_u32 s42, s96, 48
  s_sub_u32 s97, s42, 54
  s_cmp_ge_u32 s42, 54
  s_cselect_b32 s42, s97, s42
  s_mul_i32 s42, s42, 1024
  s_add_u32 s42, s42, s93
  s_add_u32 s43, s96, 52
  s_sub_u32 s97, s43, 54
  s_cmp_ge_u32 s43, 54
  s_cselect_b32 s43, s97, s43
  s_mul_i32 s43, s43, 1024
  s_add_u32 s43, s43, s93
  s_cmp_lt_u32 s26, 2
  s_cselect_b32 s43, s43, 2147483392
  s_waitcnt vmcnt(0)
  v_mov_b32 v14, s3
  v_mov_b32 v15, 0
  s_mov_b64 exec, 1
  buffer_store_dword v14, v15, s[20:23], s27 offen sc1
  s_mov_b64 exec, -1
  s_barrier
L_n2:
  s_setprio 3
  v_and_b32 v13, 15, v1
  v_min_u32 v13, 13, v13
  v_lshlrev_b32 v13, 2, v13
  v_add_u32 v13, s96, v13
  v_subrev_u32 v14, 54, v13
  v_min_u32 v13, v13, v14
  v_bfe_u32 v14, v1, 4, 1
  v_lshlrev_b32 v14, 2, v14
  v_add_u32 v14, s90, v14
  v_lshrrev_b32 v14, 3, v14
  v_lshl_add_u32 v13, v14, 6, v13
  v_lshlrev_b32 v13, 7, v13
  s_mov_b32 s27, 327680
  s_waitcnt lgkmcnt(0)
  ds_read_b64_tr_b16 v[16:17], v8 offset:0
  ds_read_b64_tr_b16 v[18:19], v8 offset:2048
  ds_read_b64_tr_b16 v[20:21], v9 offset:0
  ds_read_b64_tr_b16 v[22:23], v9 offset:2048
  ds_read_b64_tr_b16 v[24:25], v10 offset:0
  ds_read_b64_tr_b16 v[26:27], v10 offset:2048
  ds_read_b64_tr_b16 v[28:29], v11 offset:0
  ds_read_b64_tr_b16 v[30:31], v11 offset:2048
  ds_read_b64_tr_b16 v[32:33], v8 offset:4096
  ds_read_b64_tr_b16 v[34:35], v8 offset:6144
  ds_read_b64_tr_b16 v[36:37], v9 offset:4096
  ds_read_b64_tr_b16 v[38:39], v9 offset:6144
  ds_read_b64_tr_b16 v[40:41], v10 offset:4096
  ds_read_b64_tr_b16 v[42:43], v10 offset:6144
  ds_read_b64_tr_b16 v[44:45], v11 offset:4096
  ds_read_b64_tr_b16 v[46:47], v11 offset:6144
  s_waitcnt lgkmcnt(8)
  s_add_u32 m0, s95, 0
  s_add_u32 s98, s96, 32
  s_sub_u32 s97, s98, 54
  s_cmp_ge_u32 s98, 54
  s_cselect_b32 s98, s97, s98
  s_mul_i32 s98, s98, 40960
  s_add_u32 s98, s98, s94
  buffer_load_dwordx4 v172, s[16:19], s98 offen offset:0 lds
  buffer_load_dwordx4 v173, s[16:19], s98 offen offset:1024 lds
  buffer_load_dwordx4 v174, s[16:19], s98 offen offset:2048 lds
  buffer_load_dwordx4 v175, s[16:19], s98 offen offset:3072 lds
  ds_read_b64_tr_b16 v[48:49], v8 offset:8192
  ds_read_b64_tr_b16 v[50:51], v8 offset:10240
  ds_read_b64_tr_b16 v[52:53], v9 offset:8192
  ds_read_b64_tr_b16 v[54:55], v9 offset:10240
  ds_read_b64_tr_b16 v[56:57], v10 offset:8192
  ds_read_b64_tr_b16 v[58:59], v10 offset:10240
  ds_read_b64_tr_b16 v[60:61], v11 offset:8192
  ds_read_b64_tr_b16 v[62:63], v11 offset:10240
  s_waitcnt lgkmcnt(8)
  s_add_u32 m0, s95, 4096
  s_add_u32 s98, s96, 36
  s_sub_u32 s97, s98, 54
  s_cmp_ge_u32 s98, 54
  s_cselect_b32 s98, s97, s98
  s_mul_i32 s98, s98, 40960
  s_add_u32 s98, s98, s94
  buffer_load_dwordx4 v172, s[16:19], s98 offen offset:0 lds
  buffer_load_dwordx4 v173, s[16:19], s98 offen offset:1024 lds
  buffer_load_dwordx4 v174, s[16:19], s98 offen offset:2048 lds
  buffer_load_dwordx4 v175, s[16:19], s98 offen offset:3072 lds
  ds_read_b64_tr_b16 v[64:65], v8 offset:12288
  ds_read_b64_tr_b16 v[66:67], v8 offset:14336
  ds_read_b64_tr_b16 v[68:69], v9 offset:12288
  ds_read_b64_tr_b16 v[70:71], v9 offset:14336
  ds_read_b64_tr_b16 v[72:73], v10 offset:12288
  ds_read_b64_tr_b16 v[74:75], v10 offset:14336
  ds_read_b64_tr_b16 v[76:77], v11 offset:12288
  ds_read_b64_tr_b16 v[78:79], v11 offset:14336
  s_waitcnt lgkmcnt(8)
  s_add_u32 m0, s95, 8192
  s_add_u32 s98, s96, 40
  s_sub_u32 s97, s98, 54
  s_cmp_ge_u32 s98, 54
  s_cselect_b32 s98, s97, s98
  s_mul_i32 s98, s98, 40960
  s_add_u32 s98, s98, s94
  buffer_load_dwordx4 v172, s[16:19], s98 offen offset:0 lds
  buffer_load_dwordx4 v173, s[16:19], s98 offen offset:1024 lds
  buffer_load_dwordx4 v174, s[16:19], s98 offen offset:2048 lds
  buffer_load_dwordx4 v175, s[16:19], s98 offen offset:3072 lds
  ds_read_b64_tr_b16 v[80:81], v8 offset:16384
  ds_read_b64_tr_b16 v[82:83], v8 offset:18432
  ds_read_b64_tr_b16 v[84:85], v9 offset:16384
  ds_read_b64_tr_b16 v[86:87], v9 offset:18432
  ds_read_b64_tr_b16 v[88:89], v10 offset:16384
  ds_read_b64_tr_b16 v[90:91], v10 offset:18432
  ds_read_b64_tr_b16 v[92:93], v11 offset:16384
  ds_read_b64_tr_b16 v[94:95], v11 offset:18432
  s_waitcnt lgkmcnt(8)
  buffer_load_dword v14, v13, s[20:23], s27 offen sc1
  s_add_u32 m0, s95, 12288
  s_add_u32 s98, s96, 44
  s_sub_u32 s97, s98, 54
  s_cmp_ge_u32 s98, 54
  s_cselect_b32 s98, s97, s98
  s_mul_i32 s98, s98, 40960
  s_add_u32 s98, s98, s94
  buffer_load_dwordx4 v172, s[16:19], s98 offen offset:0 lds
  buffer_load_dwordx4 v173, s[16:19], s98 offen offset:1024 lds
  buffer_load_dwordx4 v174, s[16:19], s98 offen offset:2048 lds
  buffer_load_dwordx4 v175, s[16:19], s98 offen offset:3072 lds
  ds_read_b64_tr_b16 v[96:97], v8 offset:20480
  ds_read_b64_tr_b16 v[98:99], v8 offset:22528
  ds_read_b64_tr_b16 v[100:101], v9 offset:20480
  ds_read_b64_tr_b16 v[102:103], v9 offset:22528
  ds_read_b64_tr_b16 v[104:105], v10 offset:20480
  ds_read_b64_tr_b16 v[106:107], v10 offset:22528
  ds_read_b64_tr_b16 v[108:109], v11 offset:20480
  ds_read_b64_tr_b16 v[110:111], v11 offset:22528
  s_waitcnt lgkmcnt(8)
  s_add_u32 m0, s95, 16384
  s_add_u32 s98, s96, 48
  s_sub_u32 s97, s98, 54
  s_cmp_ge_u32 s98, 54
  s_cselect_b32 s98, s97, s98
  s_mul_i32 s98, s98, 40960
  s_add_u32 s98, s98, s94
  buffer_load_dwordx4 v172, s[16:19], s98 offen offset:0 lds
  buffer_load_dwordx4 v173, s[16:19], s98 offen offset:1024 lds
  buffer_load_dwordx4 v174, s[16:19], s98 offen offset:2048 lds
  buffer_load_dwordx4 v175, s[16:19], s98 offen offset:3072 lds
  s_waitcnt lgkmcnt(0)
  s_add_u32 m0, s95, 20480
  s_add_u32 s98, s96, 52
  s_sub_u32 s97, s98, 54
  s_cmp_ge_u32 s98, 54
  s_cselect_b32 s98, s97, s98
  s_mul_i32 s98, s98, 40960
  s_add_u32 s98, s98, s94
  s_cmp_lt_u32 s26, 2
  s_cselect_b32 s98, s98, 2147483392
  buffer_load_dwordx4 v172, s[16:19], s98 offen offset:0 lds
  buffer_load_dwordx4 v173, s[16:19], s98 offen offset:1024 lds
  buffer_load_dwordx4 v174, s[16:19], s98 offen offset:2048 lds
  buffer_load_dwordx4 v175, s[16:19], s98 offen offset:3072 lds
  s_mov_b32 s34, 196611
  s_mov_b32 s47, 100000
  s_waitcnt vmcnt(12)
  v_cmp_ne_u32 vcc, s3, v14
  s_nop 0
  s_mov_b32 s35, vcc_lo
  s_and_b32 s33, s35, s34
  s_cbranch_scc0 L_h1ok
  s_call_b64 s[100:101], L_hrdy_go
L_h1ok:
  buffer_load_dwordx4 v[112:115], v3, s[20:23], s48 offen sc1
  buffer_load_dwordx4 v[116:119], v4, s[20:23], s48 offen sc1
  buffer_load_dwordx4 v[120:123], v5, s[20:23], s48 offen sc1
  buffer_load_dwordx4 v[124:127], v6, s[20:23], s48 offen sc1
  buffer_load_dwordx4 v[128:131], v7, s[20:23], s48 offen sc1
  buffer_load_dwordx4 v[132:135], v3, s[20:23], s49 offen sc1
  buffer_load_dwordx4 v[136:139], v4, s[20:23], s49 offen sc1
  buffer_load_dwordx4 v[140:143], v5, s[20:23], s49 offen sc1
  buffer_load_dwordx4 v[144:147], v6, s[20:23], s49 offen sc1
  buffer_load_dwordx4 v[148:151], v7, s[20:23], s49 offen sc1
  s_waitcnt vmcnt(5)
  v_mfma_f32_16x16x32_bf16 v[176:179], v[16:19], v[112:115], 0
  s_and_b32 s34, s35, 262148
  s_cbranch_scc0 L_hok0
  s_call_b64 s[100:101], L_hrdy_go
L_hok0:
  buffer_load_dwordx4 v[152:155], v3, s[20:23], s50 offen sc1
  v_mfma_f32_16x16x32_bf16 v[180:183], v[20:23], v[112:115], 0
  v_mfma_f32_16x16x32_bf16 v[184:187], v[24:27], v[112:115], 0
  v_mfma_f32_16x16x32_bf16 v[188:191], v[28:31], v[112:115], 0
  buffer_load_dwordx4 v[156:159], v4, s[20:23], s50 offen sc1
  v_mfma_f32_16x16x32_bf16 v[192:195], v[16:19], v[116:119], 0
  v_mfma_f32_16x16x32_bf16 v[196:199], v[20:23], v[116:119], 0
  v_mfma_f32_16x16x32_bf16 v[200:203], v[24:27], v[116:119], 0
  buffer_load_dwordx4 v[160:163], v5, s[20:23], s50 offen sc1
  v_mfma_f32_16x16x32_bf16 v[204:207], v[28:31], v[116:119], 0
  v_mfma_f32_16x16x32_bf16 v[208:211], v[16:19], v[120:123], 0
  v_mfma_f32_16x16x32_bf16 v[212:215], v[20:23], v[120:123], 0
  buffer_load_dwordx4 v[164:167], v6, s[20:23], s50 offen sc1
  v_mfma_f32_16x16x32_bf16 v[216:219], v[24:27], v[120:123], 0
  v_mfma_f32_16x16x32_bf16 v[220:223], v[28:31], v[120:123], 0
  v_mfma_f32_16x16x32_bf16 v[224:227], v[16:19], v[124:127], 0
  buffer_load_dwordx4 v[168:171], v7, s[20:23], s50 offen sc1
  v_mfma_f32_16x16x32_bf16 v[228:231], v[20:23], v[124:127], 0
  v_mfma_f32_16x16x32_bf16 v[232:235], v[24:27], v[124:127], 0
  v_mfma_f32_16x16x32_bf16 v[236:239], v[28:31], v[124:127], 0
  v_mfma_f32_16x16x32_bf16 v[240:243], v[16:19], v[128:131], 0
  v_mfma_f32_16x16x32_bf16 v[244:247], v[20:23], v[128:131], 0
  v_mfma_f32_16x16x32_bf16 v[248:251], v[24:27], v[128:131], 0
  v_mfma_f32_16x16x32_bf16 v[252:255], v[28:31], v[128:131], 0
  s_waitcnt vmcnt(5)
  v_mfma_f32_16x16x32_bf16 v[176:179], v[32:35], v[132:135], v[176:179]
  s_and_b32 s34, s35, 524296
  s_cbranch_scc0 L_hok1
  s_call_b64 s[100:101], L_hrdy_go
L_hok1:
  buffer_load_dwordx4 v[112:115], v3, s[20:23], s51 offen sc1
  v_mfma_f32_16x16x32_bf16 v[180:183], v[36:39], v[132:135], v[180:183]
  v_mfma_f32_16x16x32_bf16 v[184:187], v[40:43], v[132:135], v[184:187]
  v_mfma_f32_16x16x32_bf16 v[188:191], v[44:47], v[132:135], v[188:191]
  buffer_load_dwordx4 v[116:119], v4, s[20:23], s51 offen sc1
  v_mfma_f32_16x16x32_bf16 v[192:195], v[32:35], v[136:139], v[192:195]
  v_mfma_f32_16x16x32_bf16 v[196:199], v[36:39], v[136:139], v[196:199]
  v_mfma_f32_16x16x32_bf16 v[200:203], v[40:43], v[136:139], v[200:203]
  buffer_load_dwordx4 v[120:123], v5, s[20:23], s51 offen sc1
  v_mfma_f32_16x16x32_bf16 v[204:207], v[44:47], v[136:139], v[204:207]
  v_mfma_f32_16x16x32_bf16 v[208:211], v[32:35], v[140:143], v[208:211]
  v_mfma_f32_16x16x32_bf16 v[212:215], v[36:39], v[140:143], v[212:215]
  buffer_load_dwordx4 v[124:127], v6, s[20:23], s51 offen sc1
  v_mfma_f32_16x16x32_bf16 v[216:219], v[40:43], v[140:143], v[216:219]
  v_mfma_f32_16x16x32_bf16 v[220:223], v[44:47], v[140:143], v[220:223]
  v_mfma_f32_16x16x32_bf16 v[224:227], v[32:35], v[144:147], v[224:227]
  buffer_load_dwordx4 v[128:131], v7, s[20:23], s51 offen sc1
  v_mfma_f32_16x16x32_bf16 v[228:231], v[36:39], v[144:147], v[228:231]
  v_mfma_f32_16x16x32_bf16 v[232:235], v[40:43], v[144:147], v[232:235]
  v_mfma_f32_16x16x32_bf16 v[236:239], v[44:47], v[144:147], v[236:239]
  v_mfma_f32_16x16x32_bf16 v[240:243], v[32:35], v[148:151], v[240:243]
  v_mfma_f32_16x16x32_bf16 v[244:247], v[36:39], v[148:151], v[244:247]
  v_mfma_f32_16x16x32_bf16 v[248:251], v[40:43], v[148:151], v[248:251]
  v_mfma_f32_16x16x32_bf16 v[252:255], v[44:47], v[148:151], v[252:255]
  s_waitcnt vmcnt(5)
  v_mfma_f32_16x16x32_bf16 v[176:179], v[48:51], v[152:155], v[176:179]
  s_and_b32 s34, s35, 1048592
  s_cbranch_scc0 L_hok2
  s_call_b64 s[100:101], L_hrdy_go
L_hok2:
  buffer_load_dwordx4 v[132:135], v3, s[20:23], s52 offen sc1
  v_mfma_f32_16x16x32_bf16 v[180:183], v[52:55], v[152:155], v[180:183]
  v_mfma_f32_16x16x32_bf16 v[184:187], v[56:59], v[152:155], v[184:187]
  v_mfma_f32_16x16x32_bf16 v[188:191], v[60:63], v[152:155], v[188:191]
  buffer_load_dwordx4 v[136:139], v4, s[20:23], s52 offen sc1
  v_mfma_f32_16x16x32_bf16 v[192:195], v[48:51], v[156:159], v[192:195]
  v_mfma_f32_16x16x32_bf16 v[196:199], v[52:55], v[156:159], v[196:199]
  v_mfma_f32_16x16x32_bf16 v[200:203], v[56:59], v[156:159], v[200:203]
  buffer_load_dwordx4 v[140:143], v5, s[20:23], s52 offen sc1
  v_mfma_f32_16x16x32_bf16 v[204:207], v[60:63], v[156:159], v[204:207]
  v_mfma_f32_16x16x32_bf16 v[208:211], v[48:51], v[160:163], v[208:211]
  v_mfma_f32_16x16x32_bf16 v[212:215], v[52:55], v[160:163], v[212:215]
  buffer_load_dwordx4 v[144:147], v6, s[20:23], s52 offen sc1
  v_mfma_f32_16x16x32_bf16 v[216:219], v[56:59], v[160:163], v[216:219]
  v_mfma_f32_16x16x32_bf16 v[220:223], v[60:63], v[160:163], v[220:223]
  v_mfma_f32_16x16x32_bf16 v[224:227], v[48:51], v[164:167], v[224:227]
  buffer_load_dwordx4 v[148:151], v7, s[20:23], s52 offen sc1
  v_mfma_f32_16x16x32_bf16 v[228:231], v[52:55], v[164:167], v[228:231]
  v_mfma_f32_16x16x32_bf16 v[232:235], v[56:59], v[164:167], v[232:235]
  v_mfma_f32_16x16x32_bf16 v[236:239], v[60:63], v[164:167], v[236:239]
  v_mfma_f32_16x16x32_bf16 v[240:243], v[48:51], v[168:171], v[240:243]
  v_mfma_f32_16x16x32_bf16 v[244:247], v[52:55], v[168:171], v[244:247]
  v_mfma_f32_16x16x32_bf16 v[248:251], v[56:59], v[168:171], v[248:251]
  v_mfma_f32_16x16x32_bf16 v[252:255], v[60:63], v[168:171], v[252:255]
  s_waitcnt vmcnt(5)
  v_mfma_f32_16x16x32_bf16 v[176:179], v[64:67], v[112:115], v[176:179]
  s_and_b32 s34, s35, 2097184
  s_cbranch_scc0 L_hok3
  s_call_b64 s[100:101], L_hrdy_go
L_hok3:
  buffer_load_dwordx4 v[152:155], v3, s[20:23], s53 offen sc1
  v_mfma_f32_16x16x32_bf16 v[180:183], v[68:71], v[112:115], v[180:183]
  v_mfma_f32_16x16x32_bf16 v[184:187], v[72:75], v[112:115], v[184:187]
  v_mfma_f32_16x16x32_bf16 v[188:191], v[76:79], v[112:115], v[188:191]
  buffer_load_dwordx4 v[156:159], v4, s[20:23], s53 offen sc1
  v_mfma_f32_16x16x32_bf16 v[192:195], v[64:67], v[116:119], v[192:195]
  v_mfma_f32_16x16x32_bf16 v[196:199], v[68:71], v[116:119], v[196:199]
  v_mfma_f32_16x16x32_bf16 v[200:203], v[72:75], v[116:119], v[200:203]
  buffer_load_dwordx4 v[160:163], v5, s[20:23], s53 offen sc1
  v_mfma_f32_16x16x32_bf16 v[204:207], v[76:79], v[116:119], v[204:207]
  v_mfma_f32_16x16x32_bf16 v[208:211], v[64:67], v[120:123], v[208:211]
  v_mfma_f32_16x16x32_bf16 v[212:215], v[68:71], v[120:123], v[212:215]
  buffer_load_dwordx4 v[164:167], v6, s[20:23], s53 offen sc1
  v_mfma_f32_16x16x32_bf16 v[216:219], v[72:75], v[120:123], v[216:219]
  v_mfma_f32_16x16x32_bf16 v[220:223], v[76:79], v[120:123], v[220:223]
  v_mfma_f32_16x16x32_bf16 v[224:227], v[64:67], v[124:127], v[224:227]
  buffer_load_dwordx4 v[168:171], v7, s[20:23], s53 offen sc1
  v_mfma_f32_16x16x32_bf16 v[228:231], v[68:71], v[124:127], v[228:231]
  v_mfma_f32_16x16x32_bf16 v[232:235], v[72:75], v[124:127], v[232:235]
  v_mfma_f32_16x16x32_bf16 v[236:239], v[76:79], v[124:127], v[236:239]
  v_mfma_f32_16x16x32_bf16 v[240:243], v[64:67], v[128:131], v[240:243]
  v_mfma_f32_16x16x32_bf16 v[244:247], v[68:71], v[128:131], v[244:247]
  v_mfma_f32_16x16x32_bf16 v[248:251], v[72:75], v[128:131], v[248:251]
  v_mfma_f32_16x16x32_bf16 v[252:255], v[76:79], v[128:131], v[252:255]
  s_waitcnt vmcnt(5)
  v_mfma_f32_16x16x32_bf16 v[176:179], v[80:83], v[132:135], v[176:179]
  s_and_b32 s34, s35, 4194368
  s_cbranch_scc0 L_hok4
  s_call_b64 s[100:101], L_hrdy_go
L_hok4:
  buffer_load_dwordx4 v[112:115], v3, s[20:23], s54 offen sc1
  v_mfma_f32_16x16x32_bf16 v[180:183], v[84:87], v[132:135], v[180:183]
  v_lshrrev_b32 v78, 3, v0
  v_mfma_f32_16x16x32_bf16 v[184:187], v[88:91], v[132:135], v[184:187]
  v_and_b32 v79, 7, v0
  v_mfma_f32_16x16x32_bf16 v[188:191], v[92:95], v[132:135], v[188:191]
  buffer_load_dwordx4 v[116:119], v4, s[20:23], s54 offen sc1
  v_mfma_f32_16x16x32_bf16 v[192:195], v[80:83], v[136:139], v[192:195]
  v_mul_u32_u24 v72, 1280, v78
  v_mfma_f32_16x16x32_bf16 v[196:199], v[84:87], v[136:139], v[196:199]
  v_lshl_add_u32 v72, v79, 4, v72
  v_mfma_f32_16x16x32_bf16 v[200:203], v[88:91], v[136:139], v[200:203]
  buffer_load_dwordx4 v[120:123], v5, s[20:23], s54 offen sc1
  v_mfma_f32_16x16x32_bf16 v[204:207], v[92:95], v[136:139], v[204:207]
  s_mul_i32 s36, s90, 20480
  s_add_u32 s36, s36, s94
  v_mfma_f32_16x16x32_bf16 v[208:211], v[80:83], v[140:143], v[208:211]
  buffer_load_dwordx4 v[64:67], v72, s[8:11], s36 offen
  v_mfma_f32_16x16x32_bf16 v[212:215], v[84:87], v[140:143], v[212:215]
  buffer_load_dwordx4 v[124:127], v6, s[20:23], s54 offen sc1
  v_mfma_f32_16x16x32_bf16 v[216:219], v[88:91], v[140:143], v[216:219]
  v_mfma_f32_16x16x32_bf16 v[220:223], v[92:95], v[140:143], v[220:223]
  v_mfma_f32_16x16x32_bf16 v[224:227], v[80:83], v[144:147], v[224:227]
  buffer_load_dwordx4 v[128:131], v7, s[20:23], s54 offen sc1
  v_mfma_f32_16x16x32_bf16 v[228:231], v[84:87], v[144:147], v[228:231]
  v_mfma_f32_16x16x32_bf16 v[232:235], v[88:91], v[144:147], v[232:235]
  v_mfma_f32_16x16x32_bf16 v[236:239], v[92:95], v[144:147], v[236:239]
  v_mfma_f32_16x16x32_bf16 v[240:243], v[80:83], v[148:151], v[240:243]
  v_mfma_f32_16x16x32_bf16 v[244:247], v[84:87], v[148:151], v[244:247]
  v_mfma_f32_16x16x32_bf16 v[248:251], v[88:91], v[148:151], v[248:251]
  v_mfma_f32_16x16x32_bf16 v[252:255], v[92:95], v[148:151], v[252:255]
  s_waitcnt vmcnt(6)
  v_mfma_f32_16x16x32_bf16 v[176:179], v[96:99], v[152:155], v[176:179]
  s_and_b32 s34, s35, 8388736
  s_cbranch_scc0 L_hok5
  s_call_b64 s[100:101], L_hrdy_go
L_hok5:
  buffer_load_dwordx4 v[132:135], v3, s[20:23], s55 offen sc1
  v_mfma_f32_16x16x32_bf16 v[180:183], v[100:103], v[152:155], v[180:183]
  ds_read_b64_tr_b16 v[16:17], v8 offset:24576
  v_mfma_f32_16x16x32_bf16 v[184:187], v[104:107], v[152:155], v[184:187]
  ds_read_b64_tr_b16 v[18:19], v8 offset:26624
  v_mfma_f32_16x16x32_bf16 v[188:191], v[108:111], v[152:155], v[188:191]
  buffer_load_dwordx4 v[136:139], v4, s[20:23], s55 offen sc1
  v_mfma_f32_16x16x32_bf16 v[192:195], v[96:99], v[156:159], v[192:195]
  ds_read_b64_tr_b16 v[20:21], v9 offset:24576
  v_mfma_f32_16x16x32_bf16 v[196:199], v[100:103], v[156:159], v[196:199]
  ds_read_b64_tr_b16 v[22:23], v9 offset:26624
  v_mfma_f32_16x16x32_bf16 v[200:203], v[104:107], v[156:159], v[200:203]
  buffer_load_dwordx4 v[140:143], v5, s[20:23], s55 offen sc1
  v_mfma_f32_16x16x32_bf16 v[204:207], v[108:111], v[156:159], v[204:207]
  ds_read_b64_tr_b16 v[24:25], v10 offset:24576
  v_mfma_f32_16x16x32_bf16 v[208:211], v[96:99], v[160:163], v[208:211]
  ds_read_b64_tr_b16 v[26:27], v10 offset:26624
  v_mfma_f32_16x16x32_bf16 v[212:215], v[100:103], v[160:163], v[212:215]
  buffer_load_dwordx4 v[144:147], v6, s[20:23], s55 offen sc1
  v_mfma_f32_16x16x32_bf16 v[216:219], v[104:107], v[160:163], v[216:219]
  ds_read_b64_tr_b16 v[28:29], v11 offset:24576
  v_mfma_f32_16x16x32_bf16 v[220:223], v[108:111], v[160:163], v[220:223]
  ds_read_b64_tr_b16 v[30:31], v11 offset:26624
  v_mfma_f32_16x16x32_bf16 v[224:227], v[96:99], v[164:167], v[224:227]
  buffer_load_dwordx4 v[148:151], v7, s[20:23], s55 offen sc1
  v_mfma_f32_16x16x32_bf16 v[228:231], v[100:103], v[164:167], v[228:231]
  v_mul_u32_u24 v74, 272, v78
  v_mfma_f32_16x16x32_bf16 v[232:235], v[104:107], v[164:167], v[232:235]
  v_lshl_add_u32 v74, v79, 5, v74
  v_mfma_f32_16x16x32_bf16 v[236:239], v[108:111], v[164:167], v[236:239]
  v_mul_u32_u24 v76, 144, v78
  v_mfma_f32_16x16x32_bf16 v[240:243], v[96:99], v[168:171], v[240:243]
  v_lshl_add_u32 v76, v79, 4, v76
  v_mfma_f32_16x16x32_bf16 v[244:247], v[100:103], v[168:171], v[244:247]
  v_add_u32 v76, 152064, v76
  v_mfma_f32_16x16x32_bf16 v[248:251], v[104:107], v[168:171], v[248:251]
  s_mov_b32 s12, s84
  s_mov_b32 s13, s85
  s_mov_b32 s14, 2621440
  s_mov_b32 s15, 0x20000
  v_mfma_f32_16x16x32_bf16 v[252:255], v[108:111], v[168:171], v[252:255]
  s_waitcnt vmcnt(5)
  s_waitcnt lgkmcnt(0)
  v_mfma_f32_16x16x32_bf16 v[176:179], v[16:19], v[112:115], v[176:179]
  s_and_b32 s34, s35, 16777472
  s_cbranch_scc0 L_hok6
  s_call_b64 s[100:101], L_hrdy_go
L_hok6:
  buffer_load_dwordx4 v[152:155], v3, s[20:23], s56 offen sc1
  v_mfma_f32_16x16x32_bf16 v[180:183], v[20:23], v[112:115], v[180:183]
  ds_read_b64_tr_b16 v[32:33], v8 offset:28672
  v_mfma_f32_16x16x32_bf16 v[184:187], v[24:27], v[112:115], v[184:187]
  ds_read_b64_tr_b16 v[34:35], v8 offset:30720
  v_mfma_f32_16x16x32_bf16 v[188:191], v[28:31], v[112:115], v[188:191]
  buffer_load_dwordx4 v[156:159], v4, s[20:23], s56 offen sc1
  v_mfma_f32_16x16x32_bf16 v[192:195], v[16:19], v[116:119], v[192:195]
  ds_read_b64_tr_b16 v[36:37], v9 offset:28672
  v_mfma_f32_16x16x32_bf16 v[196:199], v[20:23], v[116:119], v[196:199]
  ds_read_b64_tr_b16 v[38:39], v9 offset:30720
  v_mfma_f32_16x16x32_bf16 v[200:203], v[24:27], v[116:119], v[200:203]
  buffer_load_dwordx4 v[160:163], v5, s[20:23], s56 offen sc1
  v_mfma_f32_16x16x32_bf16 v[204:207], v[28:31], v[116:119], v[204:207]
  ds_read_b64_tr_b16 v[40:41], v10 offset:28672
  v_mfma_f32_16x16x32_bf16 v[208:211], v[16:19], v[120:123], v[208:211]
  ds_read_b64_tr_b16 v[42:43], v10 offset:30720
  v_mfma_f32_16x16x32_bf16 v[212:215], v[20:23], v[120:123], v[212:215]
  buffer_load_dwordx4 v[164:167], v6, s[20:23], s56 offen sc1
  v_mfma_f32_16x16x32_bf16 v[216:219], v[24:27], v[120:123], v[216:219]
  ds_read_b64_tr_b16 v[44:45], v11 offset:28672
  v_mfma_f32_16x16x32_bf16 v[220:223], v[28:31], v[120:123], v[220:223]
  ds_read_b64_tr_b16 v[46:47], v11 offset:30720
  v_mfma_f32_16x16x32_bf16 v[224:227], v[16:19], v[124:127], v[224:227]
  buffer_load_dwordx4 v[168:171], v7, s[20:23], s56 offen sc1
  v_mfma_f32_16x16x32_bf16 v[228:231], v[20:23], v[124:127], v[228:231]
  v_mfma_f32_16x16x32_bf16 v[232:235], v[24:27], v[124:127], v[232:235]
  v_mfma_f32_16x16x32_bf16 v[236:239], v[28:31], v[124:127], v[236:239]
  v_mfma_f32_16x16x32_bf16 v[240:243], v[16:19], v[128:131], v[240:243]
  v_mfma_f32_16x16x32_bf16 v[244:247], v[20:23], v[128:131], v[244:247]
  v_mfma_f32_16x16x32_bf16 v[248:251], v[24:27], v[128:131], v[248:251]
  v_mfma_f32_16x16x32_bf16 v[252:255], v[28:31], v[128:131], v[252:255]
  s_waitcnt vmcnt(5)
  s_waitcnt lgkmcnt(0)
  v_mfma_f32_16x16x32_bf16 v[176:179], v[32:35], v[132:135], v[176:179]
  s_and_b32 s34, s35, 33554944
  s_cbranch_scc0 L_hok7
  s_call_b64 s[100:101], L_hrdy_go
L_hok7:
  buffer_load_dwordx4 v[112:115], v3, s[20:23], s57 offen sc1
  v_mfma_f32_16x16x32_bf16 v[180:183], v[36:39], v[132:135], v[180:183]
  ds_read_b64_tr_b16 v[16:17], v8 offset:0
  v_mfma_f32_16x16x32_bf16 v[184:187], v[40:43], v[132:135], v[184:187]
  ds_read_b64_tr_b16 v[18:19], v8 offset:2048
  v_mfma_f32_16x16x32_bf16 v[188:191], v[44:47], v[132:135], v[188:191]
  buffer_load_dwordx4 v[116:119], v4, s[20:23], s57 offen sc1
  v_mfma_f32_16x16x32_bf16 v[192:195], v[32:35], v[136:139], v[192:195]
  ds_read_b64_tr_b16 v[20:21], v9 offset:0
  v_mfma_f32_16x16x32_bf16 v[196:199], v[36:39], v[136:139], v[196:199]
  ds_read_b64_tr_b16 v[22:23], v9 offset:2048
  v_mfma_f32_16x16x32_bf16 v[200:203], v[40:43], v[136:139], v[200:203]
  buffer_load_dwordx4 v[120:123], v5, s[20:23], s57 offen sc1
  v_mfma_f32_16x16x32_bf16 v[204:207], v[44:47], v[136:139], v[204:207]
  ds_read_b64_tr_b16 v[24:25], v10 offset:0
  v_mfma_f32_16x16x32_bf16 v[208:211], v[32:35], v[140:143], v[208:211]
  ds_read_b64_tr_b16 v[26:27], v10 offset:2048
  v_mfma_f32_16x16x32_bf16 v[212:215], v[36:39], v[140:143], v[212:215]
  buffer_load_dwordx4 v[124:127], v6, s[20:23], s57 offen sc1
  v_mfma_f32_16x16x32_bf16 v[216:219], v[40:43], v[140:143], v[216:219]
  ds_read_b64_tr_b16 v[28:29], v11 offset:0
  v_mfma_f32_16x16x32_bf16 v[220:223], v[44:47], v[140:143], v[220:223]
  ds_read_b64_tr_b16 v[30:31], v11 offset:2048
  v_mfma_f32_16x16x32_bf16 v[224:227], v[32:35], v[144:147], v[224:227]
  buffer_load_dwordx4 v[128:131], v7, s[20:23], s57 offen sc1
  v_mfma_f32_16x16x32_bf16 v[228:231], v[36:39], v[144:147], v[228:231]
  v_mfma_f32_16x16x32_bf16 v[232:235], v[40:43], v[144:147], v[232:235]
  v_mfma_f32_16x16x32_bf16 v[236:239], v[44:47], v[144:147], v[236:239]
  v_mfma_f32_16x16x32_bf16 v[240:243], v[32:35], v[148:151], v[240:243]
  v_mfma_f32_16x16x32_bf16 v[244:247], v[36:39], v[148:151], v[244:247]
  v_mfma_f32_16x16x32_bf16 v[248:251], v[40:43], v[148:151], v[248:251]
  v_mfma_f32_16x16x32_bf16 v[252:255], v[44:47], v[148:151], v[252:255]
  s_waitcnt vmcnt(5)
  s_waitcnt lgkmcnt(0)
  v_mfma_f32_16x16x32_bf16 v[176:179], v[16:19], v[152:155], v[176:179]
  s_and_b32 s34, s35, 67109888
  s_cbranch_scc0 L_hok8
  s_call_b64 s[100:101], L_hrdy_go
L_hok8:
  buffer_load_dwordx4 v[132:135], v3, s[20:23], s58 offen sc1
  v_mfma_f32_16x16x32_bf16 v[180:183], v[20:23], v[152:155], v[180:183]
  ds_read_b64_tr_b16 v[32:33], v8 offset:4096
  v_mfma_f32_16x16x32_bf16 v[184:187], v[24:27], v[152:155], v[184:187]
  ds_read_b64_tr_b16 v[34:35], v8 offset:6144
  v_mfma_f32_16x16x32_bf16 v[188:191], v[28:31], v[152:155], v[188:191]
  buffer_load_dwordx4 v[136:139], v4, s[20:23], s58 offen sc1
  v_mfma_f32_16x16x32_bf16 v[192:195], v[16:19], v[156:159], v[192:195]
  ds_read_b64_tr_b16 v[36:37], v9 offset:4096
  v_mfma_f32_16x16x32_bf16 v[196:199], v[20:23], v[156:159], v[196:199]
  ds_read_b64_tr_b16 v[38:39], v9 offset:6144
  v_mfma_f32_16x16x32_bf16 v[200:203], v[24:27], v[156:159], v[200:203]
  buffer_load_dwordx4 v[140:143], v5, s[20:23], s58 offen sc1
  v_mfma_f32_16x16x32_bf16 v[204:207], v[28:31], v[156:159], v[204:207]
  ds_read_b64_tr_b16 v[40:41], v10 offset:4096
  v_mfma_f32_16x16x32_bf16 v[208:211], v[16:19], v[160:163], v[208:211]
  ds_read_b64_tr_b16 v[42:43], v10 offset:6144
  s_barrier
  v_mfma_f32_16x16x32_bf16 v[212:215], v[20:23], v[160:163], v[212:215]
  buffer_load_dwordx4 v[144:147], v6, s[20:23], s58 offen sc1
  v_mfma_f32_16x16x32_bf16 v[216:219], v[24:27], v[160:163], v[216:219]
  ds_read_b64_tr_b16 v[44:45], v11 offset:4096
  v_mfma_f32_16x16x32_bf16 v[220:223], v[28:31], v[160:163], v[220:223]
  ds_read_b64_tr_b16 v[46:47], v11 offset:6144
  v_mfma_f32_16x16x32_bf16 v[224:227], v[16:19], v[164:167], v[224:227]
  buffer_load_dwordx4 v[148:151], v7, s[20:23], s58 offen sc1
  v_mfma_f32_16x16x32_bf16 v[228:231], v[20:23], v[164:167], v[228:231]
  v_mfma_f32_16x16x32_bf16 v[232:235], v[24:27], v[164:167], v[232:235]
  v_mfma_f32_16x16x32_bf16 v[236:239], v[28:31], v[164:167], v[236:239]
  v_mfma_f32_16x16x32_bf16 v[240:243], v[16:19], v[168:171], v[240:243]
  v_mfma_f32_16x16x32_bf16 v[244:247], v[20:23], v[168:171], v[244:247]
  v_mfma_f32_16x16x32_bf16 v[248:251], v[24:27], v[168:171], v[248:251]
  v_mfma_f32_16x16x32_bf16 v[252:255], v[28:31], v[168:171], v[252:255]
  s_waitcnt vmcnt(5)
  s_waitcnt lgkmcnt(0)
  v_mfma_f32_16x16x32_bf16 v[176:179], v[32:35], v[112:115], v[176:179]
  s_and_b32 s34, s35, 134219776
  s_cbranch_scc0 L_hok9
  s_call_b64 s[100:101], L_hrdy_go
L_hok9:
  buffer_load_dwordx4 v[152:155], v3, s[20:23], s59 offen sc1
  v_mfma_f32_16x16x32_bf16 v[180:183], v[36:39], v[112:115], v[180:183]
  ds_read_b64_tr_b16 v[16:17], v8 offset:8192
  v_mfma_f32_16x16x32_bf16 v[184:187], v[40:43], v[112:115], v[184:187]
  ds_read_b64_tr_b16 v[18:19], v8 offset:10240
  v_mfma_f32_16x16x32_bf16 v[188:191], v[44:47], v[112:115], v[188:191]
  buffer_load_dwordx4 v[156:159], v4, s[20:23], s59 offen sc1
  v_mfma_f32_16x16x32_bf16 v[192:195], v[32:35], v[116:119], v[192:195]
  ds_read_b64_tr_b16 v[20:21], v9 offset:8192
  v_mfma_f32_16x16x32_bf16 v[196:199], v[36:39], v[116:119], v[196:199]
  ds_read_b64_tr_b16 v[22:23], v9 offset:10240
  v_mfma_f32_16x16x32_bf16 v[200:203], v[40:43], v[116:119], v[200:203]
  buffer_load_dwordx4 v[160:163], v5, s[20:23], s59 offen sc1
  v_mfma_f32_16x16x32_bf16 v[204:207], v[44:47], v[116:119], v[204:207]
  ds_read_b64_tr_b16 v[24:25], v10 offset:8192
  v_mfma_f32_16x16x32_bf16 v[208:211], v[32:35], v[120:123], v[208:211]
  ds_read_b64_tr_b16 v[26:27], v10 offset:10240
  v_mfma_f32_16x16x32_bf16 v[212:215], v[36:39], v[120:123], v[212:215]
  buffer_load_dwordx4 v[164:167], v6, s[20:23], s59 offen sc1
  v_mfma_f32_16x16x32_bf16 v[216:219], v[40:43], v[120:123], v[216:219]
  ds_read_b64_tr_b16 v[28:29], v11 offset:8192
  v_mfma_f32_16x16x32_bf16 v[220:223], v[44:47], v[120:123], v[220:223]
  ds_read_b64_tr_b16 v[30:31], v11 offset:10240
  v_mfma_f32_16x16x32_bf16 v[224:227], v[32:35], v[124:127], v[224:227]
  buffer_load_dwordx4 v[168:171], v7, s[20:23], s59 offen sc1
  v_mfma_f32_16x16x32_bf16 v[228:231], v[36:39], v[124:127], v[228:231]
  v_mfma_f32_16x16x32_bf16 v[232:235], v[40:43], v[124:127], v[232:235]
  v_mfma_f32_16x16x32_bf16 v[236:239], v[44:47], v[124:127], v[236:239]
  v_mfma_f32_16x16x32_bf16 v[240:243], v[32:35], v[128:131], v[240:243]
  v_mfma_f32_16x16x32_bf16 v[244:247], v[36:39], v[128:131], v[244:247]
  v_mfma_f32_16x16x32_bf16 v[248:251], v[40:43], v[128:131], v[248:251]
  v_mfma_f32_16x16x32_bf16 v[252:255], v[44:47], v[128:131], v[252:255]
  s_waitcnt vmcnt(5)
  s_waitcnt lgkmcnt(0)
  v_mfma_f32_16x16x32_bf16 v[176:179], v[16:19], v[132:135], v[176:179]
  s_and_b32 s34, s35, 268439552
  s_cbranch_scc0 L_hok10
  s_call_b64 s[100:101], L_hrdy_go
L_hok10:
  buffer_load_dwordx4 v[112:115], v3, s[20:23], s42 offen sc1
  v_mfma_f32_16x16x32_bf16 v[180:183], v[20:23], v[132:135], v[180:183]
  ds_read_b64_tr_b16 v[32:33], v8 offset:12288
  v_mfma_f32_16x16x32_bf16 v[184:187], v[24:27], v[132:135], v[184:187]
  ds_read_b64_tr_b16 v[34:35], v8 offset:14336
  v_mfma_f32_16x16x32_bf16 v[188:191], v[28:31], v[132:135], v[188:191]
  buffer_load_dwordx4 v[116:119], v4, s[20:23], s42 offen sc1
  v_mfma_f32_16x16x32_bf16 v[192:195], v[16:19], v[136:139], v[192:195]
  ds_read_b64_tr_b16 v[36:37], v9 offset:12288
  v_mfma_f32_16x16x32_bf16 v[196:199], v[20:23], v[136:139], v[196:199]
  ds_read_b64_tr_b16 v[38:39], v9 offset:14336
  v_mfma_f32_16x16x32_bf16 v[200:203], v[24:27], v[136:139], v[200:203]
  buffer_load_dwordx4 v[120:123], v5, s[20:23], s42 offen sc1
  v_mfma_f32_16x16x32_bf16 v[204:207], v[28:31], v[136:139], v[204:207]
  ds_read_b64_tr_b16 v[40:41], v10 offset:12288
  v_mfma_f32_16x16x32_bf16 v[208:211], v[16:19], v[140:143], v[208:211]
  ds_read_b64_tr_b16 v[42:43], v10 offset:14336
  v_mfma_f32_16x16x32_bf16 v[212:215], v[20:23], v[140:143], v[212:215]
  buffer_load_dwordx4 v[124:127], v6, s[20:23], s42 offen sc1
  v_mfma_f32_16x16x32_bf16 v[216:219], v[24:27], v[140:143], v[216:219]
  ds_read_b64_tr_b16 v[44:45], v11 offset:12288
  v_mfma_f32_16x16x32_bf16 v[220:223], v[28:31], v[140:143], v[220:223]
  ds_read_b64_tr_b16 v[46:47], v11 offset:14336
  v_mfma_f32_16x16x32_bf16 v[224:227], v[16:19], v[144:147], v[224:227]
  buffer_load_dwordx4 v[128:131], v7, s[20:23], s42 offen sc1
  v_mfma_f32_16x16x32_bf16 v[228:231], v[20:23], v[144:147], v[228:231]
  v_mfma_f32_16x16x32_bf16 v[232:235], v[24:27], v[144:147], v[232:235]
  v_mfma_f32_16x16x32_bf16 v[236:239], v[28:31], v[144:147], v[236:239]
  v_mfma_f32_16x16x32_bf16 v[240:243], v[16:19], v[148:151], v[240:243]
  v_mfma_f32_16x16x32_bf16 v[244:247], v[20:23], v[148:151], v[244:247]
  v_mfma_f32_16x16x32_bf16 v[248:251], v[24:27], v[148:151], v[248:251]
  v_mfma_f32_16x16x32_bf16 v[252:255], v[28:31], v[148:151], v[252:255]
  s_waitcnt vmcnt(5)
  s_waitcnt lgkmcnt(0)
  v_mfma_f32_16x16x32_bf16 v[176:179], v[32:35], v[152:155], v[176:179]
  s_and_b32 s34, s35, 536879104
  s_cbranch_scc0 L_hok11
  s_call_b64 s[100:101], L_hrdy_go
L_hok11:
  buffer_load_dwordx4 v[132:135], v3, s[20:23], s43 offen sc1
  v_mfma_f32_16x16x32_bf16 v[180:183], v[36:39], v[152:155], v[180:183]
  ds_read_b64_tr_b16 v[16:17], v8 offset:16384
  v_mfma_f32_16x16x32_bf16 v[184:187], v[40:43], v[152:155], v[184:187]
  ds_read_b64_tr_b16 v[18:19], v8 offset:18432
  v_mfma_f32_16x16x32_bf16 v[188:191], v[44:47], v[152:155], v[188:191]
  buffer_load_dwordx4 v[136:139], v4, s[20:23], s43 offen sc1
  v_mfma_f32_16x16x32_bf16 v[192:195], v[32:35], v[156:159], v[192:195]
  ds_read_b64_tr_b16 v[20:21], v9 offset:16384
  v_mfma_f32_16x16x32_bf16 v[196:199], v[36:39], v[156:159], v[196:199]
  ds_read_b64_tr_b16 v[22:23], v9 offset:18432
  v_mfma_f32_16x16x32_bf16 v[200:203], v[40:43], v[156:159], v[200:203]
  buffer_load_dwordx4 v[140:143], v5, s[20:23], s43 offen sc1
  v_mfma_f32_16x16x32_bf16 v[204:207], v[44:47], v[156:159], v[204:207]
  ds_read_b64_tr_b16 v[24:25], v10 offset:16384
  v_mfma_f32_16x16x32_bf16 v[208:211], v[32:35], v[160:163], v[208:211]
  ds_read_b64_tr_b16 v[26:27], v10 offset:18432
  v_mfma_f32_16x16x32_bf16 v[212:215], v[36:39], v[160:163], v[212:215]
  buffer_load_dwordx4 v[144:147], v6, s[20:23], s43 offen sc1
  v_mfma_f32_16x16x32_bf16 v[216:219], v[40:43], v[160:163], v[216:219]
  ds_read_b64_tr_b16 v[28:29], v11 offset:16384
  v_mfma_f32_16x16x32_bf16 v[220:223], v[44:47], v[160:163], v[220:223]
  ds_read_b64_tr_b16 v[30:31], v11 offset:18432
  v_mfma_f32_16x16x32_bf16 v[224:227], v[32:35], v[164:167], v[224:227]
  buffer_load_dwordx4 v[148:151], v7, s[20:23], s43 offen sc1
  v_mfma_f32_16x16x32_bf16 v[228:231], v[36:39], v[164:167], v[228:231]
  v_mfma_f32_16x16x32_bf16 v[232:235], v[40:43], v[164:167], v[232:235]
  v_mfma_f32_16x16x32_bf16 v[236:239], v[44:47], v[164:167], v[236:239]
  v_mfma_f32_16x16x32_bf16 v[240:243], v[32:35], v[168:171], v[240:243]
  v_mfma_f32_16x16x32_bf16 v[244:247], v[36:39], v[168:171], v[244:247]
  v_mfma_f32_16x16x32_bf16 v[248:251], v[40:43], v[168:171], v[248:251]
  v_mfma_f32_16x16x32_bf16 v[252:255], v[44:47], v[168:171], v[252:255]
  s_waitcnt vmcnt(5)
  s_waitcnt lgkmcnt(0)
  v_mfma_f32_16x16x32_bf16 v[176:179], v[16:19], v[112:115], v[176:179]
  ds_read_b64_tr_b16 v[32:33], v8 offset:20480
  v_mfma_f32_16x16x32_bf16 v[180:183], v[20:23], v[112:115], v[180:183]
  ds_read_b64_tr_b16 v[34:35], v8 offset:22528
  v_mfma_f32_16x16x32_bf16 v[184:187], v[24:27], v[112:115], v[184:187]
  ds_read_b64_tr_b16 v[36:37], v9 offset:20480
  v_mfma_f32_16x16x32_bf16 v[188:191], v[28:31], v[112:115], v[188:191]
  ds_read_b64_tr_b16 v[38:39], v9 offset:22528
  v_mfma_f32_16x16x32_bf16 v[192:195], v[16:19], v[116:119], v[192:195]
  ds_read_b64_tr_b16 v[40:41], v10 offset:20480
  v_mfma_f32_16x16x32_bf16 v[196:199], v[20:23], v[116:119], v[196:199]
  ds_read_b64_tr_b16 v[42:43], v10 offset:22528
  v_mfma_f32_16x16x32_bf16 v[200:203], v[24:27], v[116:119], v[200:203]
  ds_read_b64_tr_b16 v[44:45], v11 offset:20480
  v_mfma_f32_16x16x32_bf16 v[204:207], v[28:31], v[116:119], v[204:207]
  ds_read_b64_tr_b16 v[46:47], v11 offset:22528
  v_mfma_f32_16x16x32_bf16 v[208:211], v[16:19], v[120:123], v[208:211]
  v_and_b32 v14, 15, v1
  v_mfma_f32_16x16x32_bf16 v[212:215], v[20:23], v[120:123], v[212:215]
  v_mul_u32_u24 v14, 272, v14
  v_mfma_f32_16x16x32_bf16 v[216:219], v[24:27], v[120:123], v[216:219]
  v_lshrrev_b32 v15, 4, v1
  v_mfma_f32_16x16x32_bf16 v[220:223], v[28:31], v[120:123], v[220:223]
  v_lshl_add_u32 v14, v15, 4, v14
  v_mfma_f32_16x16x32_bf16 v[224:227], v[16:19], v[124:127], v[224:227]
  v_add_u32 v3, s95, v14
  v_mfma_f32_16x16x32_bf16 v[228:231], v[20:23], v[124:127], v[228:231]
  v_mfma_f32_16x16x32_bf16 v[232:235], v[24:27], v[124:127], v[232:235]
  v_mfma_f32_16x16x32_bf16 v[236:239], v[28:31], v[124:127], v[236:239]
  v_mfma_f32_16x16x32_bf16 v[240:243], v[16:19], v[128:131], v[240:243]
  v_mfma_f32_16x16x32_bf16 v[244:247], v[20:23], v[128:131], v[244:247]
  v_mfma_f32_16x16x32_bf16 v[248:251], v[24:27], v[128:131], v[248:251]
  v_mfma_f32_16x16x32_bf16 v[252:255], v[28:31], v[128:131], v[252:255]
  s_cmp_ge_u32 s26, 2
  s_cbranch_scc1 L_nls
  s_waitcnt vmcnt(0)
  s_waitcnt lgkmcnt(0)
  v_mfma_f32_16x16x32_bf16 v[176:179], v[32:35], v[132:135], v[176:179]
  v_mfma_f32_16x16x32_bf16 v[180:183], v[36:39], v[132:135], v[180:183]
  v_mfma_f32_16x16x32_bf16 v[184:187], v[40:43], v[132:135], v[184:187]
  v_mfma_f32_16x16x32_bf16 v[188:191], v[44:47], v[132:135], v[188:191]
  v_mfma_f32_16x16x32_bf16 v[192:195], v[32:35], v[136:139], v[192:195]
  v_mfma_f32_16x16x32_bf16 v[196:199], v[36:39], v[136:139], v[196:199]
  v_mfma_f32_16x16x32_bf16 v[200:203], v[40:43], v[136:139], v[200:203]
  v_mfma_f32_16x16x32_bf16 v[204:207], v[44:47], v[136:139], v[204:207]
  v_mfma_f32_16x16x32_bf16 v[208:211], v[32:35], v[140:143], v[208:211]
  ds_write_b128 v3, v[176:179] offset:0
  v_mfma_f32_16x16x32_bf16 v[212:215], v[36:39], v[140:143], v[212:215]
  v_mfma_f32_16x16x32_bf16 v[216:219], v[40:43], v[140:143], v[216:219]
  ds_write_b128 v3, v[180:183] offset:64
  v_mfma_f32_16x16x32_bf16 v[220:223], v[44:47], v[140:143], v[220:223]
  v_mfma_f32_16x16x32_bf16 v[224:227], v[32:35], v[144:147], v[224:227]
  ds_write_b128 v3, v[184:187] offset:128
  v_mfma_f32_16x16x32_bf16 v[228:231], v[36:39], v[144:147], v[228:231]
  v_mfma_f32_16x16x32_bf16 v[232:235], v[40:43], v[144:147], v[232:235]
  ds_write_b128 v3, v[188:191] offset:192
  v_mfma_f32_16x16x32_bf16 v[236:239], v[44:47], v[144:147], v[236:239]
  v_mfma_f32_16x16x32_bf16 v[240:243], v[32:35], v[148:151], v[240:243]
  ds_write_b128 v3, v[192:195] offset:4352
  v_mfma_f32_16x16x32_bf16 v[244:247], v[36:39], v[148:151], v[244:247]
  v_mfma_f32_16x16x32_bf16 v[248:251], v[40:43], v[148:151], v[248:251]
  ds_write_b128 v3, v[196:199] offset:4416
  v_mfma_f32_16x16x32_bf16 v[252:255], v[44:47], v[148:151], v[252:255]
  ds_write_b128 v3, v[200:203] offset:4480
  ds_write_b128 v3, v[204:207] offset:4544
  ds_write_b128 v3, v[208:211] offset:8704
  ds_write_b128 v3, v[212:215] offset:8768
  ds_write_b128 v3, v[216:219] offset:8832
  ds_write_b128 v3, v[220:223] offset:8896
  ds_write_b128 v3, v[224:227] offset:13056
  ds_write_b128 v3, v[228:231] offset:13120
  ds_write_b128 v3, v[232:235] offset:13184
  ds_write_b128 v3, v[236:239] offset:13248
  ds_write_b128 v3, v[240:243] offset:17408
  ds_write_b128 v3, v[244:247] offset:17472
  ds_write_b128 v3, v[248:251] offset:17536
  ds_write_b128 v3, v[252:255] offset:17600
  s_branch L_nle
L_nls:
  s_waitcnt lgkmcnt(0)
  ds_write_b128 v3, v[176:179] offset:0
  ds_write_b128 v3, v[180:183] offset:64
  ds_write_b128 v3, v[184:187] offset:128
  ds_write_b128 v3, v[188:191] offset:192
  ds_write_b128 v3, v[192:195] offset:4352
  ds_write_b128 v3, v[196:199] offset:4416
  ds_write_b128 v3, v[200:203] offset:4480
  ds_write_b128 v3, v[204:207] offset:4544
  ds_write_b128 v3, v[208:211] offset:8704
  ds_write_b128 v3, v[212:215] offset:8768
  ds_write_b128 v3, v[216:219] offset:8832
  ds_write_b128 v3, v[220:223] offset:8896
  ds_write_b128 v3, v[224:227] offset:13056
  ds_write_b128 v3, v[228:231] offset:13120
  ds_write_b128 v3, v[232:235] offset:13184
  ds_write_b128 v3, v[236:239] offset:13248
  ds_write_b128 v3, v[240:243] offset:17408
  ds_write_b128 v3, v[244:247] offset:17472
  ds_write_b128 v3, v[248:251] offset:17536
  ds_write_b128 v3, v[252:255] offset:17600
L_nle:
  s_branch L_join
L_g2:
  s_add_u32 s98, s96, 0
  s_sub_u32 s97, s98, 54
  s_cmp_ge_u32 s98, 54
  s_cselect_b32 s98, s97, s98
  s_mul_i32 s98, s98, 40960
  s_add_u32 s98, s98, s94
  s_add_u32 m0, s95, 0
  s_nop 0
  buffer_load_dwordx4 v3, s[16:19], s98 offen lds
  s_add_u32 m0, s95, 1024
  s_nop 0
  buffer_load_dwordx4 v4, s[16:19], s98 offen lds
  s_add_u32 m0, s95, 2048
  s_nop 0
  buffer_load_dwordx4 v5, s[16:19], s98 offen lds
  s_add_u32 m0, s95, 3072
  s_nop 0
  buffer_load_dwordx4 v6, s[16:19], s98 offen lds
  s_add_u32 m0, s95, 4096
  s_nop 0
  buffer_load_dwordx4 v7, s[16:19], s98 offen lds
  s_waitcnt vmcnt(2)
  s_add_u32 s98, s96, 4
  s_sub_u32 s97, s98, 54
  s_cmp_ge_u32 s98, 54
  s_cselect_b32 s98, s97, s98
  s_mul_i32 s98, s98, 40960
  s_add_u32 s98, s98, s94
  s_add_u32 m0, s95, 5120
  s_nop 0
  buffer_load_dwordx4 v3, s[16:19], s98 offen lds
  s_add_u32 m0, s95, 6144
  s_nop 0
  buffer_load_dwordx4 v4, s[16:19], s98 offen lds
  s_add_u32 m0, s95, 7168
  s_nop 0
  buffer_load_dwordx4 v5, s[16:19], s98 offen lds
  s_add_u32 m0, s95, 8192
  s_nop 0
  buffer_load_dwordx4 v6, s[16:19], s98 offen lds
  s_add_u32 m0, s95, 9216
  s_nop 0
  buffer_load_dwordx4 v7, s[16:19], s98 offen lds
  s_waitcnt vmcnt(2)
  s_add_u32 s98, s96, 32
  s_sub_u32 s97, s98, 54
  s_cmp_ge_u32 s98, 54
  s_cselect_b32 s98, s97, s98
  s_mul_i32 s98, s98, 40960
  s_add_u32 s98, s98, s94
  s_add_u32 m0, s95, 10240
  s_nop 0
  buffer_load_dwordx4 v3, s[16:19], s98 offen lds
  s_add_u32 m0, s95, 11264
  s_nop 0
  buffer_load_dwordx4 v4, s[16:19], s98 offen lds
  s_add_u32 m0, s95, 12288
  s_nop 0
  buffer_load_dwordx4 v5, s[16:19], s98 offen lds
  s_add_u32 m0, s95, 13312
  s_nop 0
  buffer_load_dwordx4 v6, s[16:19], s98 offen lds
  s_add_u32 m0, s95, 14336
  s_nop 0
  buffer_load_dwordx4 v7, s[16:19], s98 offen lds
  s_waitcnt vmcnt(2)
  s_add_u32 s98, s96, 36
  s_sub_u32 s97, s98, 54
  s_cmp_ge_u32 s98, 54
  s_cselect_b32 s98, s97, s98
  s_mul_i32 s98, s98, 40960
  s_add_u32 s98, s98, s94
  s_add_u32 m0, s95, 15360
  s_nop 0
  buffer_load_dwordx4 v3, s[16:19], s98 offen lds
  s_add_u32 m0, s95, 16384
  s_nop 0
  buffer_load_dwordx4 v4, s[16:19], s98 offen lds
  s_add_u32 m0, s95, 17408
  s_nop 0
  buffer_load_dwordx4 v5, s[16:19], s98 offen lds
  s_add_u32 m0, s95, 18432
  s_nop 0
  buffer_load_dwordx4 v6, s[16:19], s98 offen lds
  s_add_u32 m0, s95, 19456
  s_nop 0
  buffer_load_dwordx4 v7, s[16:19], s98 offen lds
  s_waitcnt vmcnt(2)
  s_add_u32 s98, s96, 40
  s_sub_u32 s97, s98, 54
  s_cmp_ge_u32 s98, 54
  s_cselect_b32 s98, s97, s98
  s_mul_i32 s98, s98, 40960
  s_add_u32 s98, s98, s94
  s_add_u32 m0, s95, 20480
  s_nop 0
  buffer_load_dwordx4 v3, s[16:19], s98 offen lds
  s_add_u32 m0, s95, 21504
  s_nop 0
  buffer_load_dwordx4 v4, s[16:19], s98 offen lds
  s_add_u32 m0, s95, 22528
  s_nop 0
  buffer_load_dwordx4 v5, s[16:19], s98 offen lds
  s_add_u32 m0, s95, 23552
  s_nop 0
  buffer_load_dwordx4 v6, s[16:19], s98 offen lds
  s_add_u32 m0, s95, 24576
  s_nop 0
  buffer_load_dwordx4 v7, s[16:19], s98 offen lds
  s_waitcnt vmcnt(2)
  s_add_u32 s98, s96, 28
  s_sub_u32 s97, s98, 54
  s_cmp_ge_u32 s98, 54
  s_cselect_b32 s98, s97, s98
  s_mul_i32 s98, s98, 40960
  s_add_u32 s98, s98, s94
  s_add_u32 m0, s95, 25600
  s_nop 0
  buffer_load_dwordx4 v3, s[16:19], s98 offen lds
  s_add_u32 m0, s95, 26624
  s_nop 0
  buffer_load_dwordx4 v4, s[16:19], s98 offen lds
  s_add_u32 m0, s95, 27648
  s_nop 0
  buffer_load_dwordx4 v5, s[16:19], s98 offen lds
  s_add_u32 m0, s95, 28672
  s_nop 0
  buffer_load_dwordx4 v6, s[16:19], s98 offen lds
  s_add_u32 m0, s95, 29696
  s_nop 0
  buffer_load_dwordx4 v7, s[16:19], s98 offen lds
  s_waitcnt vmcnt(0)
L_g2b:
  s_setprio 3
  v_lshrrev_b32 v173, 2, v1
  v_mul_u32_u24 v172, 160, v173
  v_and_b32 v173, 3, v1
  v_lshl_add_u32 v172, v173, 3, v172
  v_add_u32 v172, s95, v172
  ds_read_b64_tr_b16 v[8:9], v172 offset:0
  ds_read_b64_tr_b16 v[10:11], v172 offset:2560
  ds_read_b64_tr_b16 v[12:13], v172 offset:32
  ds_read_b64_tr_b16 v[14:15], v172 offset:2592
  ds_read_b64_tr_b16 v[16:17], v172 offset:64
  ds_read_b64_tr_b16 v[18:19], v172 offset:2624
  ds_read_b64_tr_b16 v[20:21], v172 offset:96
  ds_read_b64_tr_b16 v[22:23], v172 offset:2656
  ds_read_b64_tr_b16 v[24:25], v172 offset:128
  ds_read_b64_tr_b16 v[26:27], v172 offset:2688
  ds_read_b64_tr_b16 v[28:29], v172 offset:5120
  ds_read_b64_tr_b16 v[30:31], v172 offset:7680
  ds_read_b64_tr_b16 v[32:33], v172 offset:5152
  ds_read_b64_tr_b16 v[34:35], v172 offset:7712
  ds_read_b64_tr_b16 v[36:37], v172 offset:5184
  ds_read_b64_tr_b16 v[38:39], v172 offset:7744
  ds_read_b64_tr_b16 v[40:41], v172 offset:5216
  ds_read_b64_tr_b16 v[42:43], v172 offset:7776
  ds_read_b64_tr_b16 v[44:45], v172 offset:5248
  ds_read_b64_tr_b16 v[46:47], v172 offset:7808
  s_waitcnt vmcnt(2) lgkmcnt(10)
  s_add_u32 s98, s96, 8
  s_sub_u32 s97, s98, 54
  s_cmp_ge_u32 s98, 54
  s_cselect_b32 s98, s97, s98
  s_mul_i32 s98, s98, 40960
  s_add_u32 s98, s98, s94
  s_add_u32 m0, s95, 0
  s_nop 0
  buffer_load_dwordx4 v3, s[16:19], s98 offen lds
  s_add_u32 m0, s95, 1024
  s_nop 0
  buffer_load_dwordx4 v4, s[16:19], s98 offen lds
  s_add_u32 m0, s95, 2048
  s_nop 0
  buffer_load_dwordx4 v5, s[16:19], s98 offen lds
  s_add_u32 m0, s95, 3072
  s_nop 0
  buffer_load_dwordx4 v6, s[16:19], s98 offen lds
  s_add_u32 m0, s95, 4096
  s_nop 0
  buffer_load_dwordx4 v7, s[16:19], s98 offen lds
  ds_read_b64_tr_b16 v[48:49], v172 offset:10240
  ds_read_b64_tr_b16 v[50:51], v172 offset:12800
  ds_read_b64_tr_b16 v[52:53], v172 offset:10272
  ds_read_b64_tr_b16 v[54:55], v172 offset:12832
  ds_read_b64_tr_b16 v[56:57], v172 offset:10304
  ds_read_b64_tr_b16 v[58:59], v172 offset:12864
  ds_read_b64_tr_b16 v[60:61], v172 offset:10336
  ds_read_b64_tr_b16 v[62:63], v172 offset:12896
  ds_read_b64_tr_b16 v[64:65], v172 offset:10368
  ds_read_b64_tr_b16 v[66:67], v172 offset:12928
  s_waitcnt vmcnt(2) lgkmcnt(10)
  s_add_u32 s98, s96, 12
  s_sub_u32 s97, s98, 54
  s_cmp_ge_u32 s98, 54
  s_cselect_b32 s98, s97, s98
  s_mul_i32 s98, s98, 40960
  s_add_u32 s98, s98, s94
  s_add_u32 m0, s95, 5120
  s_nop 0
  buffer_load_dwordx4 v3, s[16:19], s98 offen lds
  s_add_u32 m0, s95, 6144
  s_nop 0
  buffer_load_dwordx4 v4, s[16:19], s98 offen lds
  s_add_u32 m0, s95, 7168
  s_nop 0
  buffer_load_dwordx4 v5, s[16:19], s98 offen lds
  s_add_u32 m0, s95, 8192
  s_nop 0
  buffer_load_dwordx4 v6, s[16:19], s98 offen lds
  s_add_u32 m0, s95, 9216
  s_nop 0
  buffer_load_dwordx4 v7, s[16:19], s98 offen lds
  ds_read_b64_tr_b16 v[68:69], v172 offset:15360
  ds_read_b64_tr_b16 v[70:71], v172 offset:17920
  ds_read_b64_tr_b16 v[72:73], v172 offset:15392
  ds_read_b64_tr_b16 v[74:75], v172 offset:17952
  ds_read_b64_tr_b16 v[76:77], v172 offset:15424
  ds_read_b64_tr_b16 v[78:79], v172 offset:17984
  ds_read_b64_tr_b16 v[80:81], v172 offset:15456
  ds_read_b64_tr_b16 v[82:83], v172 offset:18016
  ds_read_b64_tr_b16 v[84:85], v172 offset:15488
  ds_read_b64_tr_b16 v[86:87], v172 offset:18048
  s_waitcnt vmcnt(2) lgkmcnt(10)
  s_add_u32 s98, s96, 16
  s_sub_u32 s97, s98, 54
  s_cmp_ge_u32 s98, 54
  s_cselect_b32 s98, s97, s98
  s_mul_i32 s98, s98, 40960
  s_add_u32 s98, s98, s94
  s_add_u32 m0, s95, 10240
  s_nop 0
  buffer_load_dwordx4 v3, s[16:19], s98 offen lds
  s_add_u32 m0, s95, 11264
  s_nop 0
  buffer_load_dwordx4 v4, s[16:19], s98 offen lds
  s_add_u32 m0, s95, 12288
  s_nop 0
  buffer_load_dwordx4 v5, s[16:19], s98 offen lds
  s_add_u32 m0, s95, 13312
  s_nop 0
  buffer_load_dwordx4 v6, s[16:19], s98 offen lds
  s_add_u32 m0, s95, 14336
  s_nop 0
  buffer_load_dwordx4 v7, s[16:19], s98 offen lds
  ds_read_b64_tr_b16 v[88:89], v172 offset:20480
  ds_read_b64_tr_b16 v[90:91], v172 offset:23040
  ds_read_b64_tr_b16 v[92:93], v172 offset:20512
  ds_read_b64_tr_b16 v[94:95], v172 offset:23072
  ds_read_b64_tr_b16 v[96:97], v172 offset:20544
  ds_read_b64_tr_b16 v[98:99], v172 offset:23104
  ds_read_b64_tr_b16 v[100:101], v172 offset:20576
  ds_read_b64_tr_b16 v[102:103], v172 offset:23136
  ds_read_b64_tr_b16 v[104:105], v172 offset:20608
  ds_read_b64_tr_b16 v[106:107], v172 offset:23168
  s_waitcnt vmcnt(2) lgkmcnt(10)
  s_add_u32 s98, s96, 20
  s_sub_u32 s97, s98, 54
  s_cmp_ge_u32 s98, 54
  s_cselect_b32 s98, s97, s98
  s_mul_i32 s98, s98, 40960
  s_add_u32 s98, s98, s94
  s_add_u32 m0, s95, 15360
  s_nop 0
  buffer_load_dwordx4 v3, s[16:19], s98 offen lds
  s_add_u32 m0, s95, 16384
  s_nop 0
  buffer_load_dwordx4 v4, s[16:19], s98 offen lds
  s_add_u32 m0, s95, 17408
  s_nop 0
  buffer_load_dwordx4 v5, s[16:19], s98 offen lds
  s_add_u32 m0, s95, 18432
  s_nop 0
  buffer_load_dwordx4 v6, s[16:19], s98 offen lds
  s_add_u32 m0, s95, 19456
  s_nop 0
  buffer_load_dwordx4 v7, s[16:19], s98 offen lds
  s_waitcnt vmcnt(2) lgkmcnt(0)
  s_add_u32 s98, s96, 24
  s_sub_u32 s97, s98, 54
  s_cmp_ge_u32 s98, 54
  s_cselect_b32 s98, s97, s98
  s_mul_i32 s98, s98, 40960
  s_add_u32 s98, s98, s94
  s_add_u32 m0, s95, 20480
  s_nop 0
  buffer_load_dwordx4 v3, s[16:19], s98 offen lds
  s_add_u32 m0, s95, 21504
  s_nop 0
  buffer_load_dwordx4 v4, s[16:19], s98 offen lds
  s_add_u32 m0, s95, 22528
  s_nop 0
  buffer_load_dwordx4 v5, s[16:19], s98 offen lds
  s_add_u32 m0, s95, 23552
  s_nop 0
  buffer_load_dwordx4 v6, s[16:19], s98 offen lds
  s_add_u32 m0, s95, 24576
  s_nop 0
  buffer_load_dwordx4 v7, s[16:19], s98 offen lds
  s_mov_b32 s27, 450560
  v_min_u32 v174, 13, v1
  v_lshlrev_b32 v174, 2, v174
  v_add_u32 v174, s96, v174
  v_subrev_u32 v175, 54, v174
  v_min_u32 v174, v174, v175
  v_lshlrev_b32 v174, 7, v174
  s_mov_b32 s34, 1
  s_mov_b32 s47, 100000
  s_call_b64 s[100:101], L_ordy_go
  v_add_u32 v173, 55296, v2
  s_add_u32 s32, s96, 0
  s_sub_u32 s97, s32, 54
  s_cmp_ge_u32 s32, 54
  s_cselect_b32 s32, s97, s32
  s_mul_i32 s32, s32, 1024
  s_add_u32 s32, s32, s93
  s_add_u32 s33, s32, 110592
  buffer_load_dwordx4 v[108:111], v2, s[20:23], s32 offen sc1
  buffer_load_dwordx4 v[112:115], v173, s[20:23], s32 offen sc1
  buffer_load_dwordx4 v[116:119], v2, s[20:23], s33 offen sc1
  buffer_load_dwordx4 v[120:123], v173, s[20:23], s33 offen sc1
  s_and_b32 s34, s35, 2
  s_cbranch_scc0 L_oik1
  s_call_b64 s[100:101], L_ordy_go
L_oik1:
  s_add_u32 s32, s96, 4
  s_sub_u32 s97, s32, 54
  s_cmp_ge_u32 s32, 54
  s_cselect_b32 s32, s97, s32
  s_mul_i32 s32, s32, 1024
  s_add_u32 s32, s32, s93
  s_add_u32 s33, s32, 110592
  buffer_load_dwordx4 v[124:127], v2, s[20:23], s32 offen sc1
  buffer_load_dwordx4 v[128:131], v173, s[20:23], s32 offen sc1
  buffer_load_dwordx4 v[132:135], v2, s[20:23], s33 offen sc1
  buffer_load_dwordx4 v[136:139], v173, s[20:23], s33 offen sc1
  s_and_b32 s34, s35, 4
  s_cbranch_scc0 L_oik2
  s_call_b64 s[100:101], L_ordy_go
L_oik2:
  s_add_u32 s32, s96, 8
  s_sub_u32 s97, s32, 54
  s_cmp_ge_u32 s32, 54
  s_cselect_b32 s32, s97, s32
  s_mul_i32 s32, s32, 1024
  s_add_u32 s32, s32, s93
  s_add_u32 s33, s32, 110592
  buffer_load_dwordx4 v[140:143], v2, s[20:23], s32 offen sc1
  buffer_load_dwordx4 v[144:147], v173, s[20:23], s32 offen sc1
  buffer_load_dwordx4 v[148:151], v2, s[20:23], s33 offen sc1
  buffer_load_dwordx4 v[152:155], v173, s[20:23], s33 offen sc1
  s_and_b32 s34, s35, 8
  s_cbranch_scc0 L_oik3
  s_call_b64 s[100:101], L_ordy_go
L_oik3:
  s_add_u32 s32, s96, 12
  s_sub_u32 s97, s32, 54
  s_cmp_ge_u32 s32, 54
  s_cselect_b32 s32, s97, s32
  s_mul_i32 s32, s32, 1024
  s_add_u32 s32, s32, s93
  s_add_u32 s33, s32, 110592
  buffer_load_dwordx4 v[156:159], v2, s[20:23], s32 offen sc1
  buffer_load_dwordx4 v[160:163], v173, s[20:23], s32 offen sc1
  buffer_load_dwordx4 v[164:167], v2, s[20:23], s33 offen sc1
  buffer_load_dwordx4 v[168:171], v173, s[20:23], s33 offen sc1
  s_waitcnt vmcnt(12)
  v_mfma_f32_16x16x32_bf16 v[176:179], v[8:11], v[108:111], 0
  v_mfma_f32_16x16x32_bf16 v[180:183], v[12:15], v[108:111], 0
  v_mfma_f32_16x16x32_bf16 v[184:187], v[16:19], v[108:111], 0
  v_mfma_f32_16x16x32_bf16 v[188:191], v[20:23], v[108:111], 0
  v_mfma_f32_16x16x32_bf16 v[192:195], v[24:27], v[108:111], 0
  v_mfma_f32_16x16x32_bf16 v[196:199], v[8:11], v[112:115], 0
  v_mfma_f32_16x16x32_bf16 v[200:203], v[12:15], v[112:115], 0
  v_mfma_f32_16x16x32_bf16 v[204:207], v[16:19], v[112:115], 0
  v_mfma_f32_16x16x32_bf16 v[208:211], v[20:23], v[112:115], 0
  v_mfma_f32_16x16x32_bf16 v[212:215], v[24:27], v[112:115], 0
  v_mfma_f32_16x16x32_bf16 v[216:219], v[8:11], v[116:119], 0
  v_mfma_f32_16x16x32_bf16 v[220:223], v[12:15], v[116:119], 0
  v_mfma_f32_16x16x32_bf16 v[224:227], v[16:19], v[116:119], 0
  v_mfma_f32_16x16x32_bf16 v[228:231], v[20:23], v[116:119], 0
  v_mfma_f32_16x16x32_bf16 v[232:235], v[24:27], v[116:119], 0
  v_mfma_f32_16x16x32_bf16 v[236:239], v[8:11], v[120:123], 0
  v_mfma_f32_16x16x32_bf16 v[240:243], v[12:15], v[120:123], 0
  v_mfma_f32_16x16x32_bf16 v[244:247], v[16:19], v[120:123], 0
  v_mfma_f32_16x16x32_bf16 v[248:251], v[20:23], v[120:123], 0
  v_mfma_f32_16x16x32_bf16 v[252:255], v[24:27], v[120:123], 0
  s_waitcnt vmcnt(8)
  v_mfma_f32_16x16x32_bf16 v[176:179], v[28:31], v[124:127], v[176:179]
  ds_read_b64_tr_b16 v[8:9], v172 offset:0
  v_mfma_f32_16x16x32_bf16 v[180:183], v[32:35], v[124:127], v[180:183]
  ds_read_b64_tr_b16 v[10:11], v172 offset:2560
  v_mfma_f32_16x16x32_bf16 v[184:187], v[36:39], v[124:127], v[184:187]
  ds_read_b64_tr_b16 v[12:13], v172 offset:32
  v_mfma_f32_16x16x32_bf16 v[188:191], v[40:43], v[124:127], v[188:191]
  ds_read_b64_tr_b16 v[14:15], v172 offset:2592
  v_mfma_f32_16x16x32_bf16 v[192:195], v[44:47], v[124:127], v[192:195]
  ds_read_b64_tr_b16 v[16:17], v172 offset:64
  v_mfma_f32_16x16x32_bf16 v[196:199], v[28:31], v[128:131], v[196:199]
  ds_read_b64_tr_b16 v[18:19], v172 offset:2624
  v_mfma_f32_16x16x32_bf16 v[200:203], v[32:35], v[128:131], v[200:203]
  ds_read_b64_tr_b16 v[20:21], v172 offset:96
  v_mfma_f32_16x16x32_bf16 v[204:207], v[36:39], v[128:131], v[204:207]
  ds_read_b64_tr_b16 v[22:23], v172 offset:2656
  v_mfma_f32_16x16x32_bf16 v[208:211], v[40:43], v[128:131], v[208:211]
  ds_read_b64_tr_b16 v[24:25], v172 offset:128
  v_mfma_f32_16x16x32_bf16 v[212:215], v[44:47], v[128:131], v[212:215]
  ds_read_b64_tr_b16 v[26:27], v172 offset:2688
  v_mfma_f32_16x16x32_bf16 v[216:219], v[28:31], v[132:135], v[216:219]
  s_and_b32 s34, s35, 16
  s_cbranch_scc0 L_ook1
  s_call_b64 s[100:101], L_ordy_go
L_ook1:
  s_add_u32 s32, s96, 16
  s_sub_u32 s97, s32, 54
  s_cmp_ge_u32 s32, 54
  s_cselect_b32 s32, s97, s32
  s_mul_i32 s32, s32, 1024
  s_add_u32 s32, s32, s93
  s_add_u32 s33, s32, 110592
  buffer_load_dwordx4 v[108:111], v2, s[20:23], s32 offen sc1
  v_mfma_f32_16x16x32_bf16 v[220:223], v[32:35], v[132:135], v[220:223]
  buffer_load_dwordx4 v[112:115], v173, s[20:23], s32 offen sc1
  v_mfma_f32_16x16x32_bf16 v[224:227], v[36:39], v[132:135], v[224:227]
  buffer_load_dwordx4 v[116:119], v2, s[20:23], s33 offen sc1
  v_mfma_f32_16x16x32_bf16 v[228:231], v[40:43], v[132:135], v[228:231]
  buffer_load_dwordx4 v[120:123], v173, s[20:23], s33 offen sc1
  v_mfma_f32_16x16x32_bf16 v[232:235], v[44:47], v[132:135], v[232:235]
  v_mfma_f32_16x16x32_bf16 v[236:239], v[28:31], v[136:139], v[236:239]
  v_mfma_f32_16x16x32_bf16 v[240:243], v[32:35], v[136:139], v[240:243]
  v_mfma_f32_16x16x32_bf16 v[244:247], v[36:39], v[136:139], v[244:247]
  v_mfma_f32_16x16x32_bf16 v[248:251], v[40:43], v[136:139], v[248:251]
  v_mfma_f32_16x16x32_bf16 v[252:255], v[44:47], v[136:139], v[252:255]
  s_waitcnt vmcnt(8)
  s_waitcnt lgkmcnt(0)
  v_mfma_f32_16x16x32_bf16 v[176:179], v[8:11], v[140:143], v[176:179]
  ds_read_b64_tr_b16 v[28:29], v172 offset:5120
  v_mfma_f32_16x16x32_bf16 v[180:183], v[12:15], v[140:143], v[180:183]
  ds_read_b64_tr_b16 v[30:31], v172 offset:7680
  v_mfma_f32_16x16x32_bf16 v[184:187], v[16:19], v[140:143], v[184:187]
  ds_read_b64_tr_b16 v[32:33], v172 offset:5152
  v_mfma_f32_16x16x32_bf16 v[188:191], v[20:23], v[140:143], v[188:191]
  ds_read_b64_tr_b16 v[34:35], v172 offset:7712
  v_mfma_f32_16x16x32_bf16 v[192:195], v[24:27], v[140:143], v[192:195]
  ds_read_b64_tr_b16 v[36:37], v172 offset:5184
  v_mfma_f32_16x16x32_bf16 v[196:199], v[8:11], v[144:147], v[196:199]
  ds_read_b64_tr_b16 v[38:39], v172 offset:7744
  v_mfma_f32_16x16x32_bf16 v[200:203], v[12:15], v[144:147], v[200:203]
  ds_read_b64_tr_b16 v[40:41], v172 offset:5216
  v_mfma_f32_16x16x32_bf16 v[204:207], v[16:19], v[144:147], v[204:207]
  ds_read_b64_tr_b16 v[42:43], v172 offset:7776
  v_mfma_f32_16x16x32_bf16 v[208:211], v[20:23], v[144:147], v[208:211]
  ds_read_b64_tr_b16 v[44:45], v172 offset:5248
  v_mfma_f32_16x16x32_bf16 v[212:215], v[24:27], v[144:147], v[212:215]
  ds_read_b64_tr_b16 v[46:47], v172 offset:7808
  v_mfma_f32_16x16x32_bf16 v[216:219], v[8:11], v[148:151], v[216:219]
  s_and_b32 s34, s35, 32
  s_cbranch_scc0 L_ook2
  s_call_b64 s[100:101], L_ordy_go
L_ook2:
  s_add_u32 s32, s96, 20
  s_sub_u32 s97, s32, 54
  s_cmp_ge_u32 s32, 54
  s_cselect_b32 s32, s97, s32
  s_mul_i32 s32, s32, 1024
  s_add_u32 s32, s32, s93
  s_add_u32 s33, s32, 110592
  buffer_load_dwordx4 v[124:127], v2, s[20:23], s32 offen sc1
  v_mfma_f32_16x16x32_bf16 v[220:223], v[12:15], v[148:151], v[220:223]
  buffer_load_dwordx4 v[128:131], v173, s[20:23], s32 offen sc1
  v_mfma_f32_16x16x32_bf16 v[224:227], v[16:19], v[148:151], v[224:227]
  buffer_load_dwordx4 v[132:135], v2, s[20:23], s33 offen sc1
  v_mfma_f32_16x16x32_bf16 v[228:231], v[20:23], v[148:151], v[228:231]
  buffer_load_dwordx4 v[136:139], v173, s[20:23], s33 offen sc1
  v_mfma_f32_16x16x32_bf16 v[232:235], v[24:27], v[148:151], v[232:235]
  s_add_u32 s98, s96, 44
  s_sub_u32 s97, s98, 54
  s_cmp_ge_u32 s98, 54
  s_cselect_b32 s98, s97, s98
  s_mul_i32 s98, s98, 40960
  s_add_u32 s98, s98, s94
  s_add_u32 m0, s95, 0
  s_nop 0
  buffer_load_dwordx4 v3, s[16:19], s98 offen lds
  v_mfma_f32_16x16x32_bf16 v[236:239], v[8:11], v[152:155], v[236:239]
  s_add_u32 m0, s95, 1024
  s_nop 0
  buffer_load_dwordx4 v4, s[16:19], s98 offen lds
  v_mfma_f32_16x16x32_bf16 v[240:243], v[12:15], v[152:155], v[240:243]
  s_add_u32 m0, s95, 2048
  s_nop 0
  buffer_load_dwordx4 v5, s[16:19], s98 offen lds
  v_mfma_f32_16x16x32_bf16 v[244:247], v[16:19], v[152:155], v[244:247]
  s_add_u32 m0, s95, 3072
  s_nop 0
  buffer_load_dwordx4 v6, s[16:19], s98 offen lds
  v_mfma_f32_16x16x32_bf16 v[248:251], v[20:23], v[152:155], v[248:251]
  s_add_u32 m0, s95, 4096
  s_nop 0
  buffer_load_dwordx4 v7, s[16:19], s98 offen lds
  v_mfma_f32_16x16x32_bf16 v[252:255], v[24:27], v[152:155], v[252:255]
  s_waitcnt vmcnt(13)
  s_waitcnt lgkmcnt(0)
  v_mfma_f32_16x16x32_bf16 v[176:179], v[28:31], v[156:159], v[176:179]
  ds_read_b64_tr_b16 v[8:9], v172 offset:10240
  v_mfma_f32_16x16x32_bf16 v[180:183], v[32:35], v[156:159], v[180:183]
  ds_read_b64_tr_b16 v[10:11], v172 offset:12800
  v_mfma_f32_16x16x32_bf16 v[184:187], v[36:39], v[156:159], v[184:187]
  ds_read_b64_tr_b16 v[12:13], v172 offset:10272
  v_mfma_f32_16x16x32_bf16 v[188:191], v[40:43], v[156:159], v[188:191]
  ds_read_b64_tr_b16 v[14:15], v172 offset:12832
  v_mfma_f32_16x16x32_bf16 v[192:195], v[44:47], v[156:159], v[192:195]
  ds_read_b64_tr_b16 v[16:17], v172 offset:10304
  v_mfma_f32_16x16x32_bf16 v[196:199], v[28:31], v[160:163], v[196:199]
  ds_read_b64_tr_b16 v[18:19], v172 offset:12864
  v_mfma_f32_16x16x32_bf16 v[200:203], v[32:35], v[160:163], v[200:203]
  ds_read_b64_tr_b16 v[20:21], v172 offset:10336
  v_mfma_f32_16x16x32_bf16 v[204:207], v[36:39], v[160:163], v[204:207]
  ds_read_b64_tr_b16 v[22:23], v172 offset:12896
  v_mfma_f32_16x16x32_bf16 v[208:211], v[40:43], v[160:163], v[208:211]
  ds_read_b64_tr_b16 v[24:25], v172 offset:10368
  v_mfma_f32_16x16x32_bf16 v[212:215], v[44:47], v[160:163], v[212:215]
  ds_read_b64_tr_b16 v[26:27], v172 offset:12928
  v_mfma_f32_16x16x32_bf16 v[216:219], v[28:31], v[164:167], v[216:219]
  s_and_b32 s34, s35, 64
  s_cbranch_scc0 L_ook3
  s_call_b64 s[100:101], L_ordy_go
L_ook3:
  s_add_u32 s32, s96, 24
  s_sub_u32 s97, s32, 54
  s_cmp_ge_u32 s32, 54
  s_cselect_b32 s32, s97, s32
  s_mul_i32 s32, s32, 1024
  s_add_u32 s32, s32, s93
  s_add_u32 s33, s32, 110592
  buffer_load_dwordx4 v[140:143], v2, s[20:23], s32 offen sc1
  v_mfma_f32_16x16x32_bf16 v[220:223], v[32:35], v[164:167], v[220:223]
  buffer_load_dwordx4 v[144:147], v173, s[20:23], s32 offen sc1
  v_mfma_f32_16x16x32_bf16 v[224:227], v[36:39], v[164:167], v[224:227]
  buffer_load_dwordx4 v[148:151], v2, s[20:23], s33 offen sc1
  v_mfma_f32_16x16x32_bf16 v[228:231], v[40:43], v[164:167], v[228:231]
  buffer_load_dwordx4 v[152:155], v173, s[20:23], s33 offen sc1
  v_mfma_f32_16x16x32_bf16 v[232:235], v[44:47], v[164:167], v[232:235]
  s_add_u32 s98, s96, 48
  s_sub_u32 s97, s98, 54
  s_cmp_ge_u32 s98, 54
  s_cselect_b32 s98, s97, s98
  s_mul_i32 s98, s98, 40960
  s_add_u32 s98, s98, s94
  s_add_u32 m0, s95, 5120
  s_nop 0
  buffer_load_dwordx4 v3, s[16:19], s98 offen lds
  v_mfma_f32_16x16x32_bf16 v[236:239], v[28:31], v[168:171], v[236:239]
  s_add_u32 m0, s95, 6144
  s_nop 0
  buffer_load_dwordx4 v4, s[16:19], s98 offen lds
  v_mfma_f32_16x16x32_bf16 v[240:243], v[32:35], v[168:171], v[240:243]
  s_add_u32 m0, s95, 7168
  s_nop 0
  buffer_load_dwordx4 v5, s[16:19], s98 offen lds
  v_mfma_f32_16x16x32_bf16 v[244:247], v[36:39], v[168:171], v[244:247]
  s_add_u32 m0, s95, 8192
  s_nop 0
  buffer_load_dwordx4 v6, s[16:19], s98 offen lds
  v_mfma_f32_16x16x32_bf16 v[248:251], v[40:43], v[168:171], v[248:251]
  s_add_u32 m0, s95, 9216
  s_nop 0
  buffer_load_dwordx4 v7, s[16:19], s98 offen lds
  v_mfma_f32_16x16x32_bf16 v[252:255], v[44:47], v[168:171], v[252:255]
  s_waitcnt vmcnt(18)
  s_waitcnt lgkmcnt(0)
  v_mfma_f32_16x16x32_bf16 v[176:179], v[8:11], v[108:111], v[176:179]
  ds_read_b64_tr_b16 v[28:29], v172 offset:15360
  v_mfma_f32_16x16x32_bf16 v[180:183], v[12:15], v[108:111], v[180:183]
  ds_read_b64_tr_b16 v[30:31], v172 offset:17920
  v_mfma_f32_16x16x32_bf16 v[184:187], v[16:19], v[108:111], v[184:187]
  ds_read_b64_tr_b16 v[32:33], v172 offset:15392
  v_mfma_f32_16x16x32_bf16 v[188:191], v[20:23], v[108:111], v[188:191]
  ds_read_b64_tr_b16 v[34:35], v172 offset:17952
  v_mfma_f32_16x16x32_bf16 v[192:195], v[24:27], v[108:111], v[192:195]
  ds_read_b64_tr_b16 v[36:37], v172 offset:15424
  v_mfma_f32_16x16x32_bf16 v[196:199], v[8:11], v[112:115], v[196:199]
  ds_read_b64_tr_b16 v[38:39], v172 offset:17984
  v_mfma_f32_16x16x32_bf16 v[200:203], v[12:15], v[112:115], v[200:203]
  ds_read_b64_tr_b16 v[40:41], v172 offset:15456
  v_mfma_f32_16x16x32_bf16 v[204:207], v[16:19], v[112:115], v[204:207]
  ds_read_b64_tr_b16 v[42:43], v172 offset:18016
  v_mfma_f32_16x16x32_bf16 v[208:211], v[20:23], v[112:115], v[208:211]
  ds_read_b64_tr_b16 v[44:45], v172 offset:15488
  v_mfma_f32_16x16x32_bf16 v[212:215], v[24:27], v[112:115], v[212:215]
  ds_read_b64_tr_b16 v[46:47], v172 offset:18048
  v_mfma_f32_16x16x32_bf16 v[216:219], v[8:11], v[116:119], v[216:219]
  s_and_b32 s34, s35, 128
  s_cbranch_scc0 L_ook4
  s_call_b64 s[100:101], L_ordy_go
L_ook4:
  s_add_u32 s32, s96, 28
  s_sub_u32 s97, s32, 54
  s_cmp_ge_u32 s32, 54
  s_cselect_b32 s32, s97, s32
  s_mul_i32 s32, s32, 1024
  s_add_u32 s32, s32, s93
  s_add_u32 s33, s32, 110592
  buffer_load_dwordx4 v[156:159], v2, s[20:23], s32 offen sc1
  v_mfma_f32_16x16x32_bf16 v[220:223], v[12:15], v[116:119], v[220:223]
  buffer_load_dwordx4 v[160:163], v173, s[20:23], s32 offen sc1
  v_mfma_f32_16x16x32_bf16 v[224:227], v[16:19], v[116:119], v[224:227]
  buffer_load_dwordx4 v[164:167], v2, s[20:23], s33 offen sc1
  v_mfma_f32_16x16x32_bf16 v[228:231], v[20:23], v[116:119], v[228:231]
  buffer_load_dwordx4 v[168:171], v173, s[20:23], s33 offen sc1
  v_mfma_f32_16x16x32_bf16 v[232:235], v[24:27], v[116:119], v[232:235]
  s_add_u32 s98, s96, 52
  s_sub_u32 s97, s98, 54
  s_cmp_ge_u32 s98, 54
  s_cselect_b32 s98, s97, s98
  s_mul_i32 s98, s98, 40960
  s_add_u32 s98, s98, s94
  s_cmp_lt_u32 s26, 2
  s_cselect_b32 s98, s98, 2147483392
  s_add_u32 m0, s95, 10240
  s_nop 0
  buffer_load_dwordx4 v3, s[16:19], s98 offen lds
  v_mfma_f32_16x16x32_bf16 v[236:239], v[8:11], v[120:123], v[236:239]
  s_add_u32 m0, s95, 11264
  s_nop 0
  buffer_load_dwordx4 v4, s[16:19], s98 offen lds
  v_mfma_f32_16x16x32_bf16 v[240:243], v[12:15], v[120:123], v[240:243]
  s_add_u32 m0, s95, 12288
  s_nop 0
  buffer_load_dwordx4 v5, s[16:19], s98 offen lds
  v_mfma_f32_16x16x32_bf16 v[244:247], v[16:19], v[120:123], v[244:247]
  s_add_u32 m0, s95, 13312
  s_nop 0
  buffer_load_dwordx4 v6, s[16:19], s98 offen lds
  v_mfma_f32_16x16x32_bf16 v[248:251], v[20:23], v[120:123], v[248:251]
  s_add_u32 m0, s95, 14336
  s_nop 0
  buffer_load_dwordx4 v7, s[16:19], s98 offen lds
  v_mfma_f32_16x16x32_bf16 v[252:255], v[24:27], v[120:123], v[252:255]
  s_waitcnt vmcnt(23)
  s_waitcnt lgkmcnt(0)
  v_mfma_f32_16x16x32_bf16 v[176:179], v[28:31], v[124:127], v[176:179]
  ds_read_b64_tr_b16 v[8:9], v172 offset:20480
  v_mfma_f32_16x16x32_bf16 v[180:183], v[32:35], v[124:127], v[180:183]
  ds_read_b64_tr_b16 v[10:11], v172 offset:23040
  v_mfma_f32_16x16x32_bf16 v[184:187], v[36:39], v[124:127], v[184:187]
  ds_read_b64_tr_b16 v[12:13], v172 offset:20512
  v_mfma_f32_16x16x32_bf16 v[188:191], v[40:43], v[124:127], v[188:191]
  ds_read_b64_tr_b16 v[14:15], v172 offset:23072
  v_mfma_f32_16x16x32_bf16 v[192:195], v[44:47], v[124:127], v[192:195]
  ds_read_b64_tr_b16 v[16:17], v172 offset:20544
  v_mfma_f32_16x16x32_bf16 v[196:199], v[28:31], v[128:131], v[196:199]
  ds_read_b64_tr_b16 v[18:19], v172 offset:23104
  v_mfma_f32_16x16x32_bf16 v[200:203], v[32:35], v[128:131], v[200:203]
  ds_read_b64_tr_b16 v[20:21], v172 offset:20576
  v_mfma_f32_16x16x32_bf16 v[204:207], v[36:39], v[128:131], v[204:207]
  ds_read_b64_tr_b16 v[22:23], v172 offset:23136
  v_mfma_f32_16x16x32_bf16 v[208:211], v[40:43], v[128:131], v[208:211]
  ds_read_b64_tr_b16 v[24:25], v172 offset:20608
  v_mfma_f32_16x16x32_bf16 v[212:215], v[44:47], v[128:131], v[212:215]
  ds_read_b64_tr_b16 v[26:27], v172 offset:23168
  v_mfma_f32_16x16x32_bf16 v[216:219], v[28:31], v[132:135], v[216:219]
  s_and_b32 s34, s35, 256
  s_cbranch_scc0 L_ook5
  s_call_b64 s[100:101], L_ordy_go
L_ook5:
  s_add_u32 s32, s96, 32
  s_sub_u32 s97, s32, 54
  s_cmp_ge_u32 s32, 54
  s_cselect_b32 s32, s97, s32
  s_mul_i32 s32, s32, 1024
  s_add_u32 s32, s32, s93
  s_add_u32 s33, s32, 110592
  buffer_load_dwordx4 v[108:111], v2, s[20:23], s32 offen sc1
  v_mfma_f32_16x16x32_bf16 v[220:223], v[32:35], v[132:135], v[220:223]
  buffer_load_dwordx4 v[112:115], v173, s[20:23], s32 offen sc1
  v_mfma_f32_16x16x32_bf16 v[224:227], v[36:39], v[132:135], v[224:227]
  buffer_load_dwordx4 v[116:119], v2, s[20:23], s33 offen sc1
  v_mfma_f32_16x16x32_bf16 v[228:231], v[40:43], v[132:135], v[228:231]
  buffer_load_dwordx4 v[120:123], v173, s[20:23], s33 offen sc1
  v_mfma_f32_16x16x32_bf16 v[232:235], v[44:47], v[132:135], v[232:235]
  v_mfma_f32_16x16x32_bf16 v[236:239], v[28:31], v[136:139], v[236:239]
  v_mfma_f32_16x16x32_bf16 v[240:243], v[32:35], v[136:139], v[240:243]
  v_mfma_f32_16x16x32_bf16 v[244:247], v[36:39], v[136:139], v[244:247]
  v_mfma_f32_16x16x32_bf16 v[248:251], v[40:43], v[136:139], v[248:251]
  v_mfma_f32_16x16x32_bf16 v[252:255], v[44:47], v[136:139], v[252:255]
  s_waitcnt vmcnt(18)
  s_waitcnt lgkmcnt(0)
  v_mfma_f32_16x16x32_bf16 v[176:179], v[8:11], v[140:143], v[176:179]
  ds_read_b64_tr_b16 v[28:29], v172 offset:25600
  v_mfma_f32_16x16x32_bf16 v[180:183], v[12:15], v[140:143], v[180:183]
  ds_read_b64_tr_b16 v[30:31], v172 offset:28160
  v_mfma_f32_16x16x32_bf16 v[184:187], v[16:19], v[140:143], v[184:187]
  ds_read_b64_tr_b16 v[32:33], v172 offset:25632
  v_mfma_f32_16x16x32_bf16 v[188:191], v[20:23], v[140:143], v[188:191]
  ds_read_b64_tr_b16 v[34:35], v172 offset:28192
  v_mfma_f32_16x16x32_bf16 v[192:195], v[24:27], v[140:143], v[192:195]
  ds_read_b64_tr_b16 v[36:37], v172 offset:25664
  v_mfma_f32_16x16x32_bf16 v[196:199], v[8:11], v[144:147], v[196:199]
  ds_read_b64_tr_b16 v[38:39], v172 offset:28224
  v_mfma_f32_16x16x32_bf16 v[200:203], v[12:15], v[144:147], v[200:203]
  ds_read_b64_tr_b16 v[40:41], v172 offset:25696
  v_mfma_f32_16x16x32_bf16 v[204:207], v[16:19], v[144:147], v[204:207]
  ds_read_b64_tr_b16 v[42:43], v172 offset:28256
  v_mfma_f32_16x16x32_bf16 v[208:211], v[20:23], v[144:147], v[208:211]
  ds_read_b64_tr_b16 v[44:45], v172 offset:25728
  v_mfma_f32_16x16x32_bf16 v[212:215], v[24:27], v[144:147], v[212:215]
  ds_read_b64_tr_b16 v[46:47], v172 offset:28288
  v_mfma_f32_16x16x32_bf16 v[216:219], v[8:11], v[148:151], v[216:219]
  s_and_b32 s34, s35, 512
  s_cbranch_scc0 L_ook6
  s_call_b64 s[100:101], L_ordy_go
L_ook6:
  s_add_u32 s32, s96, 36
  s_sub_u32 s97, s32, 54
  s_cmp_ge_u32 s32, 54
  s_cselect_b32 s32, s97, s32
  s_mul_i32 s32, s32, 1024
  s_add_u32 s32, s32, s93
  s_add_u32 s33, s32, 110592
  buffer_load_dwordx4 v[124:127], v2, s[20:23], s32 offen sc1
  v_mfma_f32_16x16x32_bf16 v[220:223], v[12:15], v[148:151], v[220:223]
  buffer_load_dwordx4 v[128:131], v173, s[20:23], s32 offen sc1
  v_mfma_f32_16x16x32_bf16 v[224:227], v[16:19], v[148:151], v[224:227]
  buffer_load_dwordx4 v[132:135], v2, s[20:23], s33 offen sc1
  v_mfma_f32_16x16x32_bf16 v[228:231], v[20:23], v[148:151], v[228:231]
  buffer_load_dwordx4 v[136:139], v173, s[20:23], s33 offen sc1
  v_mfma_f32_16x16x32_bf16 v[232:235], v[24:27], v[148:151], v[232:235]
  v_mfma_f32_16x16x32_bf16 v[236:239], v[8:11], v[152:155], v[236:239]
  v_mfma_f32_16x16x32_bf16 v[240:243], v[12:15], v[152:155], v[240:243]
  v_mfma_f32_16x16x32_bf16 v[244:247], v[16:19], v[152:155], v[244:247]
  v_mfma_f32_16x16x32_bf16 v[248:251], v[20:23], v[152:155], v[248:251]
  v_mfma_f32_16x16x32_bf16 v[252:255], v[24:27], v[152:155], v[252:255]
  s_waitcnt vmcnt(13)
  s_waitcnt lgkmcnt(0)
  v_mfma_f32_16x16x32_bf16 v[176:179], v[28:31], v[156:159], v[176:179]
  s_and_b32 s34, s35, 1024
  s_cbranch_scc0 L_ook7
  s_call_b64 s[100:101], L_ordy_go
L_ook7:
  s_add_u32 s32, s96, 40
  s_sub_u32 s97, s32, 54
  s_cmp_ge_u32 s32, 54
  s_cselect_b32 s32, s97, s32
  s_mul_i32 s32, s32, 1024
  s_add_u32 s32, s32, s93
  s_add_u32 s33, s32, 110592
  buffer_load_dwordx4 v[140:143], v2, s[20:23], s32 offen sc1
  v_mfma_f32_16x16x32_bf16 v[180:183], v[32:35], v[156:159], v[180:183]
  buffer_load_dwordx4 v[144:147], v173, s[20:23], s32 offen sc1
  v_mfma_f32_16x16x32_bf16 v[184:187], v[36:39], v[156:159], v[184:187]
  buffer_load_dwordx4 v[148:151], v2, s[20:23], s33 offen sc1
  v_mfma_f32_16x16x32_bf16 v[188:191], v[40:43], v[156:159], v[188:191]
  buffer_load_dwordx4 v[152:155], v173, s[20:23], s33 offen sc1
  v_mfma_f32_16x16x32_bf16 v[192:195], v[44:47], v[156:159], v[192:195]
  v_mfma_f32_16x16x32_bf16 v[196:199], v[28:31], v[160:163], v[196:199]
  v_mfma_f32_16x16x32_bf16 v[200:203], v[32:35], v[160:163], v[200:203]
  v_mfma_f32_16x16x32_bf16 v[204:207], v[36:39], v[160:163], v[204:207]
  v_mfma_f32_16x16x32_bf16 v[208:211], v[40:43], v[160:163], v[208:211]
  v_mfma_f32_16x16x32_bf16 v[212:215], v[44:47], v[160:163], v[212:215]
  v_mfma_f32_16x16x32_bf16 v[216:219], v[28:31], v[164:167], v[216:219]
  v_mfma_f32_16x16x32_bf16 v[220:223], v[32:35], v[164:167], v[220:223]
  v_mfma_f32_16x16x32_bf16 v[224:227], v[36:39], v[164:167], v[224:227]
  v_mfma_f32_16x16x32_bf16 v[228:231], v[40:43], v[164:167], v[228:231]
  v_mfma_f32_16x16x32_bf16 v[232:235], v[44:47], v[164:167], v[232:235]
  v_mfma_f32_16x16x32_bf16 v[236:239], v[28:31], v[168:171], v[236:239]
  v_mfma_f32_16x16x32_bf16 v[240:243], v[32:35], v[168:171], v[240:243]
  v_mfma_f32_16x16x32_bf16 v[244:247], v[36:39], v[168:171], v[244:247]
  v_mfma_f32_16x16x32_bf16 v[248:251], v[40:43], v[168:171], v[248:251]
  v_mfma_f32_16x16x32_bf16 v[252:255], v[44:47], v[168:171], v[252:255]
  s_waitcnt vmcnt(8)
  v_mfma_f32_16x16x32_bf16 v[176:179], v[48:51], v[108:111], v[176:179]
  s_and_b32 s34, s35, 2048
  s_cbranch_scc0 L_ook8
  s_call_b64 s[100:101], L_ordy_go
L_ook8:
  s_add_u32 s32, s96, 44
  s_sub_u32 s97, s32, 54
  s_cmp_ge_u32 s32, 54
  s_cselect_b32 s32, s97, s32
  s_mul_i32 s32, s32, 1024
  s_add_u32 s32, s32, s93
  s_add_u32 s33, s32, 110592
  buffer_load_dwordx4 v[156:159], v2, s[20:23], s32 offen sc1
  v_mfma_f32_16x16x32_bf16 v[180:183], v[52:55], v[108:111], v[180:183]
  buffer_load_dwordx4 v[160:163], v173, s[20:23], s32 offen sc1
  v_mfma_f32_16x16x32_bf16 v[184:187], v[56:59], v[108:111], v[184:187]
  buffer_load_dwordx4 v[164:167], v2, s[20:23], s33 offen sc1
  v_mfma_f32_16x16x32_bf16 v[188:191], v[60:63], v[108:111], v[188:191]
  buffer_load_dwordx4 v[168:171], v173, s[20:23], s33 offen sc1
  v_mfma_f32_16x16x32_bf16 v[192:195], v[64:67], v[108:111], v[192:195]
  v_mfma_f32_16x16x32_bf16 v[196:199], v[48:51], v[112:115], v[196:199]
  v_mfma_f32_16x16x32_bf16 v[200:203], v[52:55], v[112:115], v[200:203]
  v_mfma_f32_16x16x32_bf16 v[204:207], v[56:59], v[112:115], v[204:207]
  v_mfma_f32_16x16x32_bf16 v[208:211], v[60:63], v[112:115], v[208:211]
  v_mfma_f32_16x16x32_bf16 v[212:215], v[64:67], v[112:115], v[212:215]
  v_mfma_f32_16x16x32_bf16 v[216:219], v[48:51], v[116:119], v[216:219]
  s_barrier
  v_mfma_f32_16x16x32_bf16 v[220:223], v[52:55], v[116:119], v[220:223]
  v_mfma_f32_16x16x32_bf16 v[224:227], v[56:59], v[116:119], v[224:227]
  v_mfma_f32_16x16x32_bf16 v[228:231], v[60:63], v[116:119], v[228:231]
  v_mfma_f32_16x16x32_bf16 v[232:235], v[64:67], v[116:119], v[232:235]
  v_mfma_f32_16x16x32_bf16 v[236:239], v[48:51], v[120:123], v[236:239]
  v_mfma_f32_16x16x32_bf16 v[240:243], v[52:55], v[120:123], v[240:243]
  v_mfma_f32_16x16x32_bf16 v[244:247], v[56:59], v[120:123], v[244:247]
  v_mfma_f32_16x16x32_bf16 v[248:251], v[60:63], v[120:123], v[248:251]
  v_mfma_f32_16x16x32_bf16 v[252:255], v[64:67], v[120:123], v[252:255]
  s_waitcnt vmcnt(8)
  v_mfma_f32_16x16x32_bf16 v[176:179], v[68:71], v[124:127], v[176:179]
  s_and_b32 s34, s35, 4096
  s_cbranch_scc0 L_ook9
  s_call_b64 s[100:101], L_ordy_go
L_ook9:
  s_add_u32 s32, s96, 48
  s_sub_u32 s97, s32, 54
  s_cmp_ge_u32 s32, 54
  s_cselect_b32 s32, s97, s32
  s_mul_i32 s32, s32, 1024
  s_add_u32 s32, s32, s93
  s_add_u32 s33, s32, 110592
  buffer_load_dwordx4 v[108:111], v2, s[20:23], s32 offen sc1
  v_mfma_f32_16x16x32_bf16 v[180:183], v[72:75], v[124:127], v[180:183]
  buffer_load_dwordx4 v[112:115], v173, s[20:23], s32 offen sc1
  v_mfma_f32_16x16x32_bf16 v[184:187], v[76:79], v[124:127], v[184:187]
  buffer_load_dwordx4 v[116:119], v2, s[20:23], s33 offen sc1
  v_mfma_f32_16x16x32_bf16 v[188:191], v[80:83], v[124:127], v[188:191]
  buffer_load_dwordx4 v[120:123], v173, s[20:23], s33 offen sc1
  v_mfma_f32_16x16x32_bf16 v[192:195], v[84:87], v[124:127], v[192:195]
  v_mfma_f32_16x16x32_bf16 v[196:199], v[68:71], v[128:131], v[196:199]
  v_mfma_f32_16x16x32_bf16 v[200:203], v[72:75], v[128:131], v[200:203]
  v_mfma_f32_16x16x32_bf16 v[204:207], v[76:79], v[128:131], v[204:207]
  v_mfma_f32_16x16x32_bf16 v[208:211], v[80:83], v[128:131], v[208:211]
  v_mfma_f32_16x16x32_bf16 v[212:215], v[84:87], v[128:131], v[212:215]
  v_mfma_f32_16x16x32_bf16 v[216:219], v[68:71], v[132:135], v[216:219]
  v_mfma_f32_16x16x32_bf16 v[220:223], v[72:75], v[132:135], v[220:223]
  v_mfma_f32_16x16x32_bf16 v[224:227], v[76:79], v[132:135], v[224:227]
  v_mfma_f32_16x16x32_bf16 v[228:231], v[80:83], v[132:135], v[228:231]
  v_mfma_f32_16x16x32_bf16 v[232:235], v[84:87], v[132:135], v[232:235]
  v_mfma_f32_16x16x32_bf16 v[236:239], v[68:71], v[136:139], v[236:239]
  v_mfma_f32_16x16x32_bf16 v[240:243], v[72:75], v[136:139], v[240:243]
  v_mfma_f32_16x16x32_bf16 v[244:247], v[76:79], v[136:139], v[244:247]
  v_mfma_f32_16x16x32_bf16 v[248:251], v[80:83], v[136:139], v[248:251]
  v_mfma_f32_16x16x32_bf16 v[252:255], v[84:87], v[136:139], v[252:255]
  s_waitcnt vmcnt(8)
  v_mfma_f32_16x16x32_bf16 v[176:179], v[88:91], v[140:143], v[176:179]
  ds_read_b64_tr_b16 v[28:29], v172 offset:0
  v_mfma_f32_16x16x32_bf16 v[180:183], v[92:95], v[140:143], v[180:183]
  ds_read_b64_tr_b16 v[30:31], v172 offset:2560
  v_mfma_f32_16x16x32_bf16 v[184:187], v[96:99], v[140:143], v[184:187]
  ds_read_b64_tr_b16 v[32:33], v172 offset:32
  v_mfma_f32_16x16x32_bf16 v[188:191], v[100:103], v[140:143], v[188:191]
  ds_read_b64_tr_b16 v[34:35], v172 offset:2592
  v_mfma_f32_16x16x32_bf16 v[192:195], v[104:107], v[140:143], v[192:195]
  ds_read_b64_tr_b16 v[36:37], v172 offset:64
  v_mfma_f32_16x16x32_bf16 v[196:199], v[88:91], v[144:147], v[196:199]
  ds_read_b64_tr_b16 v[38:39], v172 offset:2624
  v_mfma_f32_16x16x32_bf16 v[200:203], v[92:95], v[144:147], v[200:203]
  ds_read_b64_tr_b16 v[40:41], v172 offset:96
  v_mfma_f32_16x16x32_bf16 v[204:207], v[96:99], v[144:147], v[204:207]
  ds_read_b64_tr_b16 v[42:43], v172 offset:2656
  v_mfma_f32_16x16x32_bf16 v[208:211], v[100:103], v[144:147], v[208:211]
  ds_read_b64_tr_b16 v[44:45], v172 offset:128
  v_mfma_f32_16x16x32_bf16 v[212:215], v[104:107], v[144:147], v[212:215]
  ds_read_b64_tr_b16 v[46:47], v172 offset:2688
  v_mfma_f32_16x16x32_bf16 v[216:219], v[88:91], v[148:151], v[216:219]
  s_and_b32 s34, s35, 8192
  s_cbranch_scc0 L_ook10
  s_call_b64 s[100:101], L_ordy_go
L_ook10:
  s_add_u32 s32, s96, 52
  s_sub_u32 s97, s32, 54
  s_cmp_ge_u32 s32, 54
  s_cselect_b32 s32, s97, s32
  s_mul_i32 s32, s32, 1024
  s_add_u32 s32, s32, s93
  s_cmp_lt_u32 s26, 2
  s_cselect_b32 s32, s32, 2147483392
  s_add_u32 s33, s32, 110592
  buffer_load_dwordx4 v[124:127], v2, s[20:23], s32 offen sc1
  v_mfma_f32_16x16x32_bf16 v[220:223], v[92:95], v[148:151], v[220:223]
  buffer_load_dwordx4 v[128:131], v173, s[20:23], s32 offen sc1
  v_mfma_f32_16x16x32_bf16 v[224:227], v[96:99], v[148:151], v[224:227]
  buffer_load_dwordx4 v[132:135], v2, s[20:23], s33 offen sc1
  v_mfma_f32_16x16x32_bf16 v[228:231], v[100:103], v[148:151], v[228:231]
  buffer_load_dwordx4 v[136:139], v173, s[20:23], s33 offen sc1
  v_mfma_f32_16x16x32_bf16 v[232:235], v[104:107], v[148:151], v[232:235]
  v_add_u32 v79, 0, v0
  v_mfma_f32_16x16x32_bf16 v[236:239], v[88:91], v[152:155], v[236:239]
  v_mul_u32_u24 v78, 6554, v79
  v_mfma_f32_16x16x32_bf16 v[240:243], v[92:95], v[152:155], v[240:243]
  v_lshrrev_b32 v78, 16, v78
  v_mfma_f32_16x16x32_bf16 v[244:247], v[96:99], v[152:155], v[244:247]
  v_mul_u32_u24 v72, 10, v78
  v_mfma_f32_16x16x32_bf16 v[248:251], v[100:103], v[152:155], v[248:251]
  v_sub_u32 v79, v79, v72
  v_mfma_f32_16x16x32_bf16 v[252:255], v[104:107], v[152:155], v[252:255]
  s_waitcnt vmcnt(8)
  s_waitcnt lgkmcnt(0)
  v_mfma_f32_16x16x32_bf16 v[176:179], v[28:31], v[156:159], v[176:179]
  ds_read_b64_tr_b16 v[8:9], v172 offset:5120
  v_mfma_f32_16x16x32_bf16 v[180:183], v[32:35], v[156:159], v[180:183]
  ds_read_b64_tr_b16 v[10:11], v172 offset:7680
  v_mfma_f32_16x16x32_bf16 v[184:187], v[36:39], v[156:159], v[184:187]
  ds_read_b64_tr_b16 v[12:13], v172 offset:5152
  v_mfma_f32_16x16x32_bf16 v[188:191], v[40:43], v[156:159], v[188:191]
  ds_read_b64_tr_b16 v[14:15], v172 offset:7712
  v_mfma_f32_16x16x32_bf16 v[192:195], v[44:47], v[156:159], v[192:195]
  ds_read_b64_tr_b16 v[16:17], v172 offset:5184
  v_mfma_f32_16x16x32_bf16 v[196:199], v[28:31], v[160:163], v[196:199]
  ds_read_b64_tr_b16 v[18:19], v172 offset:7744
  v_mfma_f32_16x16x32_bf16 v[200:203], v[32:35], v[160:163], v[200:203]
  ds_read_b64_tr_b16 v[20:21], v172 offset:5216
  v_mfma_f32_16x16x32_bf16 v[204:207], v[36:39], v[160:163], v[204:207]
  ds_read_b64_tr_b16 v[22:23], v172 offset:7776
  v_mfma_f32_16x16x32_bf16 v[208:211], v[40:43], v[160:163], v[208:211]
  ds_read_b64_tr_b16 v[24:25], v172 offset:5248
  v_mfma_f32_16x16x32_bf16 v[212:215], v[44:47], v[160:163], v[212:215]
  ds_read_b64_tr_b16 v[26:27], v172 offset:7808
  v_mfma_f32_16x16x32_bf16 v[216:219], v[28:31], v[164:167], v[216:219]
  v_mul_u32_u24 v72, 1280, v78
  v_mfma_f32_16x16x32_bf16 v[220:223], v[32:35], v[164:167], v[220:223]
  v_lshl_add_u32 v72, v79, 4, v72
  v_mfma_f32_16x16x32_bf16 v[224:227], v[36:39], v[164:167], v[224:227]
  s_mul_i32 s36, s90, 20480
  s_add_u32 s36, s36, s94
  v_mfma_f32_16x16x32_bf16 v[228:231], v[40:43], v[164:167], v[228:231]
  buffer_load_dwordx4 v[64:67], v72, s[8:11], s36 offen
  v_mfma_f32_16x16x32_bf16 v[232:235], v[44:47], v[164:167], v[232:235]
  v_mul_u32_u24 v74, 336, v78
  v_mfma_f32_16x16x32_bf16 v[236:239], v[28:31], v[168:171], v[236:239]
  v_lshl_add_u32 v74, v79, 5, v74
  v_mfma_f32_16x16x32_bf16 v[240:243], v[32:35], v[168:171], v[240:243]
  v_mul_u32_u24 v76, 176, v78
  v_mfma_f32_16x16x32_bf16 v[244:247], v[36:39], v[168:171], v[244:247]
  v_lshl_add_u32 v76, v79, 4, v76
  v_mfma_f32_16x16x32_bf16 v[248:251], v[40:43], v[168:171], v[248:251]
  v_add_u32 v76, 152064, v76
  v_mfma_f32_16x16x32_bf16 v[252:255], v[44:47], v[168:171], v[252:255]
  s_mov_b32 s12, s84
  s_mov_b32 s13, s85
  s_mov_b32 s14, 2621440
  s_mov_b32 s15, 0x20000
  s_waitcnt vmcnt(5)
  s_waitcnt lgkmcnt(0)
  v_mfma_f32_16x16x32_bf16 v[176:179], v[8:11], v[108:111], v[176:179]
  ds_read_b64_tr_b16 v[28:29], v172 offset:10240
  v_mfma_f32_16x16x32_bf16 v[180:183], v[12:15], v[108:111], v[180:183]
  ds_read_b64_tr_b16 v[30:31], v172 offset:12800
  v_mfma_f32_16x16x32_bf16 v[184:187], v[16:19], v[108:111], v[184:187]
  ds_read_b64_tr_b16 v[32:33], v172 offset:10272
  v_mfma_f32_16x16x32_bf16 v[188:191], v[20:23], v[108:111], v[188:191]
  ds_read_b64_tr_b16 v[34:35], v172 offset:12832
  v_mfma_f32_16x16x32_bf16 v[192:195], v[24:27], v[108:111], v[192:195]
  ds_read_b64_tr_b16 v[36:37], v172 offset:10304
  v_mfma_f32_16x16x32_bf16 v[196:199], v[8:11], v[112:115], v[196:199]
  ds_read_b64_tr_b16 v[38:39], v172 offset:12864
  v_mfma_f32_16x16x32_bf16 v[200:203], v[12:15], v[112:115], v[200:203]
  ds_read_b64_tr_b16 v[40:41], v172 offset:10336
  v_mfma_f32_16x16x32_bf16 v[204:207], v[16:19], v[112:115], v[204:207]
  ds_read_b64_tr_b16 v[42:43], v172 offset:12896
  v_mfma_f32_16x16x32_bf16 v[208:211], v[20:23], v[112:115], v[208:211]
  ds_read_b64_tr_b16 v[44:45], v172 offset:10368
  v_mfma_f32_16x16x32_bf16 v[212:215], v[24:27], v[112:115], v[212:215]
  ds_read_b64_tr_b16 v[46:47], v172 offset:12928
  v_mfma_f32_16x16x32_bf16 v[216:219], v[8:11], v[116:119], v[216:219]
  v_and_b32 v4, 15, v1
  v_mfma_f32_16x16x32_bf16 v[220:223], v[12:15], v[116:119], v[220:223]
  v_mul_u32_u24 v4, 336, v4
  v_mfma_f32_16x16x32_bf16 v[224:227], v[16:19], v[116:119], v[224:227]
  v_lshrrev_b32 v5, 4, v1
  v_mfma_f32_16x16x32_bf16 v[228:231], v[20:23], v[116:119], v[228:231]
  v_lshl_add_u32 v4, v5, 4, v4
  v_mfma_f32_16x16x32_bf16 v[232:235], v[24:27], v[116:119], v[232:235]
  v_add_u32 v3, s95, v4
  v_mfma_f32_16x16x32_bf16 v[236:239], v[8:11], v[120:123], v[236:239]
  v_mfma_f32_16x16x32_bf16 v[240:243], v[12:15], v[120:123], v[240:243]
  v_mfma_f32_16x16x32_bf16 v[244:247], v[16:19], v[120:123], v[244:247]
  v_mfma_f32_16x16x32_bf16 v[248:251], v[20:23], v[120:123], v[248:251]
  v_mfma_f32_16x16x32_bf16 v[252:255], v[24:27], v[120:123], v[252:255]
  s_cmp_ge_u32 s26, 2
  s_cbranch_scc1 L_ols
  s_waitcnt vmcnt(1)
  s_waitcnt lgkmcnt(0)
  v_mfma_f32_16x16x32_bf16 v[176:179], v[28:31], v[124:127], v[176:179]
  v_mfma_f32_16x16x32_bf16 v[180:183], v[32:35], v[124:127], v[180:183]
  v_mfma_f32_16x16x32_bf16 v[184:187], v[36:39], v[124:127], v[184:187]
  v_mfma_f32_16x16x32_bf16 v[188:191], v[40:43], v[124:127], v[188:191]
  v_mfma_f32_16x16x32_bf16 v[192:195], v[44:47], v[124:127], v[192:195]
  v_mfma_f32_16x16x32_bf16 v[196:199], v[28:31], v[128:131], v[196:199]
  v_mfma_f32_16x16x32_bf16 v[200:203], v[32:35], v[128:131], v[200:203]
  v_mfma_f32_16x16x32_bf16 v[204:207], v[36:39], v[128:131], v[204:207]
  v_mfma_f32_16x16x32_bf16 v[208:211], v[40:43], v[128:131], v[208:211]
  ds_write_b128 v3, v[176:179] offset:0
  v_mfma_f32_16x16x32_bf16 v[212:215], v[44:47], v[128:131], v[212:215]
  v_mfma_f32_16x16x32_bf16 v[216:219], v[28:31], v[132:135], v[216:219]
  ds_write_b128 v3, v[180:183] offset:64
  v_mfma_f32_16x16x32_bf16 v[220:223], v[32:35], v[132:135], v[220:223]
  v_mfma_f32_16x16x32_bf16 v[224:227], v[36:39], v[132:135], v[224:227]
  ds_write_b128 v3, v[184:187] offset:128
  v_mfma_f32_16x16x32_bf16 v[228:231], v[40:43], v[132:135], v[228:231]
  v_mfma_f32_16x16x32_bf16 v[232:235], v[44:47], v[132:135], v[232:235]
  ds_write_b128 v3, v[188:191] offset:192
  v_mfma_f32_16x16x32_bf16 v[236:239], v[28:31], v[136:139], v[236:239]
  v_mfma_f32_16x16x32_bf16 v[240:243], v[32:35], v[136:139], v[240:243]
  ds_write_b128 v3, v[192:195] offset:256
  v_mfma_f32_16x16x32_bf16 v[244:247], v[36:39], v[136:139], v[244:247]
  v_mfma_f32_16x16x32_bf16 v[248:251], v[40:43], v[136:139], v[248:251]
  ds_write_b128 v3, v[196:199] offset:5376
  v_mfma_f32_16x16x32_bf16 v[252:255], v[44:47], v[136:139], v[252:255]
  ds_write_b128 v3, v[200:203] offset:5440
  ds_write_b128 v3, v[204:207] offset:5504
  ds_write_b128 v3, v[208:211] offset:5568
  ds_write_b128 v3, v[212:215] offset:5632
  ds_write_b128 v3, v[216:219] offset:10752
  ds_write_b128 v3, v[220:223] offset:10816
  ds_write_b128 v3, v[224:227] offset:10880
  ds_write_b128 v3, v[228:231] offset:10944
  ds_write_b128 v3, v[232:235] offset:11008
  ds_write_b128 v3, v[236:239] offset:16128
  ds_write_b128 v3, v[240:243] offset:16192
  ds_write_b128 v3, v[244:247] offset:16256
  ds_write_b128 v3, v[248:251] offset:16320
  ds_write_b128 v3, v[252:255] offset:16384
  s_branch L_ole
L_ols:
  s_waitcnt lgkmcnt(0)
  ds_write_b128 v3, v[176:179] offset:0
  ds_write_b128 v3, v[180:183] offset:64
  ds_write_b128 v3, v[184:187] offset:128
  ds_write_b128 v3, v[188:191] offset:192
  ds_write_b128 v3, v[192:195] offset:256
  ds_write_b128 v3, v[196:199] offset:5376
  ds_write_b128 v3, v[200:203] offset:5440
  ds_write_b128 v3, v[204:207] offset:5504
  ds_write_b128 v3, v[208:211] offset:5568
  ds_write_b128 v3, v[212:215] offset:5632
  ds_write_b128 v3, v[216:219] offset:10752
  ds_write_b128 v3, v[220:223] offset:10816
  ds_write_b128 v3, v[224:227] offset:10880
  ds_write_b128 v3, v[228:231] offset:10944
  ds_write_b128 v3, v[232:235] offset:11008
  ds_write_b128 v3, v[236:239] offset:16128
  ds_write_b128 v3, v[240:243] offset:16192
  ds_write_b128 v3, v[244:247] offset:16256
  ds_write_b128 v3, v[248:251] offset:16320
  ds_write_b128 v3, v[252:255] offset:16384
L_ole:
  s_branch L_join
L_ordy:
  s_sleep 3
L_ordy_go:
  buffer_load_dword v175, v174, s[20:23], s27 offen sc1
  s_sub_u32 s47, s47, 1
  s_waitcnt vmcnt(0)
  v_cmp_ne_u32 vcc, s3, v175
  s_cmp_eq_u32 s47, 0
  s_cselect_b32 s35, 0, vcc_lo
  s_and_b32 s37, s35, s34
  s_cbranch_scc1 L_ordy
  s_setpc_b64 s[100:101]
L_hrdy:
L_hrdy_go:
  buffer_load_dword v14, v13, s[20:23], s27 offen sc1
  s_sub_u32 s47, s47, 1
  s_waitcnt vmcnt(0)
L_hrdy_chk:
  v_cmp_ne_u32 vcc, s3, v14
  s_cmp_eq_u32 s47, 0
  s_cselect_b32 s35, 0, vcc_lo
  s_and_b32 s33, s35, s34
  s_cbranch_scc1 L_hrdy
  s_setpc_b64 s[100:101]
L_kread:
  ds_read_b128 v[16:19], v2 offset:0
  ds_read_b128 v[48:51], v2 offset:8192
  ds_read_b128 v[80:83], v6 offset:16384
  ds_read_b128 v[112:115], v2 offset:24576
  ds_read_b128 v[20:23], v3 offset:0
  ds_read_b128 v[52:55], v3 offset:8192
  ds_read_b128 v[84:87], v7 offset:16384
  ds_read_b128 v[116:119], v3 offset:24576
  ds_read_b128 v[24:27], v4 offset:0
  ds_read_b128 v[56:59], v4 offset:8192
  ds_read_b128 v[88:91], v8 offset:16384
  ds_read_b128 v[120:123], v4 offset:24576
  ds_read_b128 v[28:31], v5 offset:0
  ds_read_b128 v[60:63], v5 offset:8192
  ds_read_b128 v[92:95], v9 offset:16384
  ds_read_b128 v[124:127], v5 offset:24576
  ds_read_b128 v[32:35], v2 offset:256
  ds_read_b128 v[64:67], v2 offset:8448
  ds_read_b128 v[96:99], v6 offset:16640
  ds_read_b128 v[128:131], v2 offset:24832
  ds_read_b128 v[36:39], v3 offset:256
  ds_read_b128 v[68:71], v3 offset:8448
  ds_read_b128 v[100:103], v7 offset:16640
  ds_read_b128 v[132:135], v3 offset:24832
  ds_read_b128 v[40:43], v4 offset:256
  ds_read_b128 v[72:75], v4 offset:8448
  ds_read_b128 v[104:107], v8 offset:16640
  ds_read_b128 v[136:139], v4 offset:24832
  ds_read_b128 v[44:47], v5 offset:256
  ds_read_b128 v[76:79], v5 offset:8448
  ds_read_b128 v[108:111], v9 offset:16640
  ds_read_b128 v[140:143], v5 offset:24832
  s_waitcnt lgkmcnt(0)
  s_setpc_b64 s[100:101]
L_kmm:
  v_mfma_f32_16x16x32_bf16 v[232:235], v[48:51], v[16:19], 0
  v_mfma_f32_16x16x32_bf16 v[236:239], v[80:83], v[16:19], 0
  v_mfma_f32_16x16x32_bf16 v[240:243], v[112:115], v[16:19], 0
  v_mfma_f32_16x16x32_bf16 v[232:235], v[52:55], v[20:23], v[232:235]
  v_mfma_f32_16x16x32_bf16 v[236:239], v[84:87], v[20:23], v[236:239]
  v_mfma_f32_16x16x32_bf16 v[240:243], v[116:119], v[20:23], v[240:243]
  v_mfma_f32_16x16x32_bf16 v[232:235], v[56:59], v[24:27], v[232:235]
  v_mfma_f32_16x16x32_bf16 v[236:239], v[88:91], v[24:27], v[236:239]
  v_mfma_f32_16x16x32_bf16 v[240:243], v[120:123], v[24:27], v[240:243]
  v_mfma_f32_16x16x32_bf16 v[232:235], v[60:63], v[28:31], v[232:235]
  v_mfma_f32_16x16x32_bf16 v[236:239], v[92:95], v[28:31], v[236:239]
  v_mfma_f32_16x16x32_bf16 v[240:243], v[124:127], v[28:31], v[240:243]
  s_setpc_b64 s[100:101]
L_kmm2:
  v_mfma_f32_16x16x32_bf16 v[232:235], v[64:67], v[32:35], v[232:235]
  v_mfma_f32_16x16x32_bf16 v[236:239], v[96:99], v[32:35], v[236:239]
  v_mfma_f32_16x16x32_bf16 v[240:243], v[128:131], v[32:35], v[240:243]
  v_mfma_f32_16x16x32_bf16 v[232:235], v[68:71], v[36:39], v[232:235]
  v_mfma_f32_16x16x32_bf16 v[236:239], v[100:103], v[36:39], v[236:239]
  v_mfma_f32_16x16x32_bf16 v[240:243], v[132:135], v[36:39], v[240:243]
  v_mfma_f32_16x16x32_bf16 v[232:235], v[72:75], v[40:43], v[232:235]
  v_mfma_f32_16x16x32_bf16 v[236:239], v[104:107], v[40:43], v[236:239]
  v_mfma_f32_16x16x32_bf16 v[240:243], v[136:139], v[40:43], v[240:243]
  v_mfma_f32_16x16x32_bf16 v[232:235], v[76:79], v[44:47], v[232:235]
  v_mfma_f32_16x16x32_bf16 v[236:239], v[108:111], v[44:47], v[236:239]
  v_mfma_f32_16x16x32_bf16 v[240:243], v[140:143], v[44:47], v[240:243]
  s_nop 7
  s_setpc_b64 s[100:101]
L_kfin0:
  v_lshlrev_b32 v13, 16, v13
  v_and_b32 v13, v229, v13
  v_add_f32 v232, v232, v13
  v_mov_b64 v[32:33], 0
  v_mov_b64 v[34:35], 0
  v_cvt_pk_bf16_f32 v16, v232, v32
  v_cvt_pk_bf16_f32 v17, v233, v232
  v_cvt_pk_bf16_f32 v18, v234, v233
  v_cvt_pk_bf16_f32 v19, v235, v234
  v_cvt_pk_bf16_f32 v20, v236, v32
  v_cvt_pk_bf16_f32 v21, v237, v236
  v_cvt_pk_bf16_f32 v22, v238, v237
  v_cvt_pk_bf16_f32 v23, v239, v238
  v_cvt_pk_bf16_f32 v24, v239, v239
  v_cvt_pk_bf16_f32 v28, v240, v241
  v_cvt_pk_bf16_f32 v29, v242, v243
  v_mov_b32 v25, v24
  v_mov_b32 v26, v24
  v_and_b32 v27, 0xffff0000, v24
  s_setpc_b64 s[100:101]
L_kfin1:
  ds_write_b128 v222, v[16:19] offset:64
  ds_write_b128 v222, v[20:23] offset:1088
  ds_write_b16 v222, v19 offset:82
  ds_write_b16 v222, v23 offset:1106
  ds_write_b32 v225, v28
  ds_write_b32 v226, v29
  s_mov_b32 exec_hi, 0
  ds_write_b128 v228, v[32:35]
  s_mov_b32 exec_lo, 0
  s_mov_b32 exec_hi, 0x80000000
  ds_write_b128 v222, v[24:27] offset:1104
  s_mov_b64 exec, -1
  s_waitcnt lgkmcnt(0)
  s_setpc_b64 s[100:101]
L_cprep0:
  v_and_b32 v2, 15, v1
  v_lshrrev_b32 v3, 4, v1
  v_lshlrev_b32 v4, 3, v3
  v_sub_u32 v4, v2, v4
  v_lshl_add_u32 v4, v4, 2, s46
  v_add_u32 v5, 104, v4
  v_add_u32 v6, 1000, v4
  v_add_u32 v7, 1896, v4
  ds_read2_b32 v[8:9], v7 offset0:70 offset1:68
  ds_read2_b32 v[10:11], v7 offset0:66 offset1:64
  ds_read2_b32 v[12:13], v7 offset0:38 offset1:36
  ds_read2_b32 v[14:15], v7 offset0:34 offset1:32
  ds_read2_b32 v[16:17], v7 offset0:6 offset1:4
  ds_read2_b32 v[18:19], v7 offset0:2 offset1:0
  ds_read2_b32 v[20:21], v6 offset0:198 offset1:196
  ds_read2_b32 v[22:23], v6 offset0:194 offset1:192
  ds_read2_b32 v[24:25], v6 offset0:166 offset1:164
  ds_read2_b32 v[26:27], v6 offset0:162 offset1:160
  ds_read2_b32 v[28:29], v6 offset0:134 offset1:132
  ds_read2_b32 v[30:31], v6 offset0:130 offset1:128
  ds_read2_b32 v[32:33], v6 offset0:102 offset1:100
  ds_read2_b32 v[34:35], v6 offset0:98 offset1:96
  ds_read2_b32 v[36:37], v6 offset0:70 offset1:68
  ds_read2_b32 v[38:39], v6 offset0:66 offset1:64
  ds_read2_b32 v[40:41], v6 offset0:38 offset1:36
  ds_read2_b32 v[42:43], v6 offset0:34 offset1:32
  ds_read2_b32 v[44:45], v6 offset0:6 offset1:4
  ds_read2_b32 v[46:47], v6 offset0:2 offset1:0
  ds_read2_b32 v[48:49], v5 offset0:198 offset1:196
  ds_read2_b32 v[50:51], v5 offset0:194 offset1:192
  ds_read2_b32 v[52:53], v5 offset0:166 offset1:164
  ds_read2_b32 v[54:55], v5 offset0:162 offset1:160
  ds_read2_b32 v[56:57], v5 offset0:134 offset1:132
  ds_read2_b32 v[58:59], v5 offset0:130 offset1:128
  ds_read2_b32 v[60:61], v5 offset0:102 offset1:100
  ds_read2_b32 v[62:63], v5 offset0:98 offset1:96
  ds_read2_b32 v[64:65], v5 offset0:70 offset1:68
  ds_read2_b32 v[66:67], v5 offset0:66 offset1:64
  ds_read2_b32 v[68:69], v5 offset0:38 offset1:36
  ds_read2_b32 v[70:71], v5 offset0:34 offset1:32
  ds_read2_b32 v[72:73], v5 offset0:6 offset1:4
  ds_read2_b32 v[74:75], v5 offset0:2 offset1:0
  s_waitcnt lgkmcnt(0)
  s_setpc_b64 s[100:101]
L_cprep1:
  v_and_b32 v2, 15, v1
  v_lshrrev_b32 v3, 4, v1
  v_lshlrev_b32 v5, 2, v3
  v_sub_u32 v5, v2, v5
  v_lshl_add_u32 v5, v5, 2, s46
  v_add_u32 v5, 2228, v5
  v_mov_b32 v6, s46
  ds_read_b32 v6, v6 offset:2556
  ds_read2_b32 v[80:81], v5 offset0:3 offset1:2
  ds_read2_b32 v[82:83], v5 offset0:1 offset1:0
  ds_read2_b32 v[84:85], v5 offset0:19 offset1:18
  ds_read2_b32 v[86:87], v5 offset0:17 offset1:16
  ds_read2_b32 v[88:89], v5 offset0:35 offset1:34
  ds_read2_b32 v[90:91], v5 offset0:33 offset1:32
  ds_read2_b32 v[92:93], v5 offset0:51 offset1:50
  ds_read2_b32 v[94:95], v5 offset0:49 offset1:48
  ds_read2_b32 v[96:97], v5 offset0:67 offset1:66
  ds_read2_b32 v[98:99], v5 offset0:65 offset1:64
  ds_read2_b32 v[100:101], v5 offset0:83 offset1:82
  ds_read2_b32 v[102:103], v5 offset0:81 offset1:80
  ds_read2_b32 v[104:105], v5 offset0:99 offset1:98
  ds_read2_b32 v[106:107], v5 offset0:97 offset1:96
  ds_read2_b32 v[108:109], v5 offset0:115 offset1:114
  ds_read2_b32 v[110:111], v5 offset0:113 offset1:112
  ds_read2_b32 v[112:113], v5 offset0:131 offset1:130
  ds_read2_b32 v[114:115], v5 offset0:129 offset1:128
  ds_read2_b32 v[116:117], v5 offset0:147 offset1:146
  ds_read2_b32 v[118:119], v5 offset0:145 offset1:144
  s_waitcnt lgkmcnt(0)
  v_and_b32 v6, 0xffff0000, v6
  v_lshrrev_b32 v7, 16, v6
  v_or_b32 v6, v6, v7
  v_and_b32 v76, v6, v204
  v_and_b32 v77, v6, v205
  v_and_b32 v78, v6, v206
  v_and_b32 v79, v6, v207
  s_setpc_b64 s[100:101]
L_ccon:
  v_and_b32 v2, 15, v1
  v_lshrrev_b32 v3, 4, v1
  v_lshlrev_b32 v3, 3, v3
  v_mov_b32 v4, 14336
  v_lshlrev_b32 v4, v2, v4
  v_lshrrev_b32 v4, v3, v4
  v_bfe_u32 v5, v4, 0, 2
  v_lshl_or_b32 v5, v5, 15, v5
  v_and_b32 v5, 0x10001, v5
  v_mul_u32_u24 v184, 0x3f80, v5
  v_bfe_u32 v5, v4, 2, 2
  v_lshl_or_b32 v5, v5, 15, v5
  v_and_b32 v5, 0x10001, v5
  v_mul_u32_u24 v185, 0x3f80, v5
  v_bfe_u32 v5, v4, 4, 2
  v_lshl_or_b32 v5, v5, 15, v5
  v_and_b32 v5, 0x10001, v5
  v_mul_u32_u24 v186, 0x3f80, v5
  v_bfe_u32 v5, v4, 6, 2
  v_lshl_or_b32 v5, v5, 15, v5
  v_and_b32 v5, 0x10001, v5
  v_mul_u32_u24 v187, 0x3f80, v5
  v_mov_b32 v4, 1984
  v_lshlrev_b32 v4, v2, v4
  v_lshrrev_b32 v4, v3, v4
  v_bfe_u32 v5, v4, 0, 2
  v_lshl_or_b32 v5, v5, 15, v5
  v_and_b32 v5, 0x10001, v5
  v_mul_u32_u24 v188, 0x3f80, v5
  v_bfe_u32 v5, v4, 2, 2
  v_lshl_or_b32 v5, v5, 15, v5
  v_and_b32 v5, 0x10001, v5
  v_mul_u32_u24 v189, 0x3f80, v5
  v_bfe_u32 v5, v4, 4, 2
  v_lshl_or_b32 v5, v5, 15, v5
  v_and_b32 v5, 0x10001, v5
  v_mul_u32_u24 v190, 0x3f80, v5
  v_bfe_u32 v5, v4, 6, 2
  v_lshl_or_b32 v5, v5, 15, v5
  v_and_b32 v5, 0x10001, v5
  v_mul_u32_u24 v191, 0x3f80, v5
  v_mov_b32 v4, 56
  v_lshlrev_b32 v4, v2, v4
  v_lshrrev_b32 v4, v3, v4
  v_bfe_u32 v5, v4, 0, 2
  v_lshl_or_b32 v5, v5, 15, v5
  v_and_b32 v5, 0x10001, v5
  v_mul_u32_u24 v192, 0x3f80, v5
  v_bfe_u32 v5, v4, 2, 2
  v_lshl_or_b32 v5, v5, 15, v5
  v_and_b32 v5, 0x10001, v5
  v_mul_u32_u24 v193, 0x3f80, v5
  v_bfe_u32 v5, v4, 4, 2
  v_lshl_or_b32 v5, v5, 15, v5
  v_and_b32 v5, 0x10001, v5
  v_mul_u32_u24 v194, 0x3f80, v5
  v_bfe_u32 v5, v4, 6, 2
  v_lshl_or_b32 v5, v5, 15, v5
  v_and_b32 v5, 0x10001, v5
  v_mul_u32_u24 v195, 0x3f80, v5
  v_mov_b32 v4, 4064
  v_lshlrev_b32 v4, v2, v4
  v_lshrrev_b32 v4, v3, v4
  v_bfe_u32 v5, v4, 0, 2
  v_lshl_or_b32 v5, v5, 15, v5
  v_and_b32 v5, 0x10001, v5
  v_mul_u32_u24 v196, 0x3f80, v5
  v_bfe_u32 v5, v4, 2, 2
  v_lshl_or_b32 v5, v5, 15, v5
  v_and_b32 v5, 0x10001, v5
  v_mul_u32_u24 v197, 0x3f80, v5
  v_bfe_u32 v5, v4, 4, 2
  v_lshl_or_b32 v5, v5, 15, v5
  v_and_b32 v5, 0x10001, v5
  v_mul_u32_u24 v198, 0x3f80, v5
  v_bfe_u32 v5, v4, 6, 2
  v_lshl_or_b32 v5, v5, 15, v5
  v_and_b32 v5, 0x10001, v5
  v_mul_u32_u24 v199, 0x3f80, v5
  v_mov_b32 v4, 8176
  v_lshlrev_b32 v4, v2, v4
  v_lshrrev_b32 v4, v3, v4
  v_bfe_u32 v5, v4, 0, 2
  v_lshl_or_b32 v5, v5, 15, v5
  v_and_b32 v5, 0x10001, v5
  v_mul_u32_u24 v200, 0x3f80, v5
  v_bfe_u32 v5, v4, 2, 2
  v_lshl_or_b32 v5, v5, 15, v5
  v_and_b32 v5, 0x10001, v5
  v_mul_u32_u24 v201, 0x3f80, v5
  v_bfe_u32 v5, v4, 4, 2
  v_lshl_or_b32 v5, v5, 15, v5
  v_and_b32 v5, 0x10001, v5
  v_mul_u32_u24 v202, 0x3f80, v5
  v_bfe_u32 v5, v4, 6, 2
  v_lshl_or_b32 v5, v5, 15, v5
  v_and_b32 v5, 0x10001, v5
  v_mul_u32_u24 v203, 0x3f80, v5
  v_mov_b32 v4, 12288
  v_lshlrev_b32 v4, v2, v4
  v_lshrrev_b32 v4, v3, v4
  v_bfe_u32 v5, v4, 0, 2
  v_lshl_or_b32 v5, v5, 15, v5
  v_and_b32 v5, 0x10001, v5
  v_mul_u32_u24 v204, 0xffff, v5
  v_bfe_u32 v5, v4, 2, 2
  v_lshl_or_b32 v5, v5, 15, v5
  v_and_b32 v5, 0x10001, v5
  v_mul_u32_u24 v205, 0xffff, v5
  v_bfe_u32 v5, v4, 4, 2
  v_lshl_or_b32 v5, v5, 15, v5
  v_and_b32 v5, 0x10001, v5
  v_mul_u32_u24 v206, 0xffff, v5
  v_bfe_u32 v5, v4, 6, 2
  v_lshl_or_b32 v5, v5, 15, v5
  v_and_b32 v5, 0x10001, v5
  v_mul_u32_u24 v207, 0xffff, v5
  s_setpc_b64 s[100:101]
L_kset:
  v_and_b32 v11, 15, v1
  v_lshrrev_b32 v12, 4, v1
  s_mov_b32 s27, 1126310144
  s_mov_b32 s28, 1842136388
  v_mov_b32 v244, s27
  v_mov_b32 v245, s28
  v_lshlrev_b32 v246, 2, v11
  v_lshrrev_b64 v[244:245], v246, v[244:245]
  v_and_b32 v244, 15, v244
  v_and_b32 v245, 7, v11
  v_lshlrev_b32 v245, 1, v245
  v_xor_b32 v245, v245, v12
  v_lshlrev_b32 v245, 4, v245
  v_lshl_add_u32 v245, v11, 9, v245
  v_add_u32 v2, s45, v245
  v_xor_b32 v3, 64, v2
  v_xor_b32 v4, 128, v2
  v_xor_b32 v5, 192, v2
  v_and_b32 v245, 7, v244
  v_lshlrev_b32 v245, 1, v245
  v_xor_b32 v245, v245, v12
  v_lshlrev_b32 v245, 4, v245
  v_lshl_add_u32 v245, v244, 9, v245
  v_add_u32 v6, s45, v245
  v_xor_b32 v7, 64, v6
  v_xor_b32 v8, 128, v6
  v_xor_b32 v9, 192, v6
  v_lshlrev_b32 v222, 6, v11
  v_lshl_add_u32 v222, v12, 4, v222
  v_add_u32 v222, s46, v222
  v_lshl_add_u32 v223, v12, 4, v11
  v_lshl_add_u32 v224, v12, 5, v11
  v_add_u32 v225, 560, v223
  v_add_u32 v226, 608, v223
  v_add_u32 v223, 592, v224
  v_add_u32 v224, 608, v224
  v_cmp_gt_u32 vcc, 32, v1
  v_min_u32 v227, 18, v1
  v_add_u32 v228, 129, v227
  v_cndmask_b32 v225, v223, v225, vcc
  v_cndmask_b32 v226, v224, v226, vcc
  v_cmp_gt_u32 vcc, 4, v227
  v_lshl_add_u32 v225, v225, 2, s46
  v_lshl_add_u32 v226, v226, 2, s46
  v_cndmask_b32 v228, v228, v227, vcc
  v_add_u32 v223, 137, v227
  v_cmp_gt_u32 vcc, 11, v227
  v_add_u32 v224, 145, v227
  s_nop 0
  v_cndmask_b32 v228, v223, v228, vcc
  v_cmp_gt_u32 vcc, 15, v227
  s_nop 1
  v_cndmask_b32 v228, v224, v228, vcc
  v_lshl_add_u32 v228, v228, 4, s46
  v_subrev_u32 v229, 1, v1
  v_ashrrev_i32 v229, 31, v229
  s_setpc_b64 s[100:101]
L_lnA:
  v_lshlrev_b32 v24, 16, v144
  v_and_b32 v25, 0xffff0000, v144
  v_lshlrev_b32 v26, 16, v145
  v_and_b32 v27, 0xffff0000, v145
  v_pk_add_f32 v[64:65], v[24:25], v[26:27]
  v_lshlrev_b32 v28, 16, v146
  v_and_b32 v29, 0xffff0000, v146
  v_pk_add_f32 v[64:65], v[64:65], v[28:29]
  v_lshlrev_b32 v30, 16, v147
  v_and_b32 v31, 0xffff0000, v147
  v_pk_add_f32 v[64:65], v[64:65], v[30:31]
  v_lshlrev_b32 v32, 16, v148
  v_and_b32 v33, 0xffff0000, v148
  v_pk_add_f32 v[64:65], v[64:65], v[32:33]
  v_lshlrev_b32 v34, 16, v149
  v_and_b32 v35, 0xffff0000, v149
  v_pk_add_f32 v[64:65], v[64:65], v[34:35]
  v_lshlrev_b32 v36, 16, v150
  v_and_b32 v37, 0xffff0000, v150
  v_pk_add_f32 v[64:65], v[64:65], v[36:37]
  v_lshlrev_b32 v38, 16, v151
  v_and_b32 v39, 0xffff0000, v151
  v_pk_add_f32 v[64:65], v[64:65], v[38:39]
  v_lshlrev_b32 v40, 16, v152
  v_and_b32 v41, 0xffff0000, v152
  v_pk_add_f32 v[64:65], v[64:65], v[40:41]
  v_lshlrev_b32 v42, 16, v153
  v_and_b32 v43, 0xffff0000, v153
  v_pk_add_f32 v[64:65], v[64:65], v[42:43]
  v_lshlrev_b32 v44, 16, v154
  v_and_b32 v45, 0xffff0000, v154
  v_pk_add_f32 v[64:65], v[64:65], v[44:45]
  v_lshlrev_b32 v46, 16, v155
  v_and_b32 v47, 0xffff0000, v155
  v_pk_add_f32 v[64:65], v[64:65], v[46:47]
  v_lshlrev_b32 v48, 16, v156
  v_and_b32 v49, 0xffff0000, v156
  v_pk_add_f32 v[64:65], v[64:65], v[48:49]
  v_lshlrev_b32 v50, 16, v157
  v_and_b32 v51, 0xffff0000, v157
  v_pk_add_f32 v[64:65], v[64:65], v[50:51]
  v_lshlrev_b32 v52, 16, v158
  v_and_b32 v53, 0xffff0000, v158
  v_pk_add_f32 v[64:65], v[64:65], v[52:53]
  v_lshlrev_b32 v54, 16, v159
  v_and_b32 v55, 0xffff0000, v159
  v_pk_add_f32 v[64:65], v[64:65], v[54:55]
  v_lshlrev_b32 v56, 16, v160
  v_and_b32 v57, 0xffff0000, v160
  v_pk_add_f32 v[64:65], v[64:65], v[56:57]
  v_lshlrev_b32 v58, 16, v161
  v_and_b32 v59, 0xffff0000, v161
  v_pk_add_f32 v[64:65], v[64:65], v[58:59]
  v_lshlrev_b32 v60, 16, v162
  v_and_b32 v61, 0xffff0000, v162
  v_pk_add_f32 v[64:65], v[64:65], v[60:61]
  v_lshlrev_b32 v62, 16, v163
  v_and_b32 v63, 0xffff0000, v163
  v_pk_add_f32 v[64:65], v[64:65], v[62:63]
  v_add_f32 v64, v64, v65
  s_nop 1
  v_add_f32_dpp v64, v64, v64 row_ror:8 row_mask:0xf bank_mask:0xf
  s_nop 1
  v_add_f32_dpp v64, v64, v64 row_ror:4 row_mask:0xf bank_mask:0xf
  s_nop 1
  v_add_f32_dpp v64, v64, v64 row_ror:2 row_mask:0xf bank_mask:0xf
  s_nop 1
  v_add_f32_dpp v64, v64, v64 row_ror:1 row_mask:0xf bank_mask:0xf
  v_mul_f32 v64, 0x3acccccd, v64
  v_pk_add_f32 v[24:25], v[24:25], v[64:65] op_sel:[0,0] op_sel_hi:[1,0] neg_lo:[0,1] neg_hi:[0,1]
  v_pk_mul_f32 v[66:67], v[24:25], v[24:25]
  v_pk_add_f32 v[26:27], v[26:27], v[64:65] op_sel:[0,0] op_sel_hi:[1,0] neg_lo:[0,1] neg_hi:[0,1]
  v_pk_fma_f32 v[66:67], v[26:27], v[26:27], v[66:67]
  v_pk_add_f32 v[28:29], v[28:29], v[64:65] op_sel:[0,0] op_sel_hi:[1,0] neg_lo:[0,1] neg_hi:[0,1]
  v_pk_fma_f32 v[66:67], v[28:29], v[28:29], v[66:67]
  v_pk_add_f32 v[30:31], v[30:31], v[64:65] op_sel:[0,0] op_sel_hi:[1,0] neg_lo:[0,1] neg_hi:[0,1]
  v_pk_fma_f32 v[66:67], v[30:31], v[30:31], v[66:67]
  v_pk_add_f32 v[32:33], v[32:33], v[64:65] op_sel:[0,0] op_sel_hi:[1,0] neg_lo:[0,1] neg_hi:[0,1]
  v_pk_fma_f32 v[66:67], v[32:33], v[32:33], v[66:67]
  v_pk_add_f32 v[34:35], v[34:35], v[64:65] op_sel:[0,0] op_sel_hi:[1,0] neg_lo:[0,1] neg_hi:[0,1]
  v_pk_fma_f32 v[66:67], v[34:35], v[34:35], v[66:67]
  v_pk_add_f32 v[36:37], v[36:37], v[64:65] op_sel:[0,0] op_sel_hi:[1,0] neg_lo:[0,1] neg_hi:[0,1]
  v_pk_fma_f32 v[66:67], v[36:37], v[36:37], v[66:67]
  v_pk_add_f32 v[38:39], v[38:39], v[64:65] op_sel:[0,0] op_sel_hi:[1,0] neg_lo:[0,1] neg_hi:[0,1]
  v_pk_fma_f32 v[66:67], v[38:39], v[38:39], v[66:67]
  v_pk_add_f32 v[40:41], v[40:41], v[64:65] op_sel:[0,0] op_sel_hi:[1,0] neg_lo:[0,1] neg_hi:[0,1]
  v_pk_fma_f32 v[66:67], v[40:41], v[40:41], v[66:67]
  v_pk_add_f32 v[42:43], v[42:43], v[64:65] op_sel:[0,0] op_sel_hi:[1,0] neg_lo:[0,1] neg_hi:[0,1]
  v_pk_fma_f32 v[66:67], v[42:43], v[42:43], v[66:67]
  v_pk_add_f32 v[44:45], v[44:45], v[64:65] op_sel:[0,0] op_sel_hi:[1,0] neg_lo:[0,1] neg_hi:[0,1]
  v_pk_fma_f32 v[66:67], v[44:45], v[44:45], v[66:67]
  v_pk_add_f32 v[46:47], v[46:47], v[64:65] op_sel:[0,0] op_sel_hi:[1,0] neg_lo:[0,1] neg_hi:[0,1]
  v_pk_fma_f32 v[66:67], v[46:47], v[46:47], v[66:67]
  v_pk_add_f32 v[48:49], v[48:49], v[64:65] op_sel:[0,0] op_sel_hi:[1,0] neg_lo:[0,1] neg_hi:[0,1]
  v_pk_fma_f32 v[66:67], v[48:49], v[48:49], v[66:67]
  v_pk_add_f32 v[50:51], v[50:51], v[64:65] op_sel:[0,0] op_sel_hi:[1,0] neg_lo:[0,1] neg_hi:[0,1]
  v_pk_fma_f32 v[66:67], v[50:51], v[50:51], v[66:67]
  v_pk_add_f32 v[52:53], v[52:53], v[64:65] op_sel:[0,0] op_sel_hi:[1,0] neg_lo:[0,1] neg_hi:[0,1]
  v_pk_fma_f32 v[66:67], v[52:53], v[52:53], v[66:67]
  v_pk_add_f32 v[54:55], v[54:55], v[64:65] op_sel:[0,0] op_sel_hi:[1,0] neg_lo:[0,1] neg_hi:[0,1]
  v_pk_fma_f32 v[66:67], v[54:55], v[54:55], v[66:67]
  v_pk_add_f32 v[56:57], v[56:57], v[64:65] op_sel:[0,0] op_sel_hi:[1,0] neg_lo:[0,1] neg_hi:[0,1]
  v_pk_fma_f32 v[66:67], v[56:57], v[56:57], v[66:67]
  v_pk_add_f32 v[58:59], v[58:59], v[64:65] op_sel:[0,0] op_sel_hi:[1,0] neg_lo:[0,1] neg_hi:[0,1]
  v_pk_fma_f32 v[66:67], v[58:59], v[58:59], v[66:67]
  v_pk_add_f32 v[60:61], v[60:61], v[64:65] op_sel:[0,0] op_sel_hi:[1,0] neg_lo:[0,1] neg_hi:[0,1]
  v_pk_fma_f32 v[66:67], v[60:61], v[60:61], v[66:67]
  v_pk_add_f32 v[62:63], v[62:63], v[64:65] op_sel:[0,0] op_sel_hi:[1,0] neg_lo:[0,1] neg_hi:[0,1]
  v_pk_fma_f32 v[66:67], v[62:63], v[62:63], v[66:67]
  v_add_f32 v66, v66, v67
  v_cvt_pk_bf16_f32 v70, v64, v64
  v_lshlrev_b32 v70, 16, v70
  v_add_f32_dpp v66, v66, v66 row_ror:8 row_mask:0xf bank_mask:0xf
  s_nop 1
  v_add_f32_dpp v66, v66, v66 row_ror:4 row_mask:0xf bank_mask:0xf
  s_nop 1
  v_add_f32_dpp v66, v66, v66 row_ror:2 row_mask:0xf bank_mask:0xf
  s_nop 1
  v_add_f32_dpp v66, v66, v66 row_ror:1 row_mask:0xf bank_mask:0xf
  v_mul_f32 v66, 0x3acccccd, v66
  v_cvt_pk_bf16_f32 v66, v66, v66
  v_lshlrev_b32 v66, 16, v66
  v_add_f32 v66, 0x3727c5ac, v66
  v_cvt_pk_bf16_f32 v66, v66, v66
  v_lshlrev_b32 v66, 16, v66
  v_sqrt_f32 v66, v66
  s_nop 0
  v_cvt_pk_bf16_f32 v66, v66, v66
  v_lshlrev_b32 v66, 16, v66
  v_rcp_f32 v68, v66
  v_sub_f32 v69, v64, v70
  v_xor_b32 v72, 0x80000000, v70
  v_mul_f32 v69, v69, v68
  v_mul_f32 v73, 0xbfb8aa3b, v68
  v_mul_f32 v74, v66, v66
  v_mov_b32 v75, 0
  s_lshl_b32 s27, s29, 1
  s_add_u32 s27, s27, s89
  s_lshl_b32 s27, s27, 6
  s_add_u32 s27, s27, 4096
  s_mov_b32 exec_lo, 0x00010001
  s_mov_b32 exec_hi, 0x00010001
  buffer_store_dwordx4 v[72:75], v1, s[20:23], s27 offen sc1
  s_mov_b64 exec, -1
  s_setpc_b64 s[100:101]
L_lnA2:
  v_pk_fma_f32 v[24:25], v[24:25], v[68:69], v[68:69] op_sel:[0,0,1] op_sel_hi:[1,0,1]
  v_cvt_pk_bf16_f32 v144, v24, v25
  v_pk_fma_f32 v[26:27], v[26:27], v[68:69], v[68:69] op_sel:[0,0,1] op_sel_hi:[1,0,1]
  v_cvt_pk_bf16_f32 v145, v26, v27
  v_pk_fma_f32 v[28:29], v[28:29], v[68:69], v[68:69] op_sel:[0,0,1] op_sel_hi:[1,0,1]
  v_cvt_pk_bf16_f32 v146, v28, v29
  v_pk_fma_f32 v[30:31], v[30:31], v[68:69], v[68:69] op_sel:[0,0,1] op_sel_hi:[1,0,1]
  v_cvt_pk_bf16_f32 v147, v30, v31
  v_pk_fma_f32 v[32:33], v[32:33], v[68:69], v[68:69] op_sel:[0,0,1] op_sel_hi:[1,0,1]
  v_cvt_pk_bf16_f32 v148, v32, v33
  v_pk_fma_f32 v[34:35], v[34:35], v[68:69], v[68:69] op_sel:[0,0,1] op_sel_hi:[1,0,1]
  v_cvt_pk_bf16_f32 v149, v34, v35
  v_pk_fma_f32 v[36:37], v[36:37], v[68:69], v[68:69] op_sel:[0,0,1] op_sel_hi:[1,0,1]
  v_cvt_pk_bf16_f32 v150, v36, v37
  v_pk_fma_f32 v[38:39], v[38:39], v[68:69], v[68:69] op_sel:[0,0,1] op_sel_hi:[1,0,1]
  v_cvt_pk_bf16_f32 v151, v38, v39
  v_pk_fma_f32 v[40:41], v[40:41], v[68:69], v[68:69] op_sel:[0,0,1] op_sel_hi:[1,0,1]
  v_cvt_pk_bf16_f32 v152, v40, v41
  v_pk_fma_f32 v[42:43], v[42:43], v[68:69], v[68:69] op_sel:[0,0,1] op_sel_hi:[1,0,1]
  v_cvt_pk_bf16_f32 v153, v42, v43
  v_pk_fma_f32 v[44:45], v[44:45], v[68:69], v[68:69] op_sel:[0,0,1] op_sel_hi:[1,0,1]
  v_cvt_pk_bf16_f32 v154, v44, v45
  v_pk_fma_f32 v[46:47], v[46:47], v[68:69], v[68:69] op_sel:[0,0,1] op_sel_hi:[1,0,1]
  v_cvt_pk_bf16_f32 v155, v46, v47
  v_pk_fma_f32 v[48:49], v[48:49], v[68:69], v[68:69] op_sel:[0,0,1] op_sel_hi:[1,0,1]
  v_cvt_pk_bf16_f32 v156, v48, v49
  v_pk_fma_f32 v[50:51], v[50:51], v[68:69], v[68:69] op_sel:[0,0,1] op_sel_hi:[1,0,1]
  v_cvt_pk_bf16_f32 v157, v50, v51
  v_pk_fma_f32 v[52:53], v[52:53], v[68:69], v[68:69] op_sel:[0,0,1] op_sel_hi:[1,0,1]
  v_cvt_pk_bf16_f32 v158, v52, v53
  v_pk_fma_f32 v[54:55], v[54:55], v[68:69], v[68:69] op_sel:[0,0,1] op_sel_hi:[1,0,1]
  v_cvt_pk_bf16_f32 v159, v54, v55
  v_pk_fma_f32 v[56:57], v[56:57], v[68:69], v[68:69] op_sel:[0,0,1] op_sel_hi:[1,0,1]
  v_cvt_pk_bf16_f32 v160, v56, v57
  v_pk_fma_f32 v[58:59], v[58:59], v[68:69], v[68:69] op_sel:[0,0,1] op_sel_hi:[1,0,1]
  v_cvt_pk_bf16_f32 v161, v58, v59
  v_pk_fma_f32 v[60:61], v[60:61], v[68:69], v[68:69] op_sel:[0,0,1] op_sel_hi:[1,0,1]
  v_cvt_pk_bf16_f32 v162, v60, v61
  v_pk_fma_f32 v[62:63], v[62:63], v[68:69], v[68:69] op_sel:[0,0,1] op_sel_hi:[1,0,1]
  v_cvt_pk_bf16_f32 v163, v62, v63
  v_lshrrev_b32 v14, 4, v1
  v_mul_u32_u24 v14, 1344, v14
  v_and_b32 v15, 15, v1
  v_lshl_add_u32 v14, v15, 4, v14
  s_mul_i32 s27, s89, 5376
  s_add_u32 s27, s27, s99
  v_add_u32 v164, s27, v14
  v_lshrrev_b32 v166, 2, v1
  v_and_b32 v165, 3, v166
  v_mul_u32_u24 v165, 1344, v165
  v_lshrrev_b32 v14, 4, v1
  v_lshl_add_u32 v165, v14, 5, v165
  v_and_b32 v14, 3, v1
  v_lshl_add_u32 v165, v14, 3, v165
  s_lshl_b32 s27, s89, 7
  s_add_u32 s27, s27, s99
  v_add_u32 v165, s27, v165
  v_lshlrev_b32 v166, 14, v166
  v_lshl_add_u32 v166, v14, 4, v166
  s_setpc_b64 s[100:101]
L_lnW:
  ds_write_b128 v164, v[144:147] offset:0
  ds_write_b128 v164, v[148:151] offset:256
  ds_write_b128 v164, v[152:155] offset:512
  ds_write_b128 v164, v[156:159] offset:768
  ds_write_b128 v164, v[160:163] offset:1024
  s_setpc_b64 s[100:101]
L_lnB:
  ds_read_b64_tr_b16 v[144:145], v165 offset:0
  ds_read_b64_tr_b16 v[146:147], v165 offset:5376
  ds_read_b64_tr_b16 v[148:149], v165 offset:256
  ds_read_b64_tr_b16 v[150:151], v165 offset:5632
  ds_read_b64_tr_b16 v[152:153], v165 offset:512
  ds_read_b64_tr_b16 v[154:155], v165 offset:5888
  ds_read_b64_tr_b16 v[156:157], v165 offset:768
  ds_read_b64_tr_b16 v[158:159], v165 offset:6144
  ds_read_b64_tr_b16 v[160:161], v165 offset:1024
  ds_read_b64_tr_b16 v[162:163], v165 offset:6400
  s_lshl_b32 s27, s89, 18
  s_lshl_b32 s28, s29, 6
  s_add_u32 s27, s27, s28
  s_add_u32 s27, s27, 12582912
  s_waitcnt lgkmcnt(0)
  buffer_store_dwordx4 v[144:147], v166, s[20:23], s27 offen sc1
  s_add_u32 s27, s27, 524288
  buffer_store_dwordx4 v[148:151], v166, s[20:23], s27 offen sc1
  s_add_u32 s27, s27, 524288
  buffer_store_dwordx4 v[152:155], v166, s[20:23], s27 offen sc1
  s_add_u32 s27, s27, 524288
  buffer_store_dwordx4 v[156:159], v166, s[20:23], s27 offen sc1
  s_add_u32 s27, s27, 524288
  buffer_store_dwordx4 v[160:163], v166, s[20:23], s27 offen sc1
  s_setpc_b64 s[100:101]
L_lnF:
  s_lshl_b32 s27, s89, 8
  s_add_u32 s27, s27, s29
  s_lshl_b32 s27, s27, 2
  s_add_u32 s27, s27, 196608
  v_mov_b32 v14, s3
  v_mov_b32 v15, 0
  s_mov_b64 exec, 1
  buffer_store_dword v14, v15, s[20:23], s27 offen sc1
  s_mov_b64 exec, -1
  s_setpc_b64 s[100:101]
L_uld:
  s_lshr_b32 s28, s44, 2
  s_lshl_b32 s28, s28, 14
  s_and_b32 s34, s44, 3
  s_lshl_b32 s34, s34, 4
  s_add_u32 s28, s28, s34
  s_add_u32 s28, s28, 12582912
  v_lshlrev_b32 v5, 6, v1
  s_mov_b32 m0, s45
  s_mov_b32 s34, 2147483392
  s_mov_b32 exec_hi, 0
  buffer_load_dwordx4 v5, s[20:23], s34 offen lds
  s_mov_b64 exec, -1
  s_add_u32 m0, s45, 512
  s_add_u32 s34, s28, 0
  buffer_load_dwordx4 v5, s[20:23], s34 offen sc1 lds
  s_add_u32 m0, s45, 1536
  s_add_u32 s34, s28, 4096
  buffer_load_dwordx4 v5, s[20:23], s34 offen sc1 lds
  s_add_u32 m0, s45, 2560
  s_add_u32 s34, s28, 8192
  buffer_load_dwordx4 v5, s[20:23], s34 offen sc1 lds
  s_add_u32 m0, s45, 3584
  s_add_u32 s34, s28, 12288
  buffer_load_dwordx4 v5, s[20:23], s34 offen sc1 lds
  s_setpc_b64 s[100:101]
L_cadr:
  v_and_b32 v2, 15, v1
  v_lshrrev_b32 v3, 4, v1
  v_lshlrev_b32 v6, 5, v2
  v_lshl_add_u32 v7, v3, 3, v6
  v_and_b32 v4, 1, v3
  v_mul_u32_u24 v4, 504, v4
  v_add_u32 v5, v7, v4
  v_lshl_add_u32 v6, v3, 4, v6
  v_add_u32 v6, s45, v6
  s_lshl_b32 s27, s44, 12
  s_add_u32 s27, s27, 18874368
  s_setpc_b64 s[100:101]
L_cvA:
  ds_read_b128 v[152:155], v6 offset:32
  ds_read_b128 v[156:159], v6 offset:96
  ds_read_b128 v[160:163], v6 offset:160
  ds_read_b128 v[164:167], v6 offset:224
  ds_read_b128 v[168:171], v6 offset:288
  s_waitcnt lgkmcnt(4)
  v_mfma_f32_16x16x32_bf16 v[120:123], v[44:47], v[152:155], 0
  v_mfma_f32_16x16x32_bf16 v[124:127], v[12:15], v[152:155], 0
  ds_read_b128 v[172:175], v6 offset:352
  s_waitcnt lgkmcnt(4)
  v_mfma_f32_16x16x32_bf16 v[120:123], v[48:51], v[156:159], v[120:123]
  v_mfma_f32_16x16x32_bf16 v[124:127], v[16:19], v[156:159], v[124:127]
  ds_read_b128 v[152:155], v6 offset:416
  s_waitcnt lgkmcnt(4)
  v_mfma_f32_16x16x32_bf16 v[120:123], v[52:55], v[160:163], v[120:123]
  v_mfma_f32_16x16x32_bf16 v[124:127], v[20:23], v[160:163], v[124:127]
  ds_read_b128 v[156:159], v6 offset:480
  s_waitcnt lgkmcnt(4)
  v_mfma_f32_16x16x32_bf16 v[120:123], v[56:59], v[164:167], v[120:123]
  v_mfma_f32_16x16x32_bf16 v[124:127], v[24:27], v[164:167], v[124:127]
  ds_read_b128 v[160:163], v6 offset:464
  s_waitcnt lgkmcnt(4)
  v_mfma_f32_16x16x32_bf16 v[120:123], v[60:63], v[168:171], v[120:123]
  v_mfma_f32_16x16x32_bf16 v[124:127], v[28:31], v[168:171], v[124:127]
  ds_read_b128 v[164:167], v6 offset:544
  s_waitcnt lgkmcnt(4)
  v_mfma_f32_16x16x32_bf16 v[120:123], v[64:67], v[172:175], v[120:123]
  v_mfma_f32_16x16x32_bf16 v[124:127], v[32:35], v[172:175], v[124:127]
  ds_read_b128 v[168:171], v6 offset:608
  s_waitcnt lgkmcnt(4)
  v_mfma_f32_16x16x32_bf16 v[120:123], v[68:71], v[152:155], v[120:123]
  v_mfma_f32_16x16x32_bf16 v[124:127], v[36:39], v[152:155], v[124:127]
  ds_read_b128 v[172:175], v6 offset:672
  s_waitcnt lgkmcnt(4)
  v_mfma_f32_16x16x32_bf16 v[120:123], v[72:75], v[156:159], v[120:123]
  v_mfma_f32_16x16x32_bf16 v[124:127], v[40:43], v[156:159], v[124:127]
  v_mfma_f32_16x16x32_bf16 v[128:131], v[8:11], v[156:159], 0
  v_mfma_f32_16x16x32_bf16 v[136:139], v[76:79], v[156:159], 0
  v_mfma_f32_16x16x32_bf16 v[220:223], v[156:159], v[184:187], 0
  v_mfma_f32_16x16x32_bf16 v[224:227], v[156:159], v[188:191], 0
  v_mfma_f32_16x16x32_bf16 v[228:231], v[156:159], v[192:195], 0
  v_mfma_f32_16x16x32_bf16 v[236:239], v[156:159], v[196:199], 0
  ds_read_b128 v[152:155], v6 offset:736
  s_waitcnt lgkmcnt(4)
  v_mfma_f32_16x16x32_bf16 v[232:235], v[160:163], v[188:191], 0
  v_mfma_f32_16x16x32_bf16 v[240:243], v[160:163], v[200:203], 0
  ds_read_b128 v[156:159], v6 offset:800
  s_waitcnt lgkmcnt(4)
  v_mfma_f32_16x16x32_bf16 v[124:127], v[44:47], v[164:167], v[124:127]
  v_mfma_f32_16x16x32_bf16 v[128:131], v[12:15], v[164:167], v[128:131]
  ds_read_b128 v[160:163], v6 offset:864
  s_waitcnt lgkmcnt(4)
  v_mfma_f32_16x16x32_bf16 v[124:127], v[48:51], v[168:171], v[124:127]
  v_mfma_f32_16x16x32_bf16 v[128:131], v[16:19], v[168:171], v[128:131]
  ds_read_b128 v[164:167], v6 offset:928
  v_cvt_pk_bf16_f32 v208, v220, v224
  v_cvt_pk_bf16_f32 v209, v221, v225
  v_cvt_pk_bf16_f32 v210, v222, v226
  v_cvt_pk_bf16_f32 v211, v223, v227
  v_cvt_pk_bf16_f32 v212, v228, v232
  v_cvt_pk_bf16_f32 v213, v229, v233
  v_cvt_pk_bf16_f32 v214, v230, v234
  v_cvt_pk_bf16_f32 v215, v231, v235
  v_cvt_pk_bf16_f32 v216, v236, v240
  v_cvt_pk_bf16_f32 v217, v237, v241
  v_cvt_pk_bf16_f32 v218, v238, v242
  v_cvt_pk_bf16_f32 v219, v239, v243
  s_waitcnt lgkmcnt(4)
  v_mfma_f32_16x16x32_bf16 v[124:127], v[52:55], v[172:175], v[124:127]
  v_mfma_f32_16x16x32_bf16 v[128:131], v[20:23], v[172:175], v[128:131]
  ds_read_b128 v[168:171], v6 offset:992
  v_mfma_f32_16x16x32_bf16 v[128:131], v[208:211], v[80:83], v[128:131]
  v_mfma_f32_16x16x32_bf16 v[128:131], v[212:215], v[92:95], v[128:131]
  v_mfma_f32_16x16x32_bf16 v[132:135], v[208:211], v[84:87], 0
  v_mfma_f32_16x16x32_bf16 v[132:135], v[212:215], v[96:99], v[132:135]
  v_mfma_f32_16x16x32_bf16 v[136:139], v[208:211], v[88:91], v[136:139]
  v_mfma_f32_16x16x32_bf16 v[136:139], v[212:215], v[100:103], v[136:139]
  v_mfma_f32_16x16x32_bf16 v[136:139], v[216:219], v[104:107], v[136:139]
  s_waitcnt lgkmcnt(4)
  v_mfma_f32_16x16x32_bf16 v[124:127], v[56:59], v[152:155], v[124:127]
  v_mfma_f32_16x16x32_bf16 v[128:131], v[24:27], v[152:155], v[128:131]
  ds_read_b128 v[172:175], v6 offset:976
  s_waitcnt lgkmcnt(4)
  v_mfma_f32_16x16x32_bf16 v[124:127], v[60:63], v[156:159], v[124:127]
  v_mfma_f32_16x16x32_bf16 v[128:131], v[28:31], v[156:159], v[128:131]
  ds_read_b128 v[152:155], v6 offset:1056
  s_waitcnt lgkmcnt(4)
  v_mfma_f32_16x16x32_bf16 v[124:127], v[64:67], v[160:163], v[124:127]
  v_mfma_f32_16x16x32_bf16 v[128:131], v[32:35], v[160:163], v[128:131]
  ds_read_b128 v[156:159], v6 offset:1120
  s_waitcnt lgkmcnt(4)
  v_mfma_f32_16x16x32_bf16 v[124:127], v[68:71], v[164:167], v[124:127]
  v_mfma_f32_16x16x32_bf16 v[128:131], v[36:39], v[164:167], v[128:131]
  ds_read_b128 v[160:163], v6 offset:1184
  s_waitcnt lgkmcnt(4)
  v_mfma_f32_16x16x32_bf16 v[124:127], v[72:75], v[168:171], v[124:127]
  v_mfma_f32_16x16x32_bf16 v[128:131], v[40:43], v[168:171], v[128:131]
  v_mfma_f32_16x16x32_bf16 v[132:135], v[8:11], v[168:171], v[132:135]
  v_mfma_f32_16x16x32_bf16 v[220:223], v[168:171], v[184:187], 0
  v_mfma_f32_16x16x32_bf16 v[224:227], v[168:171], v[188:191], 0
  v_mfma_f32_16x16x32_bf16 v[228:231], v[168:171], v[192:195], 0
  ds_read_b128 v[164:167], v6 offset:1248
  s_waitcnt lgkmcnt(4)
  v_mfma_f32_16x16x32_bf16 v[232:235], v[172:175], v[188:191], 0
  ds_read_b128 v[168:171], v6 offset:1312
  s_waitcnt lgkmcnt(4)
  v_mfma_f32_16x16x32_bf16 v[128:131], v[44:47], v[152:155], v[128:131]
  v_mfma_f32_16x16x32_bf16 v[132:135], v[12:15], v[152:155], v[132:135]
  ds_read_b128 v[172:175], v6 offset:1376
  s_waitcnt lgkmcnt(4)
  v_mfma_f32_16x16x32_bf16 v[128:131], v[48:51], v[156:159], v[128:131]
  v_mfma_f32_16x16x32_bf16 v[132:135], v[16:19], v[156:159], v[132:135]
  ds_read_b128 v[152:155], v6 offset:1440
  v_cvt_pk_bf16_f32 v208, v220, v224
  v_cvt_pk_bf16_f32 v209, v221, v225
  v_cvt_pk_bf16_f32 v210, v222, v226
  v_cvt_pk_bf16_f32 v211, v223, v227
  v_cvt_pk_bf16_f32 v212, v228, v232
  v_cvt_pk_bf16_f32 v213, v229, v233
  v_cvt_pk_bf16_f32 v214, v230, v234
  v_cvt_pk_bf16_f32 v215, v231, v235
  s_waitcnt lgkmcnt(4)
  v_mfma_f32_16x16x32_bf16 v[128:131], v[52:55], v[160:163], v[128:131]
  v_mfma_f32_16x16x32_bf16 v[132:135], v[20:23], v[160:163], v[132:135]
  ds_read_b128 v[156:159], v6 offset:1504
  v_mfma_f32_16x16x32_bf16 v[132:135], v[208:211], v[80:83], v[132:135]
  v_mfma_f32_16x16x32_bf16 v[132:135], v[212:215], v[92:95], v[132:135]
  v_mfma_f32_16x16x32_bf16 v[136:139], v[208:211], v[84:87], v[136:139]
  v_mfma_f32_16x16x32_bf16 v[136:139], v[212:215], v[96:99], v[136:139]
  s_waitcnt lgkmcnt(4)
  v_mfma_f32_16x16x32_bf16 v[128:131], v[56:59], v[164:167], v[128:131]
  v_mfma_f32_16x16x32_bf16 v[132:135], v[24:27], v[164:167], v[132:135]
  ds_read_b128 v[160:163], v6 offset:1488
  s_waitcnt lgkmcnt(4)
  v_mfma_f32_16x16x32_bf16 v[128:131], v[60:63], v[168:171], v[128:131]
  v_mfma_f32_16x16x32_bf16 v[132:135], v[28:31], v[168:171], v[132:135]
  ds_read_b128 v[164:167], v6 offset:1568
  s_waitcnt lgkmcnt(4)
  v_mfma_f32_16x16x32_bf16 v[128:131], v[64:67], v[172:175], v[128:131]
  v_mfma_f32_16x16x32_bf16 v[132:135], v[32:35], v[172:175], v[132:135]
  ds_read_b128 v[168:171], v6 offset:1632
  s_waitcnt lgkmcnt(4)
  v_mfma_f32_16x16x32_bf16 v[128:131], v[68:71], v[152:155], v[128:131]
  v_mfma_f32_16x16x32_bf16 v[132:135], v[36:39], v[152:155], v[132:135]
  ds_read_b128 v[172:175], v6 offset:1696
  s_waitcnt lgkmcnt(4)
  v_mfma_f32_16x16x32_bf16 v[128:131], v[72:75], v[156:159], v[128:131]
  v_mfma_f32_16x16x32_bf16 v[132:135], v[40:43], v[156:159], v[132:135]
  v_mfma_f32_16x16x32_bf16 v[136:139], v[8:11], v[156:159], v[136:139]
  v_mfma_f32_16x16x32_bf16 v[220:223], v[156:159], v[184:187], 0
  v_mfma_f32_16x16x32_bf16 v[224:227], v[156:159], v[188:191], 0
  v_mfma_f32_16x16x32_bf16 v[228:231], v[156:159], v[192:195], 0
  ds_read_b128 v[152:155], v6 offset:1760
  s_waitcnt lgkmcnt(4)
  v_mfma_f32_16x16x32_bf16 v[232:235], v[160:163], v[188:191], 0
  ds_read_b128 v[156:159], v6 offset:1824
  s_waitcnt lgkmcnt(4)
  v_mfma_f32_16x16x32_bf16 v[132:135], v[44:47], v[164:167], v[132:135]
  v_mfma_f32_16x16x32_bf16 v[136:139], v[12:15], v[164:167], v[136:139]
  ds_read_b128 v[160:163], v6 offset:1888
  s_waitcnt lgkmcnt(4)
  v_mfma_f32_16x16x32_bf16 v[132:135], v[48:51], v[168:171], v[132:135]
  v_mfma_f32_16x16x32_bf16 v[136:139], v[16:19], v[168:171], v[136:139]
  ds_read_b128 v[164:167], v6 offset:1952
  v_cvt_pk_bf16_f32 v208, v220, v224
  v_cvt_pk_bf16_f32 v209, v221, v225
  v_cvt_pk_bf16_f32 v210, v222, v226
  v_cvt_pk_bf16_f32 v211, v223, v227
  v_cvt_pk_bf16_f32 v212, v228, v232
  v_cvt_pk_bf16_f32 v213, v229, v233
  v_cvt_pk_bf16_f32 v214, v230, v234
  v_cvt_pk_bf16_f32 v215, v231, v235
  s_waitcnt lgkmcnt(4)
  v_mfma_f32_16x16x32_bf16 v[132:135], v[52:55], v[172:175], v[132:135]
  v_mfma_f32_16x16x32_bf16 v[136:139], v[20:23], v[172:175], v[136:139]
  ds_read_b128 v[168:171], v6 offset:2016
  v_mfma_f32_16x16x32_bf16 v[136:139], v[208:211], v[80:83], v[136:139]
  v_mfma_f32_16x16x32_bf16 v[136:139], v[212:215], v[92:95], v[136:139]
  s_waitcnt lgkmcnt(4)
  v_mfma_f32_16x16x32_bf16 v[132:135], v[56:59], v[152:155], v[132:135]
  v_mfma_f32_16x16x32_bf16 v[136:139], v[24:27], v[152:155], v[136:139]
  ds_read_b128 v[172:175], v6 offset:2080
  s_waitcnt lgkmcnt(4)
  v_mfma_f32_16x16x32_bf16 v[132:135], v[60:63], v[156:159], v[132:135]
  v_mfma_f32_16x16x32_bf16 v[136:139], v[28:31], v[156:159], v[136:139]
  ds_read_b128 v[152:155], v6 offset:2144
  s_waitcnt lgkmcnt(4)
  v_mfma_f32_16x16x32_bf16 v[132:135], v[64:67], v[160:163], v[132:135]
  v_mfma_f32_16x16x32_bf16 v[136:139], v[32:35], v[160:163], v[136:139]
  ds_read_b128 v[156:159], v6 offset:2208
  s_waitcnt lgkmcnt(4)
  v_mfma_f32_16x16x32_bf16 v[132:135], v[68:71], v[164:167], v[132:135]
  v_mfma_f32_16x16x32_bf16 v[136:139], v[36:39], v[164:167], v[136:139]
  ds_read_b128 v[160:163], v6 offset:2272
  s_waitcnt lgkmcnt(4)
  v_mfma_f32_16x16x32_bf16 v[132:135], v[72:75], v[168:171], v[132:135]
  v_mfma_f32_16x16x32_bf16 v[136:139], v[40:43], v[168:171], v[136:139]
  ds_read_b128 v[164:167], v6 offset:2336
  s_waitcnt lgkmcnt(4)
  v_mfma_f32_16x16x32_bf16 v[136:139], v[44:47], v[172:175], v[136:139]
  ds_read_b128 v[168:171], v6 offset:2400
  s_waitcnt lgkmcnt(4)
  v_mfma_f32_16x16x32_bf16 v[136:139], v[48:51], v[152:155], v[136:139]
  ds_read_b128 v[172:175], v6 offset:2464
  s_waitcnt lgkmcnt(4)
  v_mfma_f32_16x16x32_bf16 v[136:139], v[52:55], v[156:159], v[136:139]
  ds_read_b128 v[152:155], v6 offset:2528
  s_waitcnt lgkmcnt(4)
  v_mfma_f32_16x16x32_bf16 v[136:139], v[56:59], v[160:163], v[136:139]
  s_waitcnt lgkmcnt(3)
  v_mfma_f32_16x16x32_bf16 v[136:139], v[60:63], v[164:167], v[136:139]
  s_waitcnt lgkmcnt(2)
  v_mfma_f32_16x16x32_bf16 v[136:139], v[64:67], v[168:171], v[136:139]
  s_waitcnt lgkmcnt(1)
  v_mfma_f32_16x16x32_bf16 v[136:139], v[68:71], v[172:175], v[136:139]
  s_waitcnt lgkmcnt(0)
  v_mfma_f32_16x16x32_bf16 v[136:139], v[72:75], v[152:155], v[136:139]
  v_cvt_pk_bf16_f32 v220, v120, v121
  v_cvt_pk_bf16_f32 v221, v122, v123
  v_cvt_pk_bf16_f32 v222, v124, v125
  v_cvt_pk_bf16_f32 v223, v126, v127
  s_nop 0
  v_permlane16_swap_b32 v220, v222
  v_permlane16_swap_b32 v221, v223
  buffer_store_dwordx4 v[220:223], v5, s[20:23], s27 offen offset:0 sc1
  v_cvt_pk_bf16_f32 v224, v128, v129
  v_cvt_pk_bf16_f32 v225, v130, v131
  v_cvt_pk_bf16_f32 v226, v132, v133
  v_cvt_pk_bf16_f32 v227, v134, v135
  s_nop 0
  v_permlane16_swap_b32 v224, v226
  v_permlane16_swap_b32 v225, v227
  buffer_store_dwordx4 v[224:227], v5, s[20:23], s27 offen offset:1024 sc1
  v_cvt_pk_bf16_f32 v228, v136, v137
  v_cvt_pk_bf16_f32 v229, v138, v139
  buffer_store_dwordx2 v[228:229], v7, s[20:23], s27 offen offset:2048 sc1
  s_lshl_b32 s28, s44, 7
  s_add_u32 s28, s28, 458752
  s_waitcnt vmcnt(0)
  v_mov_b32 v2, s3
  v_mov_b32 v3, 0
  s_mov_b64 exec, 1
  buffer_store_dword v2, v3, s[20:23], s28 offen sc1
  s_mov_b64 exec, -1
  s_setpc_b64 s[100:101]
L_cvB:
  ds_read_b128 v[152:155], v6 offset:480
  ds_read_b128 v[156:159], v6 offset:464
  ds_read_b128 v[160:163], v6 offset:992
  ds_read_b128 v[164:167], v6 offset:976
  ds_read_b128 v[168:171], v6 offset:1504
  s_waitcnt lgkmcnt(4)
  v_mfma_f32_16x16x32_bf16 v[236:239], v[152:155], v[196:199], 0
  ds_read_b128 v[172:175], v6 offset:1488
  s_waitcnt lgkmcnt(4)
  v_mfma_f32_16x16x32_bf16 v[240:243], v[156:159], v[200:203], 0
  ds_read_b128 v[152:155], v6 offset:2016
  s_waitcnt lgkmcnt(4)
  v_mfma_f32_16x16x32_bf16 v[140:143], v[76:79], v[160:163], 0
  s_nop 4
  v_cvt_pk_bf16_f32 v216, v236, v240
  v_cvt_pk_bf16_f32 v217, v237, v241
  v_cvt_pk_bf16_f32 v218, v238, v242
  v_cvt_pk_bf16_f32 v219, v239, v243
  s_nop 1
  v_mfma_f32_16x16x32_bf16 v[140:143], v[216:219], v[108:111], v[140:143]
  v_mfma_f32_16x16x32_bf16 v[144:147], v[216:219], v[112:115], 0
  v_mfma_f32_16x16x32_bf16 v[148:151], v[216:219], v[116:119], 0
  v_mfma_f32_16x16x32_bf16 v[220:223], v[160:163], v[184:187], 0
  v_mfma_f32_16x16x32_bf16 v[224:227], v[160:163], v[188:191], 0
  v_mfma_f32_16x16x32_bf16 v[228:231], v[160:163], v[192:195], 0
  v_mfma_f32_16x16x32_bf16 v[236:239], v[160:163], v[196:199], 0
  ds_read_b128 v[156:159], v6 offset:2000
  s_waitcnt lgkmcnt(4)
  v_mfma_f32_16x16x32_bf16 v[232:235], v[164:167], v[188:191], 0
  v_mfma_f32_16x16x32_bf16 v[240:243], v[164:167], v[200:203], 0
  ds_read_b128 v[160:163], v6 offset:2080
  s_waitcnt lgkmcnt(4)
  v_mfma_f32_16x16x32_bf16 v[144:147], v[76:79], v[168:171], v[144:147]
  v_cvt_pk_bf16_f32 v208, v220, v224
  v_cvt_pk_bf16_f32 v209, v221, v225
  v_cvt_pk_bf16_f32 v210, v222, v226
  v_cvt_pk_bf16_f32 v211, v223, v227
  v_cvt_pk_bf16_f32 v212, v228, v232
  v_cvt_pk_bf16_f32 v213, v229, v233
  v_cvt_pk_bf16_f32 v214, v230, v234
  v_cvt_pk_bf16_f32 v215, v231, v235
  v_cvt_pk_bf16_f32 v216, v236, v240
  v_cvt_pk_bf16_f32 v217, v237, v241
  v_cvt_pk_bf16_f32 v218, v238, v242
  v_cvt_pk_bf16_f32 v219, v239, v243
  v_mfma_f32_16x16x32_bf16 v[140:143], v[208:211], v[88:91], v[140:143]
  v_mfma_f32_16x16x32_bf16 v[140:143], v[212:215], v[100:103], v[140:143]
  v_mfma_f32_16x16x32_bf16 v[140:143], v[216:219], v[104:107], v[140:143]
  v_mfma_f32_16x16x32_bf16 v[144:147], v[216:219], v[108:111], v[144:147]
  v_mfma_f32_16x16x32_bf16 v[148:151], v[216:219], v[112:115], v[148:151]
  v_mfma_f32_16x16x32_bf16 v[220:223], v[168:171], v[184:187], 0
  v_mfma_f32_16x16x32_bf16 v[224:227], v[168:171], v[188:191], 0
  v_mfma_f32_16x16x32_bf16 v[228:231], v[168:171], v[192:195], 0
  v_mfma_f32_16x16x32_bf16 v[236:239], v[168:171], v[196:199], 0
  ds_read_b128 v[164:167], v6 offset:2144
  s_waitcnt lgkmcnt(4)
  v_mfma_f32_16x16x32_bf16 v[232:235], v[172:175], v[188:191], 0
  v_mfma_f32_16x16x32_bf16 v[240:243], v[172:175], v[200:203], 0
  ds_read_b128 v[168:171], v6 offset:2208
  s_waitcnt lgkmcnt(4)
  v_mfma_f32_16x16x32_bf16 v[140:143], v[8:11], v[152:155], v[140:143]
  v_mfma_f32_16x16x32_bf16 v[148:151], v[76:79], v[152:155], v[148:151]
  v_cvt_pk_bf16_f32 v208, v220, v224
  v_cvt_pk_bf16_f32 v209, v221, v225
  v_cvt_pk_bf16_f32 v210, v222, v226
  v_cvt_pk_bf16_f32 v211, v223, v227
  v_cvt_pk_bf16_f32 v212, v228, v232
  v_cvt_pk_bf16_f32 v213, v229, v233
  v_cvt_pk_bf16_f32 v214, v230, v234
  v_cvt_pk_bf16_f32 v215, v231, v235
  v_cvt_pk_bf16_f32 v216, v236, v240
  v_cvt_pk_bf16_f32 v217, v237, v241
  v_cvt_pk_bf16_f32 v218, v238, v242
  v_cvt_pk_bf16_f32 v219, v239, v243
  v_mfma_f32_16x16x32_bf16 v[140:143], v[208:211], v[84:87], v[140:143]
  v_mfma_f32_16x16x32_bf16 v[140:143], v[212:215], v[96:99], v[140:143]
  v_mfma_f32_16x16x32_bf16 v[144:147], v[208:211], v[88:91], v[144:147]
  v_mfma_f32_16x16x32_bf16 v[144:147], v[212:215], v[100:103], v[144:147]
  v_mfma_f32_16x16x32_bf16 v[144:147], v[216:219], v[104:107], v[144:147]
  v_mfma_f32_16x16x32_bf16 v[148:151], v[216:219], v[108:111], v[148:151]
  v_mfma_f32_16x16x32_bf16 v[220:223], v[152:155], v[184:187], 0
  v_mfma_f32_16x16x32_bf16 v[224:227], v[152:155], v[188:191], 0
  v_mfma_f32_16x16x32_bf16 v[228:231], v[152:155], v[192:195], 0
  v_mfma_f32_16x16x32_bf16 v[236:239], v[152:155], v[196:199], 0
  ds_read_b128 v[172:175], v6 offset:2272
  s_waitcnt lgkmcnt(4)
  v_mfma_f32_16x16x32_bf16 v[232:235], v[156:159], v[188:191], 0
  v_mfma_f32_16x16x32_bf16 v[240:243], v[156:159], v[200:203], 0
  ds_read_b128 v[152:155], v6 offset:2336
  s_waitcnt lgkmcnt(4)
  v_mfma_f32_16x16x32_bf16 v[140:143], v[12:15], v[160:163], v[140:143]
  ds_read_b128 v[156:159], v6 offset:2400
  s_waitcnt lgkmcnt(4)
  v_mfma_f32_16x16x32_bf16 v[140:143], v[16:19], v[164:167], v[140:143]
  ds_read_b128 v[160:163], v6 offset:2464
  v_cvt_pk_bf16_f32 v208, v220, v224
  v_cvt_pk_bf16_f32 v209, v221, v225
  v_cvt_pk_bf16_f32 v210, v222, v226
  v_cvt_pk_bf16_f32 v211, v223, v227
  v_cvt_pk_bf16_f32 v212, v228, v232
  v_cvt_pk_bf16_f32 v213, v229, v233
  v_cvt_pk_bf16_f32 v214, v230, v234
  v_cvt_pk_bf16_f32 v215, v231, v235
  v_cvt_pk_bf16_f32 v216, v236, v240
  v_cvt_pk_bf16_f32 v217, v237, v241
  v_cvt_pk_bf16_f32 v218, v238, v242
  v_cvt_pk_bf16_f32 v219, v239, v243
  s_waitcnt lgkmcnt(4)
  v_mfma_f32_16x16x32_bf16 v[140:143], v[20:23], v[168:171], v[140:143]
  ds_read_b128 v[164:167], v6 offset:2528
  v_mfma_f32_16x16x32_bf16 v[140:143], v[208:211], v[80:83], v[140:143]
  v_mfma_f32_16x16x32_bf16 v[140:143], v[212:215], v[92:95], v[140:143]
  v_mfma_f32_16x16x32_bf16 v[144:147], v[208:211], v[84:87], v[144:147]
  v_mfma_f32_16x16x32_bf16 v[144:147], v[212:215], v[96:99], v[144:147]
  v_mfma_f32_16x16x32_bf16 v[148:151], v[208:211], v[88:91], v[148:151]
  v_mfma_f32_16x16x32_bf16 v[148:151], v[212:215], v[100:103], v[148:151]
  v_mfma_f32_16x16x32_bf16 v[148:151], v[216:219], v[104:107], v[148:151]
  s_waitcnt lgkmcnt(4)
  v_mfma_f32_16x16x32_bf16 v[140:143], v[24:27], v[172:175], v[140:143]
  ds_read_b128 v[168:171], v6 offset:2512
  s_waitcnt lgkmcnt(4)
  v_mfma_f32_16x16x32_bf16 v[140:143], v[28:31], v[152:155], v[140:143]
  ds_read_b128 v[172:175], v6 offset:2592
  s_waitcnt lgkmcnt(4)
  v_mfma_f32_16x16x32_bf16 v[140:143], v[32:35], v[156:159], v[140:143]
  ds_read_b128 v[152:155], v6 offset:2656
  s_waitcnt lgkmcnt(4)
  v_mfma_f32_16x16x32_bf16 v[140:143], v[36:39], v[160:163], v[140:143]
  ds_read_b128 v[156:159], v6 offset:2720
  s_waitcnt lgkmcnt(4)
  v_mfma_f32_16x16x32_bf16 v[140:143], v[40:43], v[164:167], v[140:143]
  v_mfma_f32_16x16x32_bf16 v[144:147], v[8:11], v[164:167], v[144:147]
  v_mfma_f32_16x16x32_bf16 v[220:223], v[164:167], v[184:187], 0
  v_mfma_f32_16x16x32_bf16 v[224:227], v[164:167], v[188:191], 0
  v_mfma_f32_16x16x32_bf16 v[228:231], v[164:167], v[192:195], 0
  ds_read_b128 v[160:163], v6 offset:2784
  s_waitcnt lgkmcnt(4)
  v_mfma_f32_16x16x32_bf16 v[232:235], v[168:171], v[188:191], 0
  ds_read_b128 v[164:167], v6 offset:2848
  s_waitcnt lgkmcnt(4)
  v_mfma_f32_16x16x32_bf16 v[140:143], v[44:47], v[172:175], v[140:143]
  v_mfma_f32_16x16x32_bf16 v[144:147], v[12:15], v[172:175], v[144:147]
  ds_read_b128 v[168:171], v6 offset:2912
  s_waitcnt lgkmcnt(4)
  v_mfma_f32_16x16x32_bf16 v[140:143], v[48:51], v[152:155], v[140:143]
  v_mfma_f32_16x16x32_bf16 v[144:147], v[16:19], v[152:155], v[144:147]
  ds_read_b128 v[172:175], v6 offset:2976
  v_cvt_pk_bf16_f32 v208, v220, v224
  v_cvt_pk_bf16_f32 v209, v221, v225
  v_cvt_pk_bf16_f32 v210, v222, v226
  v_cvt_pk_bf16_f32 v211, v223, v227
  v_cvt_pk_bf16_f32 v212, v228, v232
  v_cvt_pk_bf16_f32 v213, v229, v233
  v_cvt_pk_bf16_f32 v214, v230, v234
  v_cvt_pk_bf16_f32 v215, v231, v235
  s_waitcnt lgkmcnt(4)
  v_mfma_f32_16x16x32_bf16 v[140:143], v[52:55], v[156:159], v[140:143]
  v_mfma_f32_16x16x32_bf16 v[144:147], v[20:23], v[156:159], v[144:147]
  ds_read_b128 v[152:155], v6 offset:3040
  v_mfma_f32_16x16x32_bf16 v[144:147], v[208:211], v[80:83], v[144:147]
  v_mfma_f32_16x16x32_bf16 v[144:147], v[212:215], v[92:95], v[144:147]
  v_mfma_f32_16x16x32_bf16 v[148:151], v[208:211], v[84:87], v[148:151]
  v_mfma_f32_16x16x32_bf16 v[148:151], v[212:215], v[96:99], v[148:151]
  s_waitcnt lgkmcnt(4)
  v_mfma_f32_16x16x32_bf16 v[140:143], v[56:59], v[160:163], v[140:143]
  v_mfma_f32_16x16x32_bf16 v[144:147], v[24:27], v[160:163], v[144:147]
  ds_read_b128 v[156:159], v6 offset:3024
  s_waitcnt lgkmcnt(4)
  v_mfma_f32_16x16x32_bf16 v[140:143], v[60:63], v[164:167], v[140:143]
  v_mfma_f32_16x16x32_bf16 v[144:147], v[28:31], v[164:167], v[144:147]
  ds_read_b128 v[160:163], v6 offset:3104
  s_waitcnt lgkmcnt(4)
  v_mfma_f32_16x16x32_bf16 v[140:143], v[64:67], v[168:171], v[140:143]
  v_mfma_f32_16x16x32_bf16 v[144:147], v[32:35], v[168:171], v[144:147]
  ds_read_b128 v[164:167], v6 offset:3168
  s_waitcnt lgkmcnt(4)
  v_mfma_f32_16x16x32_bf16 v[140:143], v[68:71], v[172:175], v[140:143]
  v_mfma_f32_16x16x32_bf16 v[144:147], v[36:39], v[172:175], v[144:147]
  ds_read_b128 v[168:171], v6 offset:3232
  s_waitcnt lgkmcnt(4)
  v_mfma_f32_16x16x32_bf16 v[140:143], v[72:75], v[152:155], v[140:143]
  v_mfma_f32_16x16x32_bf16 v[144:147], v[40:43], v[152:155], v[144:147]
  v_mfma_f32_16x16x32_bf16 v[148:151], v[8:11], v[152:155], v[148:151]
  v_mfma_f32_16x16x32_bf16 v[220:223], v[152:155], v[184:187], 0
  v_mfma_f32_16x16x32_bf16 v[224:227], v[152:155], v[188:191], 0
  v_mfma_f32_16x16x32_bf16 v[228:231], v[152:155], v[192:195], 0
  ds_read_b128 v[172:175], v6 offset:3296
  s_waitcnt lgkmcnt(4)
  v_mfma_f32_16x16x32_bf16 v[232:235], v[156:159], v[188:191], 0
  ds_read_b128 v[152:155], v6 offset:3360
  s_waitcnt lgkmcnt(4)
  v_mfma_f32_16x16x32_bf16 v[144:147], v[44:47], v[160:163], v[144:147]
  v_mfma_f32_16x16x32_bf16 v[148:151], v[12:15], v[160:163], v[148:151]
  ds_read_b128 v[156:159], v6 offset:3424
  s_waitcnt lgkmcnt(4)
  v_mfma_f32_16x16x32_bf16 v[144:147], v[48:51], v[164:167], v[144:147]
  v_mfma_f32_16x16x32_bf16 v[148:151], v[16:19], v[164:167], v[148:151]
  ds_read_b128 v[160:163], v6 offset:3488
  v_cvt_pk_bf16_f32 v208, v220, v224
  v_cvt_pk_bf16_f32 v209, v221, v225
  v_cvt_pk_bf16_f32 v210, v222, v226
  v_cvt_pk_bf16_f32 v211, v223, v227
  v_cvt_pk_bf16_f32 v212, v228, v232
  v_cvt_pk_bf16_f32 v213, v229, v233
  v_cvt_pk_bf16_f32 v214, v230, v234
  v_cvt_pk_bf16_f32 v215, v231, v235
  s_waitcnt lgkmcnt(4)
  v_mfma_f32_16x16x32_bf16 v[144:147], v[52:55], v[168:171], v[144:147]
  v_mfma_f32_16x16x32_bf16 v[148:151], v[20:23], v[168:171], v[148:151]
  ds_read_b128 v[164:167], v6 offset:3552
  v_mfma_f32_16x16x32_bf16 v[148:151], v[208:211], v[80:83], v[148:151]
  v_mfma_f32_16x16x32_bf16 v[148:151], v[212:215], v[92:95], v[148:151]
  s_waitcnt lgkmcnt(4)
  v_mfma_f32_16x16x32_bf16 v[144:147], v[56:59], v[172:175], v[144:147]
  v_mfma_f32_16x16x32_bf16 v[148:151], v[24:27], v[172:175], v[148:151]
  ds_read_b128 v[168:171], v6 offset:3616
  s_waitcnt lgkmcnt(4)
  v_mfma_f32_16x16x32_bf16 v[144:147], v[60:63], v[152:155], v[144:147]
  v_mfma_f32_16x16x32_bf16 v[148:151], v[28:31], v[152:155], v[148:151]
  ds_read_b128 v[172:175], v6 offset:3680
  s_waitcnt lgkmcnt(4)
  v_mfma_f32_16x16x32_bf16 v[144:147], v[64:67], v[156:159], v[144:147]
  v_mfma_f32_16x16x32_bf16 v[148:151], v[32:35], v[156:159], v[148:151]
  ds_read_b128 v[152:155], v6 offset:3744
  s_waitcnt lgkmcnt(4)
  v_mfma_f32_16x16x32_bf16 v[144:147], v[68:71], v[160:163], v[144:147]
  v_mfma_f32_16x16x32_bf16 v[148:151], v[36:39], v[160:163], v[148:151]
  ds_read_b128 v[156:159], v6 offset:3808
  s_waitcnt lgkmcnt(4)
  v_mfma_f32_16x16x32_bf16 v[144:147], v[72:75], v[164:167], v[144:147]
  v_mfma_f32_16x16x32_bf16 v[148:151], v[40:43], v[164:167], v[148:151]
  ds_read_b128 v[160:163], v6 offset:3872
  s_waitcnt lgkmcnt(4)
  v_mfma_f32_16x16x32_bf16 v[148:151], v[44:47], v[168:171], v[148:151]
  ds_read_b128 v[164:167], v6 offset:3936
  s_waitcnt lgkmcnt(4)
  v_mfma_f32_16x16x32_bf16 v[148:151], v[48:51], v[172:175], v[148:151]
  ds_read_b128 v[168:171], v6 offset:4000
  s_waitcnt lgkmcnt(4)
  v_mfma_f32_16x16x32_bf16 v[148:151], v[52:55], v[152:155], v[148:151]
  ds_read_b128 v[172:175], v6 offset:4064
  s_waitcnt lgkmcnt(4)
  v_mfma_f32_16x16x32_bf16 v[148:151], v[56:59], v[156:159], v[148:151]
  s_waitcnt lgkmcnt(3)
  v_mfma_f32_16x16x32_bf16 v[148:151], v[60:63], v[160:163], v[148:151]
  s_waitcnt lgkmcnt(2)
  v_mfma_f32_16x16x32_bf16 v[148:151], v[64:67], v[164:167], v[148:151]
  s_waitcnt lgkmcnt(1)
  v_mfma_f32_16x16x32_bf16 v[148:151], v[68:71], v[168:171], v[148:151]
  s_waitcnt lgkmcnt(0)
  v_mfma_f32_16x16x32_bf16 v[148:151], v[72:75], v[172:175], v[148:151]
  v_cvt_pk_bf16_f32 v220, v140, v141
  v_cvt_pk_bf16_f32 v221, v142, v143
  v_cvt_pk_bf16_f32 v222, v144, v145
  v_cvt_pk_bf16_f32 v223, v146, v147
  s_nop 0
  v_permlane16_swap_b32 v220, v222
  v_permlane16_swap_b32 v221, v223
  buffer_store_dwordx4 v[220:223], v5, s[20:23], s27 offen offset:2560 sc1
  v_cvt_pk_bf16_f32 v224, v148, v149
  v_cvt_pk_bf16_f32 v225, v150, v151
  buffer_store_dwordx2 v[224:225], v7, s[20:23], s27 offen offset:3584 sc1
  s_lshl_b32 s28, s44, 7
  s_add_u32 s28, s28, 540672
  s_waitcnt vmcnt(0)
  v_mov_b32 v2, s3
  v_mov_b32 v3, 0
  s_mov_b64 exec, 1
  buffer_store_dword v2, v3, s[20:23], s28 offen sc1
  s_mov_b64 exec, -1
  s_setpc_b64 s[100:101]
L_hw:
  s_sub_u32 s31, s30, 2
  s_lshl_b32 s32, s31, 1
  s_lshl_b32 s44, s2, 1
  s_add_u32 s44, s44, s31
  s_lshl_b32 s45, s31, 16
  s_add_u32 s45, s45, 65536
  s_mul_i32 s46, s31, 2880
  s_add_u32 s46, s46, 152064
  s_mov_b32 s89, s31
  s_mov_b32 s99, 147456
  s_call_b64 s[100:101], L_kset
  v_lshrrev_b32 v244, 2, v1
  v_and_b32 v244, 3, v244
  v_lshrrev_b32 v245, 4, v1
  v_lshl_add_u32 v248, v245, 3, v244
  v_lshlrev_b32 v248, 7, v248
  v_lshrrev_b32 v244, 1, v244
  v_and_b32 v245, 1, v245
  v_lshl_add_u32 v244, v245, 1, v244
  v_xor_b32 v244, s32, v244
  v_lshl_add_u32 v248, v244, 5, v248
  v_and_b32 v244, 3, v1
  v_lshl_add_u32 v248, v244, 3, v248
  v_add_u32 v248, 98304, v248
  s_lshr_b32 s27, s24, 2
  s_lshl_b32 s27, s27, 13
  v_add_u32 v248, s27, v248
  v_xor_b32 v249, 32, v248
  s_and_b32 s33, s24, 1
  s_lshr_b32 s91, s2, 3
  s_sub_u32 s92, s91, 2
  s_cmp_ge_u32 s91, 27
  s_cselect_b32 s91, s92, s91
  s_mul_i32 s92, s91, 26
  s_lshr_b32 s92, s92, 8
  s_mul_i32 s93, s92, 10
  s_sub_u32 s91, s91, s93
  s_and_b32 s90, s2, 7
  s_mul_i32 s90, s90, 3
  s_add_u32 s90, s90, s92
  s_mul_i32 s90, s90, 5
  s_mul_i32 s93, s91, 5
  s_add_u32 s92, s92, s93
  s_sub_u32 s93, s92, 54
  s_cmp_ge_u32 s92, 54
  s_cselect_b32 s92, s93, s92
  s_mul_i32 s93, s90, 55296
  s_add_u32 s93, s93, 1048576
  s_lshl_b32 s94, s91, 7
  v_mov_b32 v208, 0x3f803f80
  v_mov_b32 v209, 0x3f803f80
  v_mov_b32 v210, 0x3f803f80
  v_mov_b32 v211, 0x3f803f80
  v_mov_b64 v[212:213], 0
  v_mov_b64 v[214:215], 0
  v_mov_b64 v[216:217], 0
  v_mov_b64 v[218:219], 0
  s_waitcnt vmcnt(1)
  s_call_b64 s[100:101], L_lnA
  s_call_b64 s[100:101], L_lnA2
  s_setprio 3
  s_waitcnt lgkmcnt(0)
  s_mul_i32 s3, s3, 0x9E3779B1
  s_add_u32 s3, s3, 0x7F4A7C15
  s_barrier
  s_call_b64 s[100:101], L_kread
  s_barrier
  s_call_b64 s[100:101], L_lnW
  ds_read_b64_tr_b16 v[168:169], v248 offset:0
  ds_read_b64_tr_b16 v[170:171], v248 offset:512
  ds_read_b64_tr_b16 v[172:173], v249 offset:0
  ds_read_b64_tr_b16 v[174:175], v249 offset:512
  ds_read_b64_tr_b16 v[176:177], v248 offset:4096
  ds_read_b64_tr_b16 v[178:179], v248 offset:4608
  ds_read_b64_tr_b16 v[180:181], v249 offset:4096
  ds_read_b64_tr_b16 v[182:183], v249 offset:4608
  s_waitcnt lgkmcnt(0)
  s_cmp_eq_u32 s33, 1
  s_cbranch_scc1 L_hs0
  v_mfma_f32_16x16x32_bf16 v[212:215], v[208:211], v[168:171], v[212:215]
  v_mfma_f32_16x16x32_bf16 v[216:219], v[208:211], v[172:175], v[216:219]
L_hs0:
  v_mfma_f32_16x16x32_bf16 v[212:215], v[208:211], v[176:179], v[212:215]
  v_mfma_f32_16x16x32_bf16 v[216:219], v[208:211], v[180:183], v[216:219]
  s_barrier
  ds_read_b64_tr_b16 v[168:169], v248 offset:16384
  ds_read_b64_tr_b16 v[170:171], v248 offset:16896
  ds_read_b64_tr_b16 v[172:173], v249 offset:16384
  ds_read_b64_tr_b16 v[174:175], v249 offset:16896
  ds_read_b64_tr_b16 v[176:177], v248 offset:20480
  ds_read_b64_tr_b16 v[178:179], v248 offset:20992
  ds_read_b64_tr_b16 v[180:181], v249 offset:20480
  ds_read_b64_tr_b16 v[182:183], v249 offset:20992
  s_waitcnt lgkmcnt(0)
  v_mfma_f32_16x16x32_bf16 v[212:215], v[208:211], v[168:171], v[212:215]
  v_mfma_f32_16x16x32_bf16 v[216:219], v[208:211], v[172:175], v[216:219]
  v_mfma_f32_16x16x32_bf16 v[212:215], v[208:211], v[176:179], v[212:215]
  v_mfma_f32_16x16x32_bf16 v[216:219], v[208:211], v[180:183], v[216:219]
  s_call_b64 s[100:101], L_lnB
  s_barrier
  ds_read_b64_tr_b16 v[168:169], v248 offset:32768
  ds_read_b64_tr_b16 v[170:171], v248 offset:33280
  ds_read_b64_tr_b16 v[172:173], v249 offset:32768
  ds_read_b64_tr_b16 v[174:175], v249 offset:33280
  ds_read_b64_tr_b16 v[176:177], v248 offset:36864
  ds_read_b64_tr_b16 v[178:179], v248 offset:37376
  ds_read_b64_tr_b16 v[180:181], v249 offset:36864
  ds_read_b64_tr_b16 v[182:183], v249 offset:37376
  s_waitcnt lgkmcnt(0)
  v_mfma_f32_16x16x32_bf16 v[212:215], v[208:211], v[168:171], v[212:215]
  v_mfma_f32_16x16x32_bf16 v[216:219], v[208:211], v[172:175], v[216:219]
  s_cmp_eq_u32 s33, 0
  s_cbranch_scc1 L_hs2
  v_mfma_f32_16x16x32_bf16 v[212:215], v[208:211], v[176:179], v[212:215]
  v_mfma_f32_16x16x32_bf16 v[216:219], v[208:211], v[180:183], v[216:219]
L_hs2:
  s_lshl_b32 s27, s25, 2
  s_and_b32 s28, s24, 3
  s_add_u32 s27, s27, s28
  s_lshl_b32 s27, s27, 1
  s_lshr_b32 s28, s24, 2
  s_add_u32 s27, s27, s28
  s_lshl_b32 s27, s27, 1
  s_add_u32 s27, s27, s31
  s_lshl_b32 s27, s27, 7
  s_add_u32 s27, s27, 786432
  v_lshlrev_b32 v251, 2, v1
  v_cmp_gt_u32 vcc, 16, v1
  s_nop 1
  v_cndmask_b32 v212, v216, v212, vcc
  s_mov_b32 exec_hi, 0
  buffer_store_dword v212, v251, s[20:23], s27 offen sc1
  s_mov_b64 exec, -1
  s_barrier
  s_waitcnt vmcnt(0)
  s_call_b64 s[100:101], L_lnF
  v_and_b32 v2, 15, v1
  v_lshrrev_b32 v3, 4, v1
  v_lshlrev_b32 v3, 3, v3
  v_mov_b32 v4, 14336
  v_lshlrev_b32 v4, v2, v4
  v_lshrrev_b32 v4, v3, v4
  v_bfe_u32 v5, v4, 0, 2
  v_lshl_or_b32 v5, v5, 15, v5
  v_and_b32 v5, 0x10001, v5
  v_mul_u32_u24 v184, 0x3f80, v5
  v_bfe_u32 v5, v4, 2, 2
  v_lshl_or_b32 v5, v5, 15, v5
  v_and_b32 v5, 0x10001, v5
  v_mul_u32_u24 v185, 0x3f80, v5
  v_bfe_u32 v5, v4, 4, 2
  v_lshl_or_b32 v5, v5, 15, v5
  v_and_b32 v5, 0x10001, v5
  v_mul_u32_u24 v186, 0x3f80, v5
  v_bfe_u32 v5, v4, 6, 2
  v_lshl_or_b32 v5, v5, 15, v5
  v_and_b32 v5, 0x10001, v5
  v_mul_u32_u24 v187, 0x3f80, v5
  v_mov_b32 v4, 1984
  v_lshlrev_b32 v4, v2, v4
  v_lshrrev_b32 v4, v3, v4
  v_bfe_u32 v5, v4, 0, 2
  v_lshl_or_b32 v5, v5, 15, v5
  v_and_b32 v5, 0x10001, v5
  v_mul_u32_u24 v188, 0x3f80, v5
  v_bfe_u32 v5, v4, 2, 2
  v_lshl_or_b32 v5, v5, 15, v5
  v_and_b32 v5, 0x10001, v5
  v_mul_u32_u24 v189, 0x3f80, v5
  v_bfe_u32 v5, v4, 4, 2
  v_lshl_or_b32 v5, v5, 15, v5
  v_and_b32 v5, 0x10001, v5
  v_mul_u32_u24 v190, 0x3f80, v5
  v_bfe_u32 v5, v4, 6, 2
  v_lshl_or_b32 v5, v5, 15, v5
  v_and_b32 v5, 0x10001, v5
  v_mul_u32_u24 v191, 0x3f80, v5
  v_mov_b32 v4, 56
  v_lshlrev_b32 v4, v2, v4
  v_lshrrev_b32 v4, v3, v4
  v_bfe_u32 v5, v4, 0, 2
  v_lshl_or_b32 v5, v5, 15, v5
  v_and_b32 v5, 0x10001, v5
  v_mul_u32_u24 v192, 0x3f80, v5
  v_bfe_u32 v5, v4, 2, 2
  v_lshl_or_b32 v5, v5, 15, v5
  v_and_b32 v5, 0x10001, v5
  v_mul_u32_u24 v193, 0x3f80, v5
  v_bfe_u32 v5, v4, 4, 2
  v_lshl_or_b32 v5, v5, 15, v5
  v_and_b32 v5, 0x10001, v5
  v_mul_u32_u24 v194, 0x3f80, v5
  v_bfe_u32 v5, v4, 6, 2
  v_lshl_or_b32 v5, v5, 15, v5
  v_and_b32 v5, 0x10001, v5
  v_mul_u32_u24 v195, 0x3f80, v5
  s_barrier
  v_and_b32 v2, 15, v1
  v_lshrrev_b32 v3, 4, v1
  v_lshlrev_b32 v3, 3, v3
  v_mov_b32 v4, 4064
  v_lshlrev_b32 v4, v2, v4
  v_lshrrev_b32 v4, v3, v4
  v_bfe_u32 v5, v4, 0, 2
  v_lshl_or_b32 v5, v5, 15, v5
  v_and_b32 v5, 0x10001, v5
  v_mul_u32_u24 v196, 0x3f80, v5
  v_bfe_u32 v5, v4, 2, 2
  v_lshl_or_b32 v5, v5, 15, v5
  v_and_b32 v5, 0x10001, v5
  v_mul_u32_u24 v197, 0x3f80, v5
  v_bfe_u32 v5, v4, 4, 2
  v_lshl_or_b32 v5, v5, 15, v5
  v_and_b32 v5, 0x10001, v5
  v_mul_u32_u24 v198, 0x3f80, v5
  v_bfe_u32 v5, v4, 6, 2
  v_lshl_or_b32 v5, v5, 15, v5
  v_and_b32 v5, 0x10001, v5
  v_mul_u32_u24 v199, 0x3f80, v5
  v_mov_b32 v4, 8176
  v_lshlrev_b32 v4, v2, v4
  v_lshrrev_b32 v4, v3, v4
  v_bfe_u32 v5, v4, 0, 2
  v_lshl_or_b32 v5, v5, 15, v5
  v_and_b32 v5, 0x10001, v5
  v_mul_u32_u24 v200, 0x3f80, v5
  v_bfe_u32 v5, v4, 2, 2
  v_lshl_or_b32 v5, v5, 15, v5
  v_and_b32 v5, 0x10001, v5
  v_mul_u32_u24 v201, 0x3f80, v5
  v_bfe_u32 v5, v4, 4, 2
  v_lshl_or_b32 v5, v5, 15, v5
  v_and_b32 v5, 0x10001, v5
  v_mul_u32_u24 v202, 0x3f80, v5
  v_bfe_u32 v5, v4, 6, 2
  v_lshl_or_b32 v5, v5, 15, v5
  v_and_b32 v5, 0x10001, v5
  v_mul_u32_u24 v203, 0x3f80, v5
  v_mov_b32 v4, 12288
  v_lshlrev_b32 v4, v2, v4
  v_lshrrev_b32 v4, v3, v4
  v_bfe_u32 v5, v4, 0, 2
  v_lshl_or_b32 v5, v5, 15, v5
  v_and_b32 v5, 0x10001, v5
  v_mul_u32_u24 v204, 0xffff, v5
  v_bfe_u32 v5, v4, 2, 2
  v_lshl_or_b32 v5, v5, 15, v5
  v_and_b32 v5, 0x10001, v5
  v_mul_u32_u24 v205, 0xffff, v5
  v_bfe_u32 v5, v4, 4, 2
  v_lshl_or_b32 v5, v5, 15, v5
  v_and_b32 v5, 0x10001, v5
  v_mul_u32_u24 v206, 0xffff, v5
  v_bfe_u32 v5, v4, 6, 2
  v_lshl_or_b32 v5, v5, 15, v5
  v_and_b32 v5, 0x10001, v5
  v_mul_u32_u24 v207, 0xffff, v5
  s_barrier
  s_barrier
  s_and_b32 s33, s2, 7
  s_lshl_b32 s33, s33, 7
  s_add_u32 s33, s33, 262144
  v_mov_b32 v173, 0
  buffer_load_dword v160, v173, s[20:23], s33 offen sc1
  s_barrier
  s_mov_b32 s47, 100000
  s_branch L_xpoll_go
L_xpoll_again:
  s_sleep 4
  buffer_load_dword v160, v173, s[20:23], s33 offen sc1
L_xpoll_go:
  s_sub_u32 s47, s47, 1
  s_waitcnt vmcnt(0)
  v_xor_b32 v160, s3, v160
  v_cmp_ne_u32 vcc, 0, v160
  s_cmp_eq_u32 s47, 0
  s_cbranch_scc1 L_xpoll_done
  s_cbranch_vccnz L_xpoll_again
L_xpoll_done:
  s_lshl_b32 s27, s24, 1
  s_add_u32 s27, s27, s31
  s_lshl_b32 s27, s27, 11
  s_add_u32 s27, s27, 4096
  s_lshl_b32 s28, s31, 11
  s_add_u32 m0, s28, 147456
  v_lshlrev_b32 v172, 4, v1
  buffer_load_dwordx4 v172, s[20:23], s27 offen sc1 lds
  buffer_load_dwordx4 v172, s[20:23], s27 offen offset:1024 sc1 lds
  s_lshl_b32 s27, s25, 1
  s_add_u32 s27, s27, s31
  s_lshl_b32 s27, s27, 10
  s_add_u32 s27, s27, 786432
  s_lshl_b32 s28, s31, 10
  s_add_u32 m0, s28, 157824
  s_nop 0
  buffer_load_dwordx4 v172, s[20:23], s27 offen sc1 lds
  s_xor_b32 s45, s30, 2
  s_mul_i32 s45, s45, 4608
  s_add_u32 s45, s45, 131072
  s_cmp_eq_u32 s30, 1
  s_cselect_b32 s45, 147456, s45
  s_barrier
  s_waitcnt vmcnt(0)
  s_barrier
  s_lshr_b32 s28, s44, 2
  s_lshl_b32 s28, s28, 14
  s_and_b32 s34, s44, 3
  s_lshl_b32 s34, s34, 4
  s_add_u32 s28, s28, s34
  s_add_u32 s28, s28, 12582912
  v_lshlrev_b32 v5, 6, v1
  s_mov_b32 m0, s45
  s_mov_b32 s34, 2147483392
  s_mov_b32 exec_hi, 0
  buffer_load_dwordx4 v5, s[20:23], s34 offen lds
  s_mov_b64 exec, -1
  s_add_u32 m0, s45, 512
  s_add_u32 s34, s28, 0
  buffer_load_dwordx4 v5, s[20:23], s34 offen sc1 lds
  s_add_u32 m0, s45, 1536
  s_add_u32 s34, s28, 4096
  buffer_load_dwordx4 v5, s[20:23], s34 offen sc1 lds
  s_add_u32 m0, s45, 2560
  s_add_u32 s34, s28, 8192
  buffer_load_dwordx4 v5, s[20:23], s34 offen sc1 lds
  s_add_u32 m0, s45, 3584
  s_add_u32 s34, s28, 12288
  buffer_load_dwordx4 v5, s[20:23], s34 offen sc1 lds
  s_barrier
  s_setprio 0
  s_call_b64 s[100:101], L_kmm
  s_call_b64 s[100:101], L_kmm2
  s_call_b64 s[100:101], L_kfin0
  s_call_b64 s[100:101], L_kfin1
  s_barrier
  s_call_b64 s[100:101], L_cprep0
  s_call_b64 s[100:101], L_cprep1
  v_and_b32 v2, 15, v1
  v_lshrrev_b32 v3, 4, v1
  v_lshlrev_b32 v6, 5, v2
  v_lshl_add_u32 v7, v3, 3, v6
  v_and_b32 v4, 1, v3
  v_mul_u32_u24 v4, 504, v4
  v_add_u32 v5, v7, v4
  v_lshl_add_u32 v6, v3, 4, v6
  v_add_u32 v6, s45, v6
  s_lshl_b32 s27, s44, 12
  s_add_u32 s27, s27, 18874368
  s_waitcnt vmcnt(0) lgkmcnt(0)
  s_barrier
  s_setprio 2
  s_call_b64 s[100:101], L_cvB
L_cvd:
  s_setprio 0
  s_xor_b32 s45, s30, 2
  s_mul_i32 s45, s45, 4608
  s_add_u32 s45, s45, 131072
  s_cmp_eq_u32 s30, 1
  s_cselect_b32 s45, 147456, s45
  s_sub_u32 s27, s2, 216
  s_cmp_lt_u32 s27, 16
  s_cbranch_scc1 L_ygo
  v_lshrrev_b32 v78, 3, v0
  v_and_b32 v79, 7, v0
  v_mul_u32_u24 v72, 1280, v78
  v_lshl_add_u32 v72, v79, 4, v72
  s_mul_i32 s36, s90, 20480
  s_add_u32 s36, s36, s94
  buffer_load_dwordx4 v[64:67], v72, s[8:11], s36 offen
  v_mul_u32_u24 v74, 272, v78
  v_lshl_add_u32 v74, v79, 5, v74
  v_mul_u32_u24 v76, 144, v78
  v_lshl_add_u32 v76, v79, 4, v76
  v_add_u32 v76, 152064, v76
  v_lshrrev_b32 v78, 3, v0
  v_and_b32 v79, 7, v0
  v_add_u32 v78, 16, v78
  v_mul_u32_u24 v73, 1280, v78
  v_lshl_add_u32 v73, v79, 4, v73
  s_mul_i32 s36, s90, 20480
  s_add_u32 s36, s36, s94
  buffer_load_dwordx4 v[68:71], v73, s[8:11], s36 offen
  v_mul_u32_u24 v75, 272, v78
  v_lshl_add_u32 v75, v79, 5, v75
  v_mul_u32_u24 v77, 144, v78
  v_lshl_add_u32 v77, v79, 4, v77
  v_add_u32 v77, 152064, v77
  s_mov_b32 s12, s84
  s_mov_b32 s13, s85
  s_mov_b32 s14, 2621440
  s_mov_b32 s15, 0x20000
  v_add_u32 v2, 0, v1
  v_min_u32 v2, 159, v2
  v_mul_u32_u24 v3, 6554, v2
  v_lshrrev_b32 v3, 16, v3
  v_mul_u32_u24 v3, 3936, v3
  v_lshl_add_u32 v20, v2, 4, v3
  v_add_u32 v2, 64, v1
  v_min_u32 v2, 159, v2
  v_mul_u32_u24 v3, 6554, v2
  v_lshrrev_b32 v3, 16, v3
  v_mul_u32_u24 v3, 3936, v3
  v_lshl_add_u32 v21, v2, 4, v3
  v_add_u32 v2, 128, v1
  v_min_u32 v2, 159, v2
  v_mul_u32_u24 v3, 6554, v2
  v_lshrrev_b32 v3, 16, v3
  v_mul_u32_u24 v3, 3936, v3
  v_lshl_add_u32 v22, v2, 4, v3
  s_lshl_b32 s34, s91, 2
  s_add_u32 s34, s34, s30
  s_lshl_b32 s34, s34, 16
  s_lshl_b32 s28, s90, 5
  s_add_u32 s34, s34, s28
  s_add_u32 s34, s34, 18874368
  v_lshrrev_b32 v4, 2, v1
  v_mul_u32_u24 v4, 160, v4
  v_and_b32 v5, 3, v1
  v_lshl_add_u32 v4, v5, 3, v4
  v_add_u32 v4, s45, v4
  v_and_b32 v5, 15, v1
  v_mul_u32_u24 v5, 144, v5
  v_lshrrev_b32 v6, 4, v1
  v_lshl_add_u32 v5, v6, 3, v5
  s_lshl_b32 s28, s30, 5
  s_add_u32 s28, s28, 152064
  v_add_u32 v5, s28, v5
  s_lshl_b32 s27, s91, 2
  s_add_u32 s27, s27, s30
  s_lshl_b32 s27, s27, 11
  s_add_u32 s27, s27, 458752
  s_add_u32 s28, s27, 81920
  s_cmp_lt_u32 s90, 80
  s_cselect_b32 s27, s27, s28
  v_and_b32 v2, 15, v1
  v_lshlrev_b32 v2, 7, v2
  s_barrier
  s_mov_b32 s47, 100000
  s_branch L_ypoll_go
L_ypoll_again:
  s_sleep 4
L_ypoll_go:
  buffer_load_dword v8, v2, s[20:23], s27 offen sc1
  s_sub_u32 s47, s47, 1
  s_waitcnt vmcnt(0)
  v_xor_b32 v8, s3, v8
  v_cmp_ne_u32 vcc, 0, v8
  s_cmp_eq_u32 s47, 0
  s_cbranch_scc1 L_ypoll_done
  s_cbranch_vccnz L_ypoll_again
L_ypoll_done:
  s_add_u32 m0, s45, 0
  s_nop 0
  buffer_load_dwordx4 v20, s[20:23], s34 offen sc1 lds
  s_add_u32 m0, s45, 1024
  s_nop 0
  buffer_load_dwordx4 v21, s[20:23], s34 offen sc1 lds
  s_add_u32 m0, s45, 2048
  s_nop 0
  buffer_load_dwordx4 v22, s[20:23], s34 offen sc1 lds
  s_waitcnt vmcnt(0)
  ds_read_b64_tr_b16 v[8:9], v4 offset:0
  ds_read_b64_tr_b16 v[10:11], v4 offset:32
  ds_read_b64_tr_b16 v[12:13], v4 offset:64
  ds_read_b64_tr_b16 v[14:15], v4 offset:96
  ds_read_b64_tr_b16 v[16:17], v4 offset:128
  s_waitcnt lgkmcnt(0)
  ds_write_b64 v5, v[8:9] offset:0
  ds_write_b64 v5, v[10:11] offset:2304
  ds_write_b64 v5, v[12:13] offset:4608
  ds_write_b64 v5, v[14:15] offset:6912
  ds_write_b64 v5, v[16:17] offset:9216
  s_waitcnt lgkmcnt(0)
L_join:
  s_waitcnt vmcnt(0)
  v_add_u32 v78, 0x10000, v74
  v_lshlrev_b32 v88, 16, v64
  v_and_b32 v89, 0xffff0000, v64
  v_lshlrev_b32 v90, 16, v65
  v_and_b32 v91, 0xffff0000, v65
  v_lshlrev_b32 v92, 16, v66
  v_and_b32 v93, 0xffff0000, v66
  v_lshlrev_b32 v94, 16, v67
  v_and_b32 v95, 0xffff0000, v67
  s_cmp_ge_u32 s26, 6
  s_cbranch_scc1 L_fin2
  s_waitcnt lgkmcnt(0)
  s_barrier
  ds_read_b128 v[40:43], v76
  ds_read_b128 v[8:11], v74 offset:0
  ds_read_b128 v[12:15], v74 offset:16
  ds_read_b128 v[16:19], v74 offset:32768
  ds_read_b128 v[20:23], v74 offset:32784
  ds_read_b128 v[24:27], v78 offset:0
  ds_read_b128 v[28:31], v78 offset:16
  ds_read_b128 v[32:35], v78 offset:32768
  ds_read_b128 v[36:39], v78 offset:32784
  s_waitcnt lgkmcnt(8)
  v_lshlrev_b32 v44, 16, v40
  v_and_b32 v45, 0xffff0000, v40
  v_lshlrev_b32 v46, 16, v41
  v_and_b32 v47, 0xffff0000, v41
  v_lshlrev_b32 v48, 16, v42
  v_and_b32 v49, 0xffff0000, v42
  v_lshlrev_b32 v50, 16, v43
  v_and_b32 v51, 0xffff0000, v43
  v_pk_add_f32 v[88:89], v[88:89], v[44:45]
  v_pk_add_f32 v[90:91], v[90:91], v[46:47]
  v_pk_add_f32 v[92:93], v[92:93], v[48:49]
  v_pk_add_f32 v[94:95], v[94:95], v[50:51]
  s_waitcnt lgkmcnt(6)
  v_pk_add_f32 v[88:89], v[88:89], v[8:9]
  v_pk_add_f32 v[90:91], v[90:91], v[10:11]
  v_pk_add_f32 v[92:93], v[92:93], v[12:13]
  v_pk_add_f32 v[94:95], v[94:95], v[14:15]
  s_waitcnt lgkmcnt(4)
  v_pk_add_f32 v[88:89], v[88:89], v[16:17]
  v_pk_add_f32 v[90:91], v[90:91], v[18:19]
  v_pk_add_f32 v[92:93], v[92:93], v[20:21]
  v_pk_add_f32 v[94:95], v[94:95], v[22:23]
  s_waitcnt lgkmcnt(2)
  v_pk_add_f32 v[88:89], v[88:89], v[24:25]
  v_pk_add_f32 v[90:91], v[90:91], v[26:27]
  v_pk_add_f32 v[92:93], v[92:93], v[28:29]
  v_pk_add_f32 v[94:95], v[94:95], v[30:31]
  s_waitcnt lgkmcnt(0)
  v_pk_add_f32 v[88:89], v[88:89], v[32:33]
  v_pk_add_f32 v[90:91], v[90:91], v[34:35]
  v_pk_add_f32 v[92:93], v[92:93], v[36:37]
  v_pk_add_f32 v[94:95], v[94:95], v[38:39]
  v_cvt_pk_bf16_f32 v80, v88, v89
  v_cvt_pk_bf16_f32 v81, v90, v91
  v_cvt_pk_bf16_f32 v82, v92, v93
  v_cvt_pk_bf16_f32 v83, v94, v95
  buffer_store_dwordx4 v[80:83], v72, s[12:15], s36 offen sc0 sc1
  s_branch L_fin
L_fin2:
  v_add_u32 v79, 0x10000, v75
  v_lshlrev_b32 v96, 16, v68
  v_and_b32 v97, 0xffff0000, v68
  v_lshlrev_b32 v98, 16, v69
  v_and_b32 v99, 0xffff0000, v69
  v_lshlrev_b32 v100, 16, v70
  v_and_b32 v101, 0xffff0000, v70
  v_lshlrev_b32 v102, 16, v71
  v_and_b32 v103, 0xffff0000, v71
  s_waitcnt lgkmcnt(0)
  s_barrier
  ds_read_b128 v[40:43], v76
  ds_read_b128 v[8:11], v74 offset:0
  ds_read_b128 v[12:15], v74 offset:16
  ds_read_b128 v[16:19], v74 offset:32768
  ds_read_b128 v[20:23], v74 offset:32784
  ds_read_b128 v[24:27], v78 offset:0
  ds_read_b128 v[28:31], v78 offset:16
  ds_read_b128 v[32:35], v78 offset:32768
  ds_read_b128 v[36:39], v78 offset:32784
  ds_read_b128 v[144:147], v77
  ds_read_b128 v[112:115], v75 offset:0
  ds_read_b128 v[116:119], v75 offset:16
  ds_read_b128 v[120:123], v75 offset:32768
  ds_read_b128 v[124:127], v75 offset:32784
  ds_read_b128 v[128:131], v79 offset:0
  ds_read_b128 v[132:135], v79 offset:16
  ds_read_b128 v[136:139], v79 offset:32768
  ds_read_b128 v[140:143], v79 offset:32784
  s_waitcnt lgkmcnt(15)
  v_lshlrev_b32 v44, 16, v40
  v_and_b32 v45, 0xffff0000, v40
  v_lshlrev_b32 v46, 16, v41
  v_and_b32 v47, 0xffff0000, v41
  v_lshlrev_b32 v48, 16, v42
  v_and_b32 v49, 0xffff0000, v42
  v_lshlrev_b32 v50, 16, v43
  v_and_b32 v51, 0xffff0000, v43
  v_pk_add_f32 v[88:89], v[88:89], v[44:45]
  v_pk_add_f32 v[90:91], v[90:91], v[46:47]
  v_pk_add_f32 v[92:93], v[92:93], v[48:49]
  v_pk_add_f32 v[94:95], v[94:95], v[50:51]
  s_waitcnt lgkmcnt(15)
  v_pk_add_f32 v[88:89], v[88:89], v[8:9]
  v_pk_add_f32 v[90:91], v[90:91], v[10:11]
  v_pk_add_f32 v[92:93], v[92:93], v[12:13]
  v_pk_add_f32 v[94:95], v[94:95], v[14:15]
  s_waitcnt lgkmcnt(13)
  v_pk_add_f32 v[88:89], v[88:89], v[16:17]
  v_pk_add_f32 v[90:91], v[90:91], v[18:19]
  v_pk_add_f32 v[92:93], v[92:93], v[20:21]
  v_pk_add_f32 v[94:95], v[94:95], v[22:23]
  s_waitcnt lgkmcnt(11)
  v_pk_add_f32 v[88:89], v[88:89], v[24:25]
  v_pk_add_f32 v[90:91], v[90:91], v[26:27]
  v_pk_add_f32 v[92:93], v[92:93], v[28:29]
  v_pk_add_f32 v[94:95], v[94:95], v[30:31]
  s_waitcnt lgkmcnt(9)
  v_pk_add_f32 v[88:89], v[88:89], v[32:33]
  v_pk_add_f32 v[90:91], v[90:91], v[34:35]
  v_pk_add_f32 v[92:93], v[92:93], v[36:37]
  v_pk_add_f32 v[94:95], v[94:95], v[38:39]
  v_cvt_pk_bf16_f32 v80, v88, v89
  v_cvt_pk_bf16_f32 v81, v90, v91
  v_cvt_pk_bf16_f32 v82, v92, v93
  v_cvt_pk_bf16_f32 v83, v94, v95
  buffer_store_dwordx4 v[80:83], v72, s[12:15], s36 offen sc0 sc1
  s_waitcnt lgkmcnt(8)
  v_lshlrev_b32 v148, 16, v144
  v_and_b32 v149, 0xffff0000, v144
  v_lshlrev_b32 v150, 16, v145
  v_and_b32 v151, 0xffff0000, v145
  v_lshlrev_b32 v152, 16, v146
  v_and_b32 v153, 0xffff0000, v146
  v_lshlrev_b32 v154, 16, v147
  v_and_b32 v155, 0xffff0000, v147
  v_pk_add_f32 v[96:97], v[96:97], v[148:149]
  v_pk_add_f32 v[98:99], v[98:99], v[150:151]
  v_pk_add_f32 v[100:101], v[100:101], v[152:153]
  v_pk_add_f32 v[102:103], v[102:103], v[154:155]
  s_waitcnt lgkmcnt(6)
  v_pk_add_f32 v[96:97], v[96:97], v[112:113]
  v_pk_add_f32 v[98:99], v[98:99], v[114:115]
  v_pk_add_f32 v[100:101], v[100:101], v[116:117]
  v_pk_add_f32 v[102:103], v[102:103], v[118:119]
  s_waitcnt lgkmcnt(4)
  v_pk_add_f32 v[96:97], v[96:97], v[120:121]
  v_pk_add_f32 v[98:99], v[98:99], v[122:123]
  v_pk_add_f32 v[100:101], v[100:101], v[124:125]
  v_pk_add_f32 v[102:103], v[102:103], v[126:127]
  s_waitcnt lgkmcnt(2)
  v_pk_add_f32 v[96:97], v[96:97], v[128:129]
  v_pk_add_f32 v[98:99], v[98:99], v[130:131]
  v_pk_add_f32 v[100:101], v[100:101], v[132:133]
  v_pk_add_f32 v[102:103], v[102:103], v[134:135]
  s_waitcnt lgkmcnt(0)
  v_pk_add_f32 v[96:97], v[96:97], v[136:137]
  v_pk_add_f32 v[98:99], v[98:99], v[138:139]
  v_pk_add_f32 v[100:101], v[100:101], v[140:141]
  v_pk_add_f32 v[102:103], v[102:103], v[142:143]
  v_cvt_pk_bf16_f32 v84, v96, v97
  v_cvt_pk_bf16_f32 v85, v98, v99
  v_cvt_pk_bf16_f32 v86, v100, v101
  v_cvt_pk_bf16_f32 v87, v102, v103
  buffer_store_dwordx4 v[84:87], v73, s[12:15], s36 offen sc0 sc1
L_fin:
  s_endpgm
L_aux:
  s_sub_u32 s31, s2, 216
  s_lshr_b32 s32, s26, 1
  s_and_b32 s33, s2, 7
  s_lshr_b32 s39, s31, 3
  s_and_b32 s89, s26, 1
  v_mov_b32 v166, 0
  s_mov_b32 s99, 131072
  s_lshl_b32 s35, s31, 2
  s_add_u32 s35, s35, 432
  s_add_u32 s44, s35, s32
  s_and_b32 s82, s26, 3
  s_add_u32 s82, s82, s35
  s_lshl_b32 s36, s31, 1
  s_add_u32 s36, s36, 560
  s_and_b32 s37, s32, 1
  s_add_u32 s36, s36, s37
  s_min_u32 s36, s36, 639
  s_lshl_b32 s27, s44, 8
  v_lshl_add_u32 v14, v1, 2, s27
  s_lshl_b32 s27, s44, 1
  v_mov_b32 v15, s27
  s_waitcnt lgkmcnt(0)
  global_load_dword v16, v14, s[48:49]
  global_load_dword v17, v14, s[50:51]
  global_load_dword v18, v14, s[52:53]
  global_load_dword v19, v14, s[54:55]
  global_load_ushort v20, v15, s[56:57]
  s_load_dword s3, s[6:7], 0
  s_mov_b64 s[8:9], s[4:5]
  s_mov_b64 s[12:13], s[40:41]
  s_mov_b64 s[16:17], s[42:43]
  s_mov_b64 s[20:21], s[6:7]
  s_lshl_b32 s27, s82, 1
  v_mov_b32 v15, s27
  global_load_ushort v13, v15, s[58:59]
  s_lshl_b32 s27, s36, 8
  v_lshl_add_u32 v14, v1, 2, s27
  s_lshl_b32 s27, s36, 1
  v_mov_b32 v15, s27
  global_load_dword v208, v14, s[48:49]
  global_load_dword v209, v14, s[50:51]
  global_load_dword v210, v14, s[52:53]
  global_load_dword v211, v14, s[54:55]
  global_load_ushort v212, v15, s[56:57]
  s_lshl_b32 s27, s36, 1
  v_mov_b32 v15, s27
  global_load_ushort v213, v15, s[58:59]
  s_cmp_lg_u32 s32, 1
  s_cbranch_scc1 L_a1
  v_lshrrev_b32 v14, 4, v1
  v_mul_u32_u24 v14, 1280, v14
  v_and_b32 v15, 15, v1
  v_lshl_add_u32 v14, v15, 4, v14
  s_lshl_b32 s27, s29, 1
  s_add_u32 s27, s27, s89
  s_mul_i32 s27, s27, 5120
  buffer_load_dwordx4 v[144:147], v14, s[8:11], s27 offen offset:0
  buffer_load_dwordx4 v[148:151], v14, s[8:11], s27 offen offset:256
  buffer_load_dwordx4 v[152:155], v14, s[8:11], s27 offen offset:512
  buffer_load_dwordx4 v[156:159], v14, s[8:11], s27 offen offset:768
  buffer_load_dwordx4 v[160:163], v14, s[8:11], s27 offen offset:1024
L_a1:
  s_lshr_b32 s91, s2, 3
  s_sub_u32 s92, s91, 2
  s_cmp_ge_u32 s91, 27
  s_cselect_b32 s91, s92, s91
  s_mul_i32 s92, s91, 26
  s_lshr_b32 s92, s92, 8
  s_mul_i32 s93, s92, 10
  s_sub_u32 s91, s91, s93
  s_and_b32 s90, s2, 7
  s_mul_i32 s90, s90, 3
  s_add_u32 s90, s90, s92
  s_mul_i32 s90, s90, 5
  s_mul_i32 s93, s91, 5
  s_add_u32 s92, s92, s93
  s_sub_u32 s93, s92, 54
  s_cmp_ge_u32 s92, 54
  s_cselect_b32 s92, s93, s92
  s_mul_i32 s93, s90, 55296
  s_add_u32 s93, s93, 1048576
  s_lshl_b32 s94, s91, 7
  s_cmp_ge_u32 s31, 16
  s_cbranch_scc1 L_a0
  s_and_b32 s90, s2, 4
  s_add_u32 s90, s90, 120
  s_and_b32 s91, s2, 3
  s_lshl_b32 s91, s91, 1
  s_bfe_u32 s92, s2, 0x10003
  s_xor_b32 s92, s92, 1
  s_add_u32 s91, s91, s92
  s_mul_i32 s92, s92, 27
  s_mul_i32 s93, s90, 55296
  s_add_u32 s93, s93, 1048576
  s_mul_i32 s94, s91, 160
L_a0:
  s_add_u32 s96, s92, s26
  s_sub_u32 s97, s96, 54
  s_cmp_ge_u32 s96, 54
  s_cselect_b32 s96, s97, s96
  s_lshl_b32 s95, s26, 15
  s_mul_i32 s83, s30, 2880
  s_add_u32 s83, s83, 152064
  s_mov_b32 s47, s26
  s_lshl_b32 s45, s32, 15
  v_lshl_add_u32 v120, v1, 3, s45
  v_xor_b32 v121, 32, v120
  v_xor_b32 v122, 64, v120
  v_xor_b32 v123, 96, v120
  v_xor_b32 v124, 128, v120
  v_xor_b32 v125, 160, v120
  v_xor_b32 v126, 192, v120
  v_xor_b32 v127, 224, v120
  s_call_b64 s[100:101], L_ccon
  s_waitcnt vmcnt(0)
  s_cmp_lg_u32 s32, 1
  s_cbranch_scc1 L_a2
  s_call_b64 s[100:101], L_lnA
  s_call_b64 s[100:101], L_lnA2
  s_call_b64 s[100:101], L_lnW
L_a2:
  s_call_b64 s[100:101], L_krows
  s_waitcnt lgkmcnt(0)
  s_mul_i32 s3, s3, 0x9E3779B1
  s_add_u32 s3, s3, 0x7F4A7C15
  s_cmp_ge_u32 s26, 4
  s_cbranch_scc0 L_r1n
  s_lshl_b32 s45, s30, 15
  s_mov_b32 s46, s83
  s_call_b64 s[100:101], L_kset
  s_barrier
  s_call_b64 s[100:101], L_kread
  s_barrier
  s_call_b64 s[100:101], L_kmm
  s_call_b64 s[100:101], L_kmm2
  s_call_b64 s[100:101], L_kfin0
  s_call_b64 s[100:101], L_kfin1
  s_branch L_r1d
L_r1n:
  s_barrier
  s_cmp_lg_u32 s32, 1
  s_cbranch_scc1 L_a2b
  s_call_b64 s[100:101], L_lnB
L_a2b:
  s_barrier
L_r1d:
  s_cmp_lg_u32 s32, 1
  s_cbranch_scc1 L_a2c
  s_waitcnt vmcnt(0)
  s_call_b64 s[100:101], L_lnF
L_a2c:
  s_cmp_lt_u32 s26, 4
  s_cbranch_scc1 L_a2d
  s_cmp_lt_u32 s31, 16
  s_cbranch_scc1 L_a2d
  s_cmp_eq_u32 s31, 39
  s_cbranch_scc1 L_a2d
  s_lshl_b32 s34, s39, 2
  s_add_u32 s34, s34, s30
  s_sub_u32 s34, s34, 8
  s_mul_i32 s34, s34, 320
  s_mul_i32 s28, s33, 2160
  s_add_u32 s34, s34, s28
  s_mov_b32 s16, s86
  s_mov_b32 s17, s87
  s_mov_b32 s18, 2211840
  s_mov_b32 s19, 0x20000
  s_lshl_b32 s27, s34, 7
  v_lshlrev_b32 v251, 7, v1
  buffer_load_dword v250, v251, s[16:19], s27 offen
  s_add_u32 s27, s27, 8192
  buffer_load_dword v250, v251, s[16:19], s27 offen
  s_add_u32 s27, s27, 8192
  buffer_load_dword v250, v251, s[16:19], s27 offen
  s_add_u32 s27, s27, 8192
  buffer_load_dword v250, v251, s[16:19], s27 offen
  s_add_u32 s27, s27, 8192
  buffer_load_dword v250, v251, s[16:19], s27 offen
L_a2d:
  s_lshl_b32 s27, s2, 3
  s_add_u32 s27, s27, s26
  s_cmp_lg_u32 s27, 2047
  s_cbranch_scc1 L_a7
  v_lshlrev_b32 v2, 4, v1
  s_mov_b32 s28, 196608
  s_mov_b32 s47, 100000
  s_branch L_epoll_go
L_epoll_again:
  s_sleep 4
L_epoll_go:
  buffer_load_dwordx4 v[8:11], v2, s[20:23], s28 offen sc1
  buffer_load_dwordx4 v[12:15], v2, s[20:23], s28 offen offset:1024 sc1
  s_sub_u32 s47, s47, 1
  s_waitcnt vmcnt(0)
  v_xor_b32 v8, s3, v8
  v_xor_b32 v9, s3, v9
  v_xor_b32 v10, s3, v10
  v_xor_b32 v11, s3, v11
  v_xor_b32 v12, s3, v12
  v_xor_b32 v13, s3, v13
  v_xor_b32 v14, s3, v14
  v_xor_b32 v15, s3, v15
  v_or3_b32 v8, v8, v9, v10
  v_or3_b32 v8, v8, v11, v12
  v_or3_b32 v8, v8, v13, v14
  v_or_b32 v8, v8, v15
  v_cmp_ne_u32 vcc, 0, v8
  s_cmp_eq_u32 s47, 0
  s_cbranch_scc1 L_epoll_done
  s_cbranch_vccnz L_epoll_again
L_epoll_done:
  v_mov_b32 v2, s3
  v_lshlrev_b32 v3, 7, v1
  s_mov_b32 s27, 262144
  s_mov_b64 exec, 0xff
  buffer_store_dword v2, v3, s[20:23], s27 offen sc1
  s_mov_b64 exec, 1
  buffer_store_dword v2, v3, s[20:23], 0 offen sc1
  s_mov_b64 exec, -1
L_a7:
  s_mov_b32 s37, 0
  s_cmp_lt_u32 s31, 16
  s_cbranch_scc1 L_rxd
  s_cmp_ge_u32 s26, 4
  s_cbranch_scc1 L_a3
  v_mov_b32 v16, v208
  v_mov_b32 v17, v209
  v_mov_b32 v18, v210
  v_mov_b32 v19, v211
  v_mov_b32 v20, v212
  s_call_b64 s[100:101], L_krows
L_a3:
  s_cmp_ge_u32 s31, 16
  s_cselect_b32 s37, 1, 0
  s_cmp_lt_u32 s26, 4
  s_cselect_b32 s37, s37, 0
  s_cmp_eq_u32 s37, 1
  s_cbranch_scc0 L_rxn
  s_lshl_b32 s45, s32, 15
  s_mov_b32 s46, s95
  s_mov_b32 s83, s95
  s_mov_b32 s82, s36
  v_mov_b32 v13, v213
  s_call_b64 s[100:101], L_kset
  s_barrier
  s_call_b64 s[100:101], L_kread
  s_barrier
  s_call_b64 s[100:101], L_kmm
  s_call_b64 s[100:101], L_kmm2
  s_call_b64 s[100:101], L_kfin0
  s_call_b64 s[100:101], L_kfin1
  s_branch L_rxd
L_rxn:
  s_barrier
  s_barrier
L_rxd:
  s_cmp_ge_u32 s26, 4
  s_cbranch_scc1 L_a6
  s_cmp_eq_u32 s37, 0
  s_cbranch_scc1 L_a5
L_a6:
  s_mov_b32 s44, s82
  s_mov_b32 s46, s83
  s_cmp_ge_u32 s31, 16
  s_cbranch_scc1 L_a6b
  s_call_b64 s[100:101], L_cprep0
  s_call_b64 s[100:101], L_cprep1
L_a6b:
  s_and_b32 s28, s2, 7
  s_lshl_b32 s28, s28, 7
  s_add_u32 s28, s28, 262144
  v_mov_b32 v2, 0
  s_mov_b32 s47, 100000
  s_branch L_apoll_go
L_apoll_again:
  s_sleep 6
L_apoll_go:
  buffer_load_dword v4, v2, s[20:23], s28 offen sc1
  s_sub_u32 s47, s47, 1
  s_waitcnt vmcnt(0)
  v_xor_b32 v4, s3, v4
  v_cmp_ne_u32 vcc, 0, v4
  s_cmp_eq_u32 s47, 0
  s_cbranch_scc1 L_apoll_done
  s_cbranch_vccnz L_apoll_again
L_apoll_done:
  s_xor_b32 s45, s30, 2
  s_mul_i32 s45, s45, 4608
  s_add_u32 s45, s45, 131072
  s_cmp_eq_u32 s30, 1
  s_cselect_b32 s45, 147456, s45
  s_add_u32 s27, s95, 3072
  s_cmp_lt_u32 s26, 4
  s_cselect_b32 s45, s27, s45
  s_call_b64 s[100:101], L_uld
  s_cmp_lt_u32 s31, 16
  s_cbranch_scc1 L_a6c
  s_call_b64 s[100:101], L_cprep0
  s_call_b64 s[100:101], L_cprep1
L_a6c:
  s_call_b64 s[100:101], L_cadr
  s_waitcnt vmcnt(0) lgkmcnt(0)
  s_cmp_lt_u32 s26, 4
  s_cbranch_scc1 L_a8
  s_call_b64 s[100:101], L_cvB
  s_call_b64 s[100:101], L_cvA
  s_branch L_cvd
L_a8:
  v_lshrrev_b32 v2, 4, v1
  v_lshlrev_b32 v2, 1, v2
  v_and_b32 v248, 7, v1
  v_xor_b32 v248, v248, v2
  v_lshrrev_b32 v2, 3, v1
  v_mul_u32_u24 v2, 1280, v2
  v_lshl_add_u32 v248, v248, 4, v2
  v_add_u32 v249, 9216, v248
  v_add_u32 v250, 18432, v248
  v_add_u32 v251, 27648, v248
  s_mov_b32 s16, s86
  s_mov_b32 s17, s87
  s_mov_b32 s18, 2211840
  s_mov_b32 s19, 0x20000
  s_add_u32 m0, s95, 8192
  s_add_u32 s98, s96, 8
  s_sub_u32 s97, s98, 54
  s_cmp_ge_u32 s98, 54
  s_cselect_b32 s98, s97, s98
  s_mul_i32 s98, s98, 40960
  s_add_u32 s98, s98, s94
  buffer_load_dwordx4 v248, s[16:19], s98 offen offset:0 lds
  buffer_load_dwordx4 v249, s[16:19], s98 offen offset:1024 lds
  buffer_load_dwordx4 v250, s[16:19], s98 offen offset:2048 lds
  buffer_load_dwordx4 v251, s[16:19], s98 offen offset:3072 lds
  s_add_u32 m0, s95, 12288
  s_add_u32 s98, s96, 12
  s_sub_u32 s97, s98, 54
  s_cmp_ge_u32 s98, 54
  s_cselect_b32 s98, s97, s98
  s_mul_i32 s98, s98, 40960
  s_add_u32 s98, s98, s94
  buffer_load_dwordx4 v248, s[16:19], s98 offen offset:0 lds
  buffer_load_dwordx4 v249, s[16:19], s98 offen offset:1024 lds
  buffer_load_dwordx4 v250, s[16:19], s98 offen offset:2048 lds
  buffer_load_dwordx4 v251, s[16:19], s98 offen offset:3072 lds
  s_add_u32 m0, s95, 16384
  s_add_u32 s98, s96, 16
  s_sub_u32 s97, s98, 54
  s_cmp_ge_u32 s98, 54
  s_cselect_b32 s98, s97, s98
  s_mul_i32 s98, s98, 40960
  s_add_u32 s98, s98, s94
  buffer_load_dwordx4 v248, s[16:19], s98 offen offset:0 lds
  buffer_load_dwordx4 v249, s[16:19], s98 offen offset:1024 lds
  buffer_load_dwordx4 v250, s[16:19], s98 offen offset:2048 lds
  buffer_load_dwordx4 v251, s[16:19], s98 offen offset:3072 lds
  s_add_u32 m0, s95, 20480
  s_add_u32 s98, s96, 20
  s_sub_u32 s97, s98, 54
  s_cmp_ge_u32 s98, 54
  s_cselect_b32 s98, s97, s98
  s_mul_i32 s98, s98, 40960
  s_add_u32 s98, s98, s94
  buffer_load_dwordx4 v248, s[16:19], s98 offen offset:0 lds
  buffer_load_dwordx4 v249, s[16:19], s98 offen offset:1024 lds
  buffer_load_dwordx4 v250, s[16:19], s98 offen offset:2048 lds
  buffer_load_dwordx4 v251, s[16:19], s98 offen offset:3072 lds
  s_add_u32 m0, s95, 24576
  s_add_u32 s98, s96, 24
  s_sub_u32 s97, s98, 54
  s_cmp_ge_u32 s98, 54
  s_cselect_b32 s98, s97, s98
  s_mul_i32 s98, s98, 40960
  s_add_u32 s98, s98, s94
  buffer_load_dwordx4 v248, s[16:19], s98 offen offset:0 lds
  buffer_load_dwordx4 v249, s[16:19], s98 offen offset:1024 lds
  buffer_load_dwordx4 v250, s[16:19], s98 offen offset:2048 lds
  buffer_load_dwordx4 v251, s[16:19], s98 offen offset:3072 lds
  s_add_u32 m0, s95, 28672
  s_add_u32 s98, s96, 28
  s_sub_u32 s97, s98, 54
  s_cmp_ge_u32 s98, 54
  s_cselect_b32 s98, s97, s98
  s_mul_i32 s98, s98, 40960
  s_add_u32 s98, s98, s94
  buffer_load_dwordx4 v248, s[16:19], s98 offen offset:0 lds
  buffer_load_dwordx4 v249, s[16:19], s98 offen offset:1024 lds
  buffer_load_dwordx4 v250, s[16:19], s98 offen offset:2048 lds
  buffer_load_dwordx4 v251, s[16:19], s98 offen offset:3072 lds
  s_setprio 1
  s_bitcmp1_b32 s26, 0
  s_cbranch_scc1 L_a9
  s_call_b64 s[100:101], L_cvA
  s_branch L_ag2
L_a9:
  s_call_b64 s[100:101], L_cvB
  s_branch L_ag2
L_a5:
L_ag2:
  s_cmp_lt_u32 s31, 16
  s_cbranch_scc1 L_ag3
  v_lshlrev_b32 v3, 4, v1
  v_add_u32 v4, 55296, v3
  v_add_u32 v5, 110592, v3
  v_add_u32 v6, 165888, v3
  v_add_u32 v7, 221184, v3
  v_lshrrev_b32 v13, 2, v1
  v_lshlrev_b32 v8, 7, v13
  v_bfe_u32 v13, v1, 3, 2
  v_lshl_add_u32 v8, v13, 5, v8
  v_and_b32 v13, 3, v1
  v_lshl_add_u32 v8, v13, 3, v8
  v_add_u32 v8, s95, v8
  v_xor_b32 v9, 32, v8
  v_xor_b32 v10, 64, v8
  v_xor_b32 v11, 0x60, v8
  v_lshrrev_b32 v13, 4, v1
  v_lshlrev_b32 v13, 1, v13
  v_and_b32 v172, 7, v1
  v_xor_b32 v172, v172, v13
  v_lshrrev_b32 v13, 3, v1
  v_mul_u32_u24 v13, 1280, v13
  v_lshl_add_u32 v172, v172, 4, v13
  v_add_u32 v173, 9216, v172
  v_add_u32 v174, 18432, v172
  v_add_u32 v175, 27648, v172
  s_mov_b32 s16, s86
  s_mov_b32 s17, s87
  s_mov_b32 s18, 2211840
  s_mov_b32 s19, 0x20000
  s_add_u32 s48, s96, 0
  s_sub_u32 s97, s48, 54
  s_cmp_ge_u32 s48, 54
  s_cselect_b32 s48, s97, s48
  s_mul_i32 s48, s48, 1024
  s_add_u32 s48, s48, s93
  s_add_u32 s49, s96, 4
  s_sub_u32 s97, s49, 54
  s_cmp_ge_u32 s49, 54
  s_cselect_b32 s49, s97, s49
  s_mul_i32 s49, s49, 1024
  s_add_u32 s49, s49, s93
  s_add_u32 s50, s96, 8
  s_sub_u32 s97, s50, 54
  s_cmp_ge_u32 s50, 54
  s_cselect_b32 s50, s97, s50
  s_mul_i32 s50, s50, 1024
  s_add_u32 s50, s50, s93
  s_add_u32 s51, s96, 12
  s_sub_u32 s97, s51, 54
  s_cmp_ge_u32 s51, 54
  s_cselect_b32 s51, s97, s51
  s_mul_i32 s51, s51, 1024
  s_add_u32 s51, s51, s93
  s_add_u32 s52, s96, 16
  s_sub_u32 s97, s52, 54
  s_cmp_ge_u32 s52, 54
  s_cselect_b32 s52, s97, s52
  s_mul_i32 s52, s52, 1024
  s_add_u32 s52, s52, s93
  s_add_u32 s53, s96, 20
  s_sub_u32 s97, s53, 54
  s_cmp_ge_u32 s53, 54
  s_cselect_b32 s53, s97, s53
  s_mul_i32 s53, s53, 1024
  s_add_u32 s53, s53, s93
  s_add_u32 s54, s96, 24
  s_sub_u32 s97, s54, 54
  s_cmp_ge_u32 s54, 54
  s_cselect_b32 s54, s97, s54
  s_mul_i32 s54, s54, 1024
  s_add_u32 s54, s54, s93
  s_add_u32 s55, s96, 28
  s_sub_u32 s97, s55, 54
  s_cmp_ge_u32 s55, 54
  s_cselect_b32 s55, s97, s55
  s_mul_i32 s55, s55, 1024
  s_add_u32 s55, s55, s93
  s_add_u32 s56, s96, 32
  s_sub_u32 s97, s56, 54
  s_cmp_ge_u32 s56, 54
  s_cselect_b32 s56, s97, s56
  s_mul_i32 s56, s56, 1024
  s_add_u32 s56, s56, s93
  s_add_u32 s57, s96, 36
  s_sub_u32 s97, s57, 54
  s_cmp_ge_u32 s57, 54
  s_cselect_b32 s57, s97, s57
  s_mul_i32 s57, s57, 1024
  s_add_u32 s57, s57, s93
  s_add_u32 s58, s96, 40
  s_sub_u32 s97, s58, 54
  s_cmp_ge_u32 s58, 54
  s_cselect_b32 s58, s97, s58
  s_mul_i32 s58, s58, 1024
  s_add_u32 s58, s58, s93
  s_add_u32 s59, s96, 44
  s_sub_u32 s97, s59, 54
  s_cmp_ge_u32 s59, 54
  s_cselect_b32 s59, s97, s59
  s_mul_i32 s59, s59, 1024
  s_add_u32 s59, s59, s93
  s_add_u32 s42, s96, 48
  s_sub_u32 s97, s42, 54
  s_cmp_ge_u32 s42, 54
  s_cselect_b32 s42, s97, s42
  s_mul_i32 s42, s42, 1024
  s_add_u32 s42, s42, s93
  s_add_u32 s43, s96, 52
  s_sub_u32 s97, s43, 54
  s_cmp_ge_u32 s43, 54
  s_cselect_b32 s43, s97, s43
  s_mul_i32 s43, s43, 1024
  s_add_u32 s43, s43, s93
  s_cmp_lt_u32 s26, 2
  s_cselect_b32 s43, s43, 2147483392
  s_add_u32 m0, s95, 0
  s_add_u32 s98, s96, 0
  s_sub_u32 s97, s98, 54
  s_cmp_ge_u32 s98, 54
  s_cselect_b32 s98, s97, s98
  s_mul_i32 s98, s98, 40960
  s_add_u32 s98, s98, s94
  buffer_load_dwordx4 v172, s[16:19], s98 offen offset:0 lds
  buffer_load_dwordx4 v173, s[16:19], s98 offen offset:1024 lds
  buffer_load_dwordx4 v174, s[16:19], s98 offen offset:2048 lds
  buffer_load_dwordx4 v175, s[16:19], s98 offen offset:3072 lds
  s_add_u32 m0, s95, 4096
  s_add_u32 s98, s96, 4
  s_sub_u32 s97, s98, 54
  s_cmp_ge_u32 s98, 54
  s_cselect_b32 s98, s97, s98
  s_mul_i32 s98, s98, 40960
  s_add_u32 s98, s98, s94
  buffer_load_dwordx4 v172, s[16:19], s98 offen offset:0 lds
  buffer_load_dwordx4 v173, s[16:19], s98 offen offset:1024 lds
  buffer_load_dwordx4 v174, s[16:19], s98 offen offset:2048 lds
  buffer_load_dwordx4 v175, s[16:19], s98 offen offset:3072 lds
  s_mov_b32 s27, 2147483392
  s_waitcnt vmcnt(0)
  s_branch L_n2
L_ag3:
  v_add_u32 v173, 0, v1
  v_mul_u32_u24 v174, 6554, v173
  v_lshrrev_b32 v174, 16, v174
  v_mul_u32_u24 v174, 1120, v174
  v_lshl_add_u32 v3, v173, 4, v174
  v_add_u32 v173, 64, v1
  v_mul_u32_u24 v174, 6554, v173
  v_lshrrev_b32 v174, 16, v174
  v_mul_u32_u24 v174, 1120, v174
  v_lshl_add_u32 v4, v173, 4, v174
  v_add_u32 v173, 128, v1
  v_mul_u32_u24 v174, 6554, v173
  v_lshrrev_b32 v174, 16, v174
  v_mul_u32_u24 v174, 1120, v174
  v_lshl_add_u32 v5, v173, 4, v174
  v_add_u32 v173, 192, v1
  v_mul_u32_u24 v174, 6554, v173
  v_lshrrev_b32 v174, 16, v174
  v_mul_u32_u24 v174, 1120, v174
  v_lshl_add_u32 v6, v173, 4, v174
  v_add_u32 v173, 256, v1
  v_mul_u32_u24 v174, 6554, v173
  v_lshrrev_b32 v174, 16, v174
  v_mul_u32_u24 v174, 1120, v174
  v_lshl_add_u32 v7, v173, 4, v174
  s_mov_b32 s16, s86
  s_mov_b32 s17, s87
  s_mov_b32 s18, 2211840
  s_mov_b32 s19, 0x20000
  v_lshlrev_b32 v2, 4, v1
  s_branch L_g2
L_ygo:
  v_add_u32 v79, 0, v0
  v_mul_u32_u24 v78, 6554, v79
  v_lshrrev_b32 v78, 16, v78
  v_mul_u32_u24 v72, 10, v78
  v_sub_u32 v79, v79, v72
  v_mul_u32_u24 v72, 1280, v78
  v_lshl_add_u32 v72, v79, 4, v72
  s_mul_i32 s36, s90, 20480
  s_add_u32 s36, s36, s94
  buffer_load_dwordx4 v[64:67], v72, s[8:11], s36 offen
  v_mul_u32_u24 v74, 336, v78
  v_lshl_add_u32 v74, v79, 5, v74
  v_mul_u32_u24 v76, 176, v78
  v_lshl_add_u32 v76, v79, 4, v76
  v_add_u32 v76, 152064, v76
  v_add_u32 v79, 128, v0
  v_mul_u32_u24 v78, 6554, v79
  v_lshrrev_b32 v78, 16, v78
  v_mul_u32_u24 v73, 10, v78
  v_sub_u32 v79, v79, v73
  v_mul_u32_u24 v73, 1280, v78
  v_lshl_add_u32 v73, v79, 4, v73
  s_mul_i32 s36, s90, 20480
  s_add_u32 s36, s36, s94
  buffer_load_dwordx4 v[68:71], v73, s[8:11], s36 offen
  v_mul_u32_u24 v75, 336, v78
  v_lshl_add_u32 v75, v79, 5, v75
  v_mul_u32_u24 v77, 176, v78
  v_lshl_add_u32 v77, v79, 4, v77
  v_add_u32 v77, 152064, v77
  s_mov_b32 s12, s84
  s_mov_b32 s13, s85
  s_mov_b32 s14, 2621440
  s_mov_b32 s15, 0x20000
  s_mul_i32 s27, s91, 10240
  s_mul_i32 s28, s30, 2560
  s_add_u32 s27, s27, s28
  s_add_u32 s27, s27, 540672
  v_min_u32 v2, 19, v1
  v_lshlrev_b32 v2, 7, v2
  s_lshr_b32 s33, s90, 2
  s_barrier
  s_mov_b32 s47, 100000
  s_branch L_opoll_go
L_opoll_again:
  s_sleep 4
L_opoll_go:
  buffer_load_dword v8, v2, s[20:23], s27 offen sc1
  s_sub_u32 s47, s47, 1
  s_waitcnt vmcnt(0)
  v_xor_b32 v8, s3, v8
  v_cmp_ne_u32 vcc, 0, v8
  s_cmp_eq_u32 s47, 0
  s_cbranch_scc1 L_opoll_done
  s_cbranch_vccnz L_opoll_again
L_opoll_done:
  v_lshrrev_b32 v2, 3, v1
  v_lshlrev_b32 v2, 12, v2
  v_and_b32 v3, 7, v1
  v_lshl_add_u32 v2, v3, 4, v2
  s_mul_i32 s27, s91, 80
  s_mul_i32 s28, s30, 20
  s_add_u32 s27, s27, s28
  s_lshl_b32 s27, s27, 12
  s_lshl_b32 s28, s33, 7
  s_add_u32 s27, s27, s28
  s_add_u32 s27, s27, 18874368
  s_mov_b32 s35, s45
  s_add_u32 m0, s35, 0
  s_add_u32 s34, s27, 0
  buffer_load_dwordx4 v2, s[20:23], s34 offen sc1 lds
  s_add_u32 m0, s35, 1024
  s_add_u32 s34, s27, 32768
  buffer_load_dwordx4 v2, s[20:23], s34 offen sc1 lds
  s_mov_b32 exec_hi, 0
  s_add_u32 m0, s35, 2048
  s_add_u32 s34, s27, 65536
  buffer_load_dwordx4 v2, s[20:23], s34 offen sc1 lds
  s_mov_b64 exec, -1
  v_lshrrev_b32 v4, 2, v1
  v_and_b32 v4, 3, v4
  v_lshlrev_b32 v4, 7, v4
  v_lshrrev_b32 v5, 4, v1
  v_lshl_add_u32 v4, v5, 5, v4
  v_and_b32 v5, 3, v1
  v_lshl_add_u32 v4, v5, 3, v4
  v_add_u32 v4, s35, v4
  v_mul_u32_u24 v5, 176, v1
  s_mul_i32 s28, s30, 40
  s_add_u32 s28, s28, 152064
  v_add_u32 v5, s28, v5
  s_waitcnt vmcnt(0)
  ds_read_b64_tr_b16 v[8:9], v4 offset:0
  ds_read_b64_tr_b16 v[10:11], v4 offset:512
  ds_read_b64_tr_b16 v[12:13], v4 offset:1024
  ds_read_b64_tr_b16 v[14:15], v4 offset:1536
  ds_read_b64_tr_b16 v[16:17], v4 offset:2048
  s_waitcnt lgkmcnt(0)
  ds_write_b64 v5, v[8:9] offset:0
  ds_write_b64 v5, v[10:11] offset:8
  ds_write_b64 v5, v[12:13] offset:16
  ds_write_b64 v5, v[14:15] offset:24
  ds_write_b64 v5, v[16:17] offset:32
  s_waitcnt lgkmcnt(0)
  s_branch L_join
L_end2:
  s_endpgm

.section .rodata,"a"
.p2align 6
.amdhsa_kernel parallel_sum__ssm_conv_s4d__glu_gated_swiglu__prompt_kernel
  .amdhsa_next_free_vgpr 256
  .amdhsa_next_free_sgpr 102
  .amdhsa_accum_offset 256
  .amdhsa_group_segment_fixed_size 0
  .amdhsa_kernarg_size 112
  .amdhsa_user_sgpr_count 2
  .amdhsa_user_sgpr_kernarg_segment_ptr 1
  .amdhsa_system_sgpr_workgroup_id_x 1
  .amdhsa_float_denorm_mode_32 3
.end_amdhsa_kernel
.text
```
